```python
import torch

def _softmax(x, axis=-1):
    return torch.softmax(x, dim=axis)
def _gelu(x):
    return torch.nn.functional.gelu(x, approximate="tanh")
def _silu(x):
    return torch.nn.functional.silu(x)
def _sigmoid(x):
    return torch.sigmoid(x)
def _layernorm(x, axis=-1, eps=1e-5):
    m = x.mean(dim=axis, keepdim=True)
    v = x.var(dim=axis, keepdim=True, unbiased=False)
    return (x - m) / torch.sqrt(v + eps)
def _scatter_add(tgt, idx, src, axis=0):
    return tgt.clone().index_add_(axis, idx, src)
def _segment_sum(src, seg, n):
    out = torch.zeros((n,) + src.shape[1:], dtype=src.dtype)
    return out.index_add_(0, seg, src)
def _pad(x, pw):
    flat = tuple(v for pair in reversed(pw) for v in pair)
    return torch.nn.functional.pad(x, flat)

kernel_name = 'interleave_layers__gqa_block_cached__dense_activation_silu__decode'

def setup_inputs():

    _w = (lambda a: (lambda t: t.to(torch.bfloat16) if t.is_floating_point() else t)(torch.as_tensor(a)))
    def _A_setup():
        B, Sq, D = 8, 1, 512
        Hq, Hkv, Sk, Dh = 32, 32, 4096, 128
        assert Hq % Hkv == 0, (Hq, Hkv)
        return {
            "x": _w((lambda *s: torch.randn(*s, dtype=torch.bfloat16) * 0.1)(B, Sq, D)),
            "k_cache": _w((lambda *s: torch.randn(*s, dtype=torch.bfloat16) * 0.8)(B, Hkv, Sk, Dh)),
            "v_cache": _w((lambda *s: torch.randn(*s, dtype=torch.bfloat16) * 1.6)(B, Hkv, Sk, Dh)),
            "wq": _w((lambda *s: torch.randn(*s, dtype=torch.bfloat16) * 0.8)(D, Hq * Dh) * (D ** -0.5)),
            "wo": _w((lambda *s: torch.randn(*s, dtype=torch.bfloat16) * 1.6)(Hq * Dh, D) * ((Hq * Dh) ** -0.5)),
        }
    _A_in = _A_setup()

    def _B_setup():
        B, S, D, F = 8, 1, 512, 1376
        return {
            "x": _w((lambda *s: torch.randn(*s, dtype=torch.bfloat16) * 0.1)(B, S, D)),
            "w1": _w((lambda *s: torch.randn(*s, dtype=torch.bfloat16) * 0.4)(D, F) * (D ** -0.5)),
            "w2": _w((lambda *s: torch.randn(*s, dtype=torch.bfloat16) * 0.4)(F, D) * (F ** -0.5)),
        }
    _B_in = _B_setup()

    return {
        "A_x": _A_in["x"],
        "A_k_cache": _A_in["k_cache"],
        "A_v_cache": _A_in["v_cache"],
        "A_wq": _A_in["wq"],
        "A_wo": _A_in["wo"],
        "B_x": _B_in["x"],
        "B_w1": _B_in["w1"],
        "B_w2": _B_in["w2"],
    }

def reference(A_x, A_k_cache, A_v_cache, A_wq, A_wo, B_x, B_w1, B_w2):
    def _A_ref(x, k_cache, v_cache, wq, wo):
        B, Sq, D = x.shape
        Hq, Dh = 32, 128
        Hkv = k_cache.shape[1]
        rep = Hq // Hkv
        q = (lambda x, *d: x.permute(*d))((x @ wq).reshape(B, Sq, Hq, Dh), 0, 2, 1, 3)
        k = (lambda x, n, axis: torch.repeat_interleave(x, n, dim=axis))(k_cache, rep, axis=1)
        v = (lambda x, n, axis: torch.repeat_interleave(x, n, dim=axis))(v_cache, rep, axis=1)
        scores = torch.einsum("bhqd,bhkd->bhqk", q, k) * (Dh ** -0.5)
        p = _softmax(scores, axis=-1)
        o = torch.einsum("bhqk,bhkd->bhqd", p, v)
        return (lambda x, *d: x.permute(*d))(o, 0, 2, 1, 3).reshape(B, Sq, Hq * Dh) @ wo

    def _B_ref(x, w1, w2):
        h = torch.einsum("bsd,df->bsf", x, w1)
        h = _silu(h)
        out = torch.einsum("bsf,fd->bsd", h, w2)
        return out

    x = A_x
    x = x + _A_ref(_layernorm(x, axis=-1), A_k_cache, A_v_cache, A_wq, A_wo)
    x = x + _B_ref(_layernorm(x, axis=-1), B_w1, B_w2)
    x = x + _A_ref(_layernorm(x, axis=-1), A_k_cache, A_v_cache, A_wq, A_wo)
    x = x + _B_ref(_layernorm(x, axis=-1), B_w1, B_w2)
    return x
```

```asm
; @launch grid=(256,1,1) block=(512,1,1) lds=160288
.amdgcn_target "amdgcn-amd-amdhsa--gfx950"
.text
.globl interleave_layers__gqa_block_cached__dense_activation_silu__decode_kernel
.p2align 8
.type interleave_layers__gqa_block_cached__dense_activation_silu__decode_kernel,@function
interleave_layers__gqa_block_cached__dense_activation_silu__decode_kernel:
s_cmp_ge_u32 s2, 256
s_cbranch_scc1 L_exit
s_load_dwordx16 s[8:23], s[0:1], 0
s_load_dwordx4 s[24:27], s[0:1], 64
s_load_dwordx2 s[28:29], s[0:1], 80
v_lshrrev_b32 v2, 6, v0
s_nop 0
v_readfirstlane_b32 s30, v2
s_mov_b32 s47, 0
s_mov_b32 s44, 0x3e0293ee
s_waitcnt lgkmcnt(0)
s_lshl_b32 s72, s2, 3
s_add_u32 s72, s72, s30
s_lshl_b32 s72, s72, 9
s_add_u32 s72, s72, 0x800000
s_cmp_ge_u32 s2, 224
s_cbranch_scc1 L_chain
s_mov_b32 s3, 0x24924925
s_mul_hi_u32 s31, s2, s3
s_mul_i32 s3, s31, 7
s_sub_u32 s32, s2, s3
v_and_b32 v16, 63, v0
s_mul_i32 s3, s32, 147
s_mul_i32 s4, s30, 19
s_add_u32 s3, s3, s4
s_lshl_b32 s3, s3, 10
v_lshlrev_b32 v1, 4, v16
v_add_u32 v0, s3, v1
s_mul_i32 s48, s30, 20480
v_add_u32 v1, s48, v1
s_lshl_b32 s3, s31, 20
s_add_u32 s36, s10, s3
s_addc_u32 s37, s11, 0
s_and_b32 s37, s37, 0xffff
s_mov_b32 s38, 0x100000
s_mov_b32 s39, 0x00020000
s_add_u32 s40, s12, s3
s_addc_u32 s41, s13, 0
s_and_b32 s41, s41, 0xffff
s_mov_b32 s42, 0x100000
s_mov_b32 s43, 0x00020000
s_cmp_eq_u32 s32, 6
s_cselect_b32 s45, 0xf149f2ca, 0
v_and_b32 v17, 15, v16
v_and_b32 v18, 1, v17
v_cmp_eq_u32 vcc, 1, v18
v_mov_b32 v19, 0xffff
v_mov_b32 v20, 0xffff0000
v_cndmask_b32 v19, v19, v20, vcc
v_lshrrev_b32 v18, 1, v17
v_cmp_eq_u32 vcc, 0, v18
s_nop 1
v_cndmask_b32 v12, 0, v19, vcc
v_cmp_eq_u32 vcc, 1, v18
s_nop 1
v_cndmask_b32 v13, 0, v19, vcc
v_cmp_eq_u32 vcc, 2, v18
s_nop 1
v_cndmask_b32 v14, 0, v19, vcc
v_cmp_eq_u32 vcc, 3, v18
s_nop 1
v_cndmask_b32 v15, 0, v19, vcc
s_lshl_b32 s3, s2, 3
s_add_u32 s3, s3, s30
v_lshlrev_b32 v17, 4, v16
s_mov_b32 s64, s14
s_and_b32 s65, s15, 0xffff
s_mov_b32 s66, 4194304
s_mov_b32 s67, 0x00020000
s_mul_i32 s4, s3, 3072
buffer_load_dwordx4 v[32:35], v17, s[64:67], s4 offen offset:0
buffer_load_dwordx4 v[32:35], v17, s[64:67], s4 offen offset:1024
buffer_load_dwordx4 v[32:35], v17, s[64:67], s4 offen offset:2048
s_mov_b32 s64, s16
s_and_b32 s65, s17, 0xffff
s_mov_b32 s66, 4194304
s_mov_b32 s67, 0x00020000
s_mul_i32 s4, s3, 3072
buffer_load_dwordx4 v[32:35], v17, s[64:67], s4 offen offset:0
buffer_load_dwordx4 v[32:35], v17, s[64:67], s4 offen offset:1024
buffer_load_dwordx4 v[32:35], v17, s[64:67], s4 offen offset:2048
s_mov_b32 s64, s20
s_and_b32 s65, s21, 0xffff
s_mov_b32 s66, 1409024
s_mov_b32 s67, 0x00020000
s_mul_i32 s4, s3, 1024
buffer_load_dwordx4 v[32:35], v17, s[64:67], s4 offen offset:0
s_mov_b32 s64, s22
s_and_b32 s65, s23, 0xffff
s_mov_b32 s66, 1409024
s_mov_b32 s67, 0x00020000
s_mul_i32 s4, s3, 1024
buffer_load_dwordx4 v[32:35], v17, s[64:67], s4 offen offset:0
s_cmp_lt_u32 s30, 4
s_cbranch_scc1 .L1
s_setprio 2
.L1:
s_nop 4
s_cmp_eq_u32 s30, 7
s_cbranch_scc1 L_w7
s_barrier
s_mov_b32 s54, 0
s_nop 7
s_mov_b32 s46, 0
buffer_load_dwordx4 v[32:35], v0, s[36:39], s46 offen nt
s_mov_b32 s46, 1024
buffer_load_dwordx4 v[36:39], v0, s[36:39], s46 offen nt
s_mov_b32 s46, 2048
buffer_load_dwordx4 v[40:43], v0, s[36:39], s46 offen nt
s_mov_b32 s46, 3072
buffer_load_dwordx4 v[44:47], v0, s[36:39], s46 offen nt
s_mov_b32 s46, 0
s_add_u32 s49, s48, 0
s_mov_b32 m0, s49
s_nop 0
buffer_load_dwordx4 v0, s[40:43], s46 offen nt lds
s_waitcnt vmcnt(4)
s_mov_b32 s46, 1024
s_add_u32 s49, s48, 1024
s_mov_b32 m0, s49
s_nop 0
buffer_load_dwordx4 v0, s[40:43], s46 offen nt lds
s_waitcnt vmcnt(4)
s_mov_b32 s46, 2048
s_add_u32 s49, s48, 2048
s_mov_b32 m0, s49
s_nop 0
buffer_load_dwordx4 v0, s[40:43], s46 offen nt lds
s_waitcnt vmcnt(4)
s_mov_b32 s46, 3072
s_add_u32 s49, s48, 3072
s_mov_b32 m0, s49
s_nop 0
buffer_load_dwordx4 v0, s[40:43], s46 offen nt lds
s_nop 7
s_waitcnt vmcnt(4)
s_mov_b32 s46, 4096
buffer_load_dwordx4 v[48:51], v0, s[36:39], s46 offen nt
s_waitcnt vmcnt(4)
s_mov_b32 s46, 5120
buffer_load_dwordx4 v[52:55], v0, s[36:39], s46 offen nt
s_waitcnt vmcnt(4)
s_mov_b32 s46, 6144
buffer_load_dwordx4 v[56:59], v0, s[36:39], s46 offen nt
s_waitcnt vmcnt(4)
s_mov_b32 s46, 7168
buffer_load_dwordx4 v[60:63], v0, s[36:39], s46 offen nt
s_waitcnt vmcnt(4)
s_mov_b32 s46, 4096
s_add_u32 s49, s48, 4096
s_mov_b32 m0, s49
s_nop 0
buffer_load_dwordx4 v0, s[40:43], s46 offen nt lds
s_waitcnt vmcnt(4)
s_mov_b32 s46, 5120
s_add_u32 s49, s48, 5120
s_mov_b32 m0, s49
s_nop 0
buffer_load_dwordx4 v0, s[40:43], s46 offen nt lds
s_waitcnt vmcnt(4)
s_mov_b32 s46, 6144
s_add_u32 s49, s48, 6144
s_mov_b32 m0, s49
s_nop 0
buffer_load_dwordx4 v0, s[40:43], s46 offen nt lds
s_waitcnt vmcnt(4)
s_mov_b32 s46, 7168
s_add_u32 s49, s48, 7168
s_mov_b32 m0, s49
s_nop 0
buffer_load_dwordx4 v0, s[40:43], s46 offen nt lds
s_nop 7
s_waitcnt vmcnt(4)
s_mov_b32 s46, 8192
buffer_load_dwordx4 v[64:67], v0, s[36:39], s46 offen nt
s_waitcnt vmcnt(4)
s_mov_b32 s46, 9216
buffer_load_dwordx4 v[68:71], v0, s[36:39], s46 offen nt
s_waitcnt vmcnt(4)
s_mov_b32 s46, 10240
buffer_load_dwordx4 v[72:75], v0, s[36:39], s46 offen nt
s_waitcnt vmcnt(4)
s_mov_b32 s46, 11264
buffer_load_dwordx4 v[76:79], v0, s[36:39], s46 offen nt
s_waitcnt vmcnt(4)
s_mov_b32 s46, 8192
s_add_u32 s49, s48, 8192
s_mov_b32 m0, s49
s_nop 0
buffer_load_dwordx4 v0, s[40:43], s46 offen nt lds
s_waitcnt vmcnt(4)
s_mov_b32 s46, 9216
s_add_u32 s49, s48, 9216
s_mov_b32 m0, s49
s_nop 0
buffer_load_dwordx4 v0, s[40:43], s46 offen nt lds
s_waitcnt vmcnt(4)
s_mov_b32 s46, 10240
buffer_load_dwordx4 v[108:111], v0, s[40:43], s46 offen nt
s_waitcnt vmcnt(4)
s_mov_b32 s46, 11264
buffer_load_dwordx4 v[112:115], v0, s[40:43], s46 offen nt
s_nop 7
s_waitcnt vmcnt(4)
s_mov_b32 s46, 12288
buffer_load_dwordx4 v[80:83], v0, s[36:39], s46 offen nt
s_waitcnt vmcnt(4)
s_mov_b32 s46, 13312
buffer_load_dwordx4 v[84:87], v0, s[36:39], s46 offen nt
s_waitcnt vmcnt(4)
s_mov_b32 s46, 14336
buffer_load_dwordx4 v[88:91], v0, s[36:39], s46 offen nt
s_waitcnt vmcnt(4)
s_mov_b32 s46, 15360
buffer_load_dwordx4 v[92:95], v0, s[36:39], s46 offen nt
s_waitcnt vmcnt(4)
s_mov_b32 s46, 12288
buffer_load_dwordx4 v[116:119], v0, s[40:43], s46 offen nt
s_waitcnt vmcnt(4)
s_mov_b32 s46, 13312
buffer_load_dwordx4 v[120:123], v0, s[40:43], s46 offen nt
s_waitcnt vmcnt(4)
s_mov_b32 s46, 14336
buffer_load_dwordx4 v[124:127], v0, s[40:43], s46 offen nt
s_waitcnt vmcnt(4)
s_mov_b32 s46, 15360
buffer_load_dwordx4 v[128:131], v0, s[40:43], s46 offen nt
s_nop 7
s_waitcnt vmcnt(4)
s_mov_b32 s46, 16384
buffer_load_dwordx4 v[96:99], v0, s[36:39], s46 offen nt
s_waitcnt vmcnt(4)
s_mov_b32 s46, 17408
buffer_load_dwordx4 v[100:103], v0, s[36:39], s46 offen nt
s_waitcnt vmcnt(4)
s_mov_b32 s46, 18432
buffer_load_dwordx4 v[104:107], v0, s[36:39], s46 offen nt
s_waitcnt vmcnt(4)
s_mov_b32 s46, 16384
buffer_load_dwordx4 v[132:135], v0, s[40:43], s46 offen nt
s_waitcnt vmcnt(4)
s_mov_b32 s46, 17408
buffer_load_dwordx4 v[136:139], v0, s[40:43], s46 offen nt
s_waitcnt vmcnt(4)
s_mov_b32 s46, 18432
buffer_load_dwordx4 v[140:143], v0, s[40:43], s46 offen nt
s_mov_b32 s51, 0
s_mov_b32 s52, 1
.L7:
s_nop 4
s_add_u32 s3, s51, 0
s_mul_i32 s3, s3, 57344
s_lshl_b32 s4, s2, 8
s_add_u32 s3, s3, s4
s_add_u32 s3, s3, 4194304
v_subrev_u32 v20, s48, v1
v_and_b32 v20, 0xf0, v20
v_add_u32 v20, s3, v20
global_load_dwordx4 v[2:5], v20, s[28:29] sc1
s_waitcnt vmcnt(0)
.L9:
s_nop 4
v_max3_u32 v17, v2, v3, v4
v_max_u32 v17, v17, v5
v_cmp_eq_u32 vcc, -1, v17
s_nop 0
s_cmp_eq_u64 vcc, 0
s_cbranch_scc1 .L8
s_sleep 2
s_add_u32 s47, s47, 1
s_cmp_lt_u32 s47, 262144
s_cbranch_scc1 .L7
s_endpgm
.L8:
s_nop 4
v_mov_b32 v6, 0xff800000
v_mov_b32 v7, 0
v_mov_b32 v8, 0
v_mov_b32 v9, 0
v_mov_b32 v10, 0
v_mov_b32 v11, 0
v_dot2_f32_bf16 v16, v32, v2, 0
v_dot2_f32_bf16 v17, v36, v2, 0
v_dot2_f32_bf16 v18, v40, v2, 0
v_dot2_f32_bf16 v19, v44, v2, 0
v_dot2_f32_bf16 v16, v33, v3, v16
v_dot2_f32_bf16 v17, v37, v3, v17
v_dot2_f32_bf16 v18, v41, v3, v18
v_dot2_f32_bf16 v19, v45, v3, v19
v_dot2_f32_bf16 v16, v34, v4, v16
v_dot2_f32_bf16 v17, v38, v4, v17
v_dot2_f32_bf16 v18, v42, v4, v18
v_dot2_f32_bf16 v19, v46, v4, v19
v_dot2_f32_bf16 v16, v35, v5, v16
v_dot2_f32_bf16 v17, v39, v5, v17
v_dot2_f32_bf16 v18, v43, v5, v18
v_dot2_f32_bf16 v19, v47, v5, v19
ds_read_b128 v[24:27], v1 offset:0
ds_read_b128 v[28:31], v1 offset:1024
v_add_f32_dpp v16, v16, v16 row_ror:8 row_mask:0xf bank_mask:0xf
v_add_f32_dpp v17, v17, v17 row_ror:8 row_mask:0xf bank_mask:0xf
v_add_f32_dpp v18, v18, v18 row_ror:8 row_mask:0xf bank_mask:0xf
v_add_f32_dpp v19, v19, v19 row_ror:8 row_mask:0xf bank_mask:0xf
v_add_f32_dpp v16, v16, v16 row_ror:4 row_mask:0xf bank_mask:0xf
v_add_f32_dpp v17, v17, v17 row_ror:4 row_mask:0xf bank_mask:0xf
v_add_f32_dpp v18, v18, v18 row_ror:4 row_mask:0xf bank_mask:0xf
v_add_f32_dpp v19, v19, v19 row_ror:4 row_mask:0xf bank_mask:0xf
v_add_f32_dpp v16, v16, v16 row_ror:2 row_mask:0xf bank_mask:0xf
v_add_f32_dpp v17, v17, v17 row_ror:2 row_mask:0xf bank_mask:0xf
v_add_f32_dpp v18, v18, v18 row_ror:2 row_mask:0xf bank_mask:0xf
v_add_f32_dpp v19, v19, v19 row_ror:2 row_mask:0xf bank_mask:0xf
v_add_f32_dpp v16, v16, v16 row_ror:1 row_mask:0xf bank_mask:0xf
v_add_f32_dpp v17, v17, v17 row_ror:1 row_mask:0xf bank_mask:0xf
v_add_f32_dpp v18, v18, v18 row_ror:1 row_mask:0xf bank_mask:0xf
v_add_f32_dpp v19, v19, v19 row_ror:1 row_mask:0xf bank_mask:0xf
v_max3_f32 v20, v16, v17, v18
v_max3_f32 v20, v20, v19, v6
v_mov_b32 v21, v20
s_nop 1
v_permlane16_swap_b32 v20, v21
v_max_f32 v20, v20, v21
v_mov_b32 v21, v20
s_nop 1
v_permlane32_swap_b32 v20, v21
v_max_f32 v20, v20, v21
v_sub_f32 v21, v6, v20
v_mul_f32 v21, s44, v21
v_exp_f32 v21, v21
v_mul_f32 v22, s44, v20
v_mov_b32 v6, v20
v_fma_f32 v16, v16, s44, -v22
v_fma_f32 v17, v17, s44, -v22
v_fma_f32 v18, v18, s44, -v22
v_fma_f32 v19, v19, s44, -v22
v_exp_f32 v16, v16
v_exp_f32 v17, v17
v_exp_f32 v18, v18
v_exp_f32 v19, v19
v_mul_f32 v7, v7, v21
v_mul_f32 v8, v8, v21
v_mul_f32 v9, v9, v21
v_mul_f32 v10, v10, v21
v_mul_f32 v11, v11, v21
v_add_f32 v7, v7, v16
v_add_f32 v7, v7, v17
v_add_f32 v7, v7, v18
v_add_f32 v7, v7, v19
v_cvt_pk_bf16_f32 v16, v16, v16
v_cvt_pk_bf16_f32 v17, v17, v17
v_cvt_pk_bf16_f32 v18, v18, v18
v_cvt_pk_bf16_f32 v19, v19, v19
s_waitcnt lgkmcnt(0)
v_and_b32 v20, v12, v16
v_and_b32 v21, v13, v16
v_and_b32 v22, v14, v16
v_and_b32 v23, v15, v16
s_nop 1
v_mfma_f32_16x16x32_bf16 v[8:11], v[20:23], v[24:27], v[8:11]
s_nop 7
ds_read_b128 v[24:27], v1 offset:2048
s_waitcnt lgkmcnt(0)
v_and_b32 v20, v12, v17
v_and_b32 v21, v13, v17
v_and_b32 v22, v14, v17
v_and_b32 v23, v15, v17
s_nop 1
v_mfma_f32_16x16x32_bf16 v[8:11], v[20:23], v[28:31], v[8:11]
s_nop 7
ds_read_b128 v[28:31], v1 offset:3072
s_waitcnt lgkmcnt(0)
v_and_b32 v20, v12, v18
v_and_b32 v21, v13, v18
v_and_b32 v22, v14, v18
v_and_b32 v23, v15, v18
s_nop 1
v_mfma_f32_16x16x32_bf16 v[8:11], v[20:23], v[24:27], v[8:11]
s_waitcnt lgkmcnt(0)
v_and_b32 v20, v12, v19
v_and_b32 v21, v13, v19
v_and_b32 v22, v14, v19
v_and_b32 v23, v15, v19
s_nop 1
v_mfma_f32_16x16x32_bf16 v[8:11], v[20:23], v[28:31], v[8:11]
v_dot2_f32_bf16 v16, v48, v2, 0
v_dot2_f32_bf16 v17, v52, v2, 0
v_dot2_f32_bf16 v18, v56, v2, 0
v_dot2_f32_bf16 v19, v60, v2, 0
v_dot2_f32_bf16 v16, v49, v3, v16
v_dot2_f32_bf16 v17, v53, v3, v17
v_dot2_f32_bf16 v18, v57, v3, v18
v_dot2_f32_bf16 v19, v61, v3, v19
v_dot2_f32_bf16 v16, v50, v4, v16
v_dot2_f32_bf16 v17, v54, v4, v17
v_dot2_f32_bf16 v18, v58, v4, v18
v_dot2_f32_bf16 v19, v62, v4, v19
v_dot2_f32_bf16 v16, v51, v5, v16
v_dot2_f32_bf16 v17, v55, v5, v17
v_dot2_f32_bf16 v18, v59, v5, v18
v_dot2_f32_bf16 v19, v63, v5, v19
ds_read_b128 v[24:27], v1 offset:4096
ds_read_b128 v[28:31], v1 offset:5120
v_add_f32_dpp v16, v16, v16 row_ror:8 row_mask:0xf bank_mask:0xf
v_add_f32_dpp v17, v17, v17 row_ror:8 row_mask:0xf bank_mask:0xf
v_add_f32_dpp v18, v18, v18 row_ror:8 row_mask:0xf bank_mask:0xf
v_add_f32_dpp v19, v19, v19 row_ror:8 row_mask:0xf bank_mask:0xf
v_add_f32_dpp v16, v16, v16 row_ror:4 row_mask:0xf bank_mask:0xf
v_add_f32_dpp v17, v17, v17 row_ror:4 row_mask:0xf bank_mask:0xf
v_add_f32_dpp v18, v18, v18 row_ror:4 row_mask:0xf bank_mask:0xf
v_add_f32_dpp v19, v19, v19 row_ror:4 row_mask:0xf bank_mask:0xf
v_add_f32_dpp v16, v16, v16 row_ror:2 row_mask:0xf bank_mask:0xf
v_add_f32_dpp v17, v17, v17 row_ror:2 row_mask:0xf bank_mask:0xf
v_add_f32_dpp v18, v18, v18 row_ror:2 row_mask:0xf bank_mask:0xf
v_add_f32_dpp v19, v19, v19 row_ror:2 row_mask:0xf bank_mask:0xf
v_add_f32_dpp v16, v16, v16 row_ror:1 row_mask:0xf bank_mask:0xf
v_add_f32_dpp v17, v17, v17 row_ror:1 row_mask:0xf bank_mask:0xf
v_add_f32_dpp v18, v18, v18 row_ror:1 row_mask:0xf bank_mask:0xf
v_add_f32_dpp v19, v19, v19 row_ror:1 row_mask:0xf bank_mask:0xf
v_max3_f32 v20, v16, v17, v18
v_max3_f32 v20, v20, v19, v6
v_mov_b32 v21, v20
s_nop 1
v_permlane16_swap_b32 v20, v21
v_max_f32 v20, v20, v21
v_mov_b32 v21, v20
s_nop 1
v_permlane32_swap_b32 v20, v21
v_max_f32 v20, v20, v21
v_sub_f32 v21, v6, v20
v_mul_f32 v21, s44, v21
v_exp_f32 v21, v21
v_mul_f32 v22, s44, v20
v_mov_b32 v6, v20
v_fma_f32 v16, v16, s44, -v22
v_fma_f32 v17, v17, s44, -v22
v_fma_f32 v18, v18, s44, -v22
v_fma_f32 v19, v19, s44, -v22
v_exp_f32 v16, v16
v_exp_f32 v17, v17
v_exp_f32 v18, v18
v_exp_f32 v19, v19
v_mul_f32 v7, v7, v21
v_mul_f32 v8, v8, v21
v_mul_f32 v9, v9, v21
v_mul_f32 v10, v10, v21
v_mul_f32 v11, v11, v21
v_add_f32 v7, v7, v16
v_add_f32 v7, v7, v17
v_add_f32 v7, v7, v18
v_add_f32 v7, v7, v19
v_cvt_pk_bf16_f32 v16, v16, v16
v_cvt_pk_bf16_f32 v17, v17, v17
v_cvt_pk_bf16_f32 v18, v18, v18
v_cvt_pk_bf16_f32 v19, v19, v19
s_waitcnt lgkmcnt(0)
v_and_b32 v20, v12, v16
v_and_b32 v21, v13, v16
v_and_b32 v22, v14, v16
v_and_b32 v23, v15, v16
s_nop 1
v_mfma_f32_16x16x32_bf16 v[8:11], v[20:23], v[24:27], v[8:11]
s_nop 7
ds_read_b128 v[24:27], v1 offset:6144
s_waitcnt lgkmcnt(0)
v_and_b32 v20, v12, v17
v_and_b32 v21, v13, v17
v_and_b32 v22, v14, v17
v_and_b32 v23, v15, v17
s_nop 1
v_mfma_f32_16x16x32_bf16 v[8:11], v[20:23], v[28:31], v[8:11]
s_nop 7
ds_read_b128 v[28:31], v1 offset:7168
s_waitcnt lgkmcnt(0)
v_and_b32 v20, v12, v18
v_and_b32 v21, v13, v18
v_and_b32 v22, v14, v18
v_and_b32 v23, v15, v18
s_nop 1
v_mfma_f32_16x16x32_bf16 v[8:11], v[20:23], v[24:27], v[8:11]
s_waitcnt lgkmcnt(0)
v_and_b32 v20, v12, v19
v_and_b32 v21, v13, v19
v_and_b32 v22, v14, v19
v_and_b32 v23, v15, v19
s_nop 1
v_mfma_f32_16x16x32_bf16 v[8:11], v[20:23], v[28:31], v[8:11]
v_dot2_f32_bf16 v16, v64, v2, 0
v_dot2_f32_bf16 v17, v68, v2, 0
v_dot2_f32_bf16 v18, v72, v2, 0
v_dot2_f32_bf16 v19, v76, v2, 0
v_dot2_f32_bf16 v16, v65, v3, v16
v_dot2_f32_bf16 v17, v69, v3, v17
v_dot2_f32_bf16 v18, v73, v3, v18
v_dot2_f32_bf16 v19, v77, v3, v19
v_dot2_f32_bf16 v16, v66, v4, v16
v_dot2_f32_bf16 v17, v70, v4, v17
v_dot2_f32_bf16 v18, v74, v4, v18
v_dot2_f32_bf16 v19, v78, v4, v19
v_dot2_f32_bf16 v16, v67, v5, v16
v_dot2_f32_bf16 v17, v71, v5, v17
v_dot2_f32_bf16 v18, v75, v5, v18
v_dot2_f32_bf16 v19, v79, v5, v19
ds_read_b128 v[24:27], v1 offset:8192
ds_read_b128 v[28:31], v1 offset:9216
v_add_f32_dpp v16, v16, v16 row_ror:8 row_mask:0xf bank_mask:0xf
v_add_f32_dpp v17, v17, v17 row_ror:8 row_mask:0xf bank_mask:0xf
v_add_f32_dpp v18, v18, v18 row_ror:8 row_mask:0xf bank_mask:0xf
v_add_f32_dpp v19, v19, v19 row_ror:8 row_mask:0xf bank_mask:0xf
v_add_f32_dpp v16, v16, v16 row_ror:4 row_mask:0xf bank_mask:0xf
v_add_f32_dpp v17, v17, v17 row_ror:4 row_mask:0xf bank_mask:0xf
v_add_f32_dpp v18, v18, v18 row_ror:4 row_mask:0xf bank_mask:0xf
v_add_f32_dpp v19, v19, v19 row_ror:4 row_mask:0xf bank_mask:0xf
v_add_f32_dpp v16, v16, v16 row_ror:2 row_mask:0xf bank_mask:0xf
v_add_f32_dpp v17, v17, v17 row_ror:2 row_mask:0xf bank_mask:0xf
v_add_f32_dpp v18, v18, v18 row_ror:2 row_mask:0xf bank_mask:0xf
v_add_f32_dpp v19, v19, v19 row_ror:2 row_mask:0xf bank_mask:0xf
v_add_f32_dpp v16, v16, v16 row_ror:1 row_mask:0xf bank_mask:0xf
v_add_f32_dpp v17, v17, v17 row_ror:1 row_mask:0xf bank_mask:0xf
v_add_f32_dpp v18, v18, v18 row_ror:1 row_mask:0xf bank_mask:0xf
v_add_f32_dpp v19, v19, v19 row_ror:1 row_mask:0xf bank_mask:0xf
v_max3_f32 v20, v16, v17, v18
v_max3_f32 v20, v20, v19, v6
v_mov_b32 v21, v20
s_nop 1
v_permlane16_swap_b32 v20, v21
v_max_f32 v20, v20, v21
v_mov_b32 v21, v20
s_nop 1
v_permlane32_swap_b32 v20, v21
v_max_f32 v20, v20, v21
v_sub_f32 v21, v6, v20
v_mul_f32 v21, s44, v21
v_exp_f32 v21, v21
v_mul_f32 v22, s44, v20
v_mov_b32 v6, v20
v_fma_f32 v16, v16, s44, -v22
v_fma_f32 v17, v17, s44, -v22
v_fma_f32 v18, v18, s44, -v22
v_fma_f32 v19, v19, s44, -v22
v_exp_f32 v16, v16
v_exp_f32 v17, v17
v_exp_f32 v18, v18
v_exp_f32 v19, v19
v_mul_f32 v7, v7, v21
v_mul_f32 v8, v8, v21
v_mul_f32 v9, v9, v21
v_mul_f32 v10, v10, v21
v_mul_f32 v11, v11, v21
v_add_f32 v7, v7, v16
v_add_f32 v7, v7, v17
v_add_f32 v7, v7, v18
v_add_f32 v7, v7, v19
v_cvt_pk_bf16_f32 v16, v16, v16
v_cvt_pk_bf16_f32 v17, v17, v17
v_cvt_pk_bf16_f32 v18, v18, v18
v_cvt_pk_bf16_f32 v19, v19, v19
s_waitcnt lgkmcnt(0)
v_and_b32 v20, v12, v16
v_and_b32 v21, v13, v16
v_and_b32 v22, v14, v16
v_and_b32 v23, v15, v16
s_nop 1
v_mfma_f32_16x16x32_bf16 v[8:11], v[20:23], v[24:27], v[8:11]
s_waitcnt lgkmcnt(0)
v_and_b32 v20, v12, v17
v_and_b32 v21, v13, v17
v_and_b32 v22, v14, v17
v_and_b32 v23, v15, v17
s_nop 1
v_mfma_f32_16x16x32_bf16 v[8:11], v[20:23], v[28:31], v[8:11]
v_and_b32 v20, v12, v18
v_and_b32 v21, v13, v18
v_and_b32 v22, v14, v18
v_and_b32 v23, v15, v18
s_nop 1
v_mfma_f32_16x16x32_bf16 v[8:11], v[20:23], v[108:111], v[8:11]
v_and_b32 v20, v12, v19
v_and_b32 v21, v13, v19
v_and_b32 v22, v14, v19
v_and_b32 v23, v15, v19
s_nop 1
v_mfma_f32_16x16x32_bf16 v[8:11], v[20:23], v[112:115], v[8:11]
v_dot2_f32_bf16 v16, v80, v2, 0
v_dot2_f32_bf16 v17, v84, v2, 0
v_dot2_f32_bf16 v18, v88, v2, 0
v_dot2_f32_bf16 v19, v92, v2, 0
v_dot2_f32_bf16 v16, v81, v3, v16
v_dot2_f32_bf16 v17, v85, v3, v17
v_dot2_f32_bf16 v18, v89, v3, v18
v_dot2_f32_bf16 v19, v93, v3, v19
v_dot2_f32_bf16 v16, v82, v4, v16
v_dot2_f32_bf16 v17, v86, v4, v17
v_dot2_f32_bf16 v18, v90, v4, v18
v_dot2_f32_bf16 v19, v94, v4, v19
v_dot2_f32_bf16 v16, v83, v5, v16
v_dot2_f32_bf16 v17, v87, v5, v17
v_dot2_f32_bf16 v18, v91, v5, v18
v_dot2_f32_bf16 v19, v95, v5, v19
v_add_f32_dpp v16, v16, v16 row_ror:8 row_mask:0xf bank_mask:0xf
v_add_f32_dpp v17, v17, v17 row_ror:8 row_mask:0xf bank_mask:0xf
v_add_f32_dpp v18, v18, v18 row_ror:8 row_mask:0xf bank_mask:0xf
v_add_f32_dpp v19, v19, v19 row_ror:8 row_mask:0xf bank_mask:0xf
v_add_f32_dpp v16, v16, v16 row_ror:4 row_mask:0xf bank_mask:0xf
v_add_f32_dpp v17, v17, v17 row_ror:4 row_mask:0xf bank_mask:0xf
v_add_f32_dpp v18, v18, v18 row_ror:4 row_mask:0xf bank_mask:0xf
v_add_f32_dpp v19, v19, v19 row_ror:4 row_mask:0xf bank_mask:0xf
v_add_f32_dpp v16, v16, v16 row_ror:2 row_mask:0xf bank_mask:0xf
v_add_f32_dpp v17, v17, v17 row_ror:2 row_mask:0xf bank_mask:0xf
v_add_f32_dpp v18, v18, v18 row_ror:2 row_mask:0xf bank_mask:0xf
v_add_f32_dpp v19, v19, v19 row_ror:2 row_mask:0xf bank_mask:0xf
v_add_f32_dpp v16, v16, v16 row_ror:1 row_mask:0xf bank_mask:0xf
v_add_f32_dpp v17, v17, v17 row_ror:1 row_mask:0xf bank_mask:0xf
v_add_f32_dpp v18, v18, v18 row_ror:1 row_mask:0xf bank_mask:0xf
v_add_f32_dpp v19, v19, v19 row_ror:1 row_mask:0xf bank_mask:0xf
v_max3_f32 v20, v16, v17, v18
v_max3_f32 v20, v20, v19, v6
v_mov_b32 v21, v20
s_nop 1
v_permlane16_swap_b32 v20, v21
v_max_f32 v20, v20, v21
v_mov_b32 v21, v20
s_nop 1
v_permlane32_swap_b32 v20, v21
v_max_f32 v20, v20, v21
v_sub_f32 v21, v6, v20
v_mul_f32 v21, s44, v21
v_exp_f32 v21, v21
v_mul_f32 v22, s44, v20
v_mov_b32 v6, v20
v_fma_f32 v16, v16, s44, -v22
v_fma_f32 v17, v17, s44, -v22
v_fma_f32 v18, v18, s44, -v22
v_fma_f32 v19, v19, s44, -v22
v_exp_f32 v16, v16
v_exp_f32 v17, v17
v_exp_f32 v18, v18
v_exp_f32 v19, v19
v_mul_f32 v7, v7, v21
v_mul_f32 v8, v8, v21
v_mul_f32 v9, v9, v21
v_mul_f32 v10, v10, v21
v_mul_f32 v11, v11, v21
v_add_f32 v7, v7, v16
v_add_f32 v7, v7, v17
v_add_f32 v7, v7, v18
v_add_f32 v7, v7, v19
v_cvt_pk_bf16_f32 v16, v16, v16
v_cvt_pk_bf16_f32 v17, v17, v17
v_cvt_pk_bf16_f32 v18, v18, v18
v_cvt_pk_bf16_f32 v19, v19, v19
v_and_b32 v20, v12, v16
v_and_b32 v21, v13, v16
v_and_b32 v22, v14, v16
v_and_b32 v23, v15, v16
s_nop 1
v_mfma_f32_16x16x32_bf16 v[8:11], v[20:23], v[116:119], v[8:11]
v_and_b32 v20, v12, v17
v_and_b32 v21, v13, v17
v_and_b32 v22, v14, v17
v_and_b32 v23, v15, v17
s_nop 1
v_mfma_f32_16x16x32_bf16 v[8:11], v[20:23], v[120:123], v[8:11]
v_and_b32 v20, v12, v18
v_and_b32 v21, v13, v18
v_and_b32 v22, v14, v18
v_and_b32 v23, v15, v18
s_nop 1
v_mfma_f32_16x16x32_bf16 v[8:11], v[20:23], v[124:127], v[8:11]
v_and_b32 v20, v12, v19
v_and_b32 v21, v13, v19
v_and_b32 v22, v14, v19
v_and_b32 v23, v15, v19
s_nop 1
v_mfma_f32_16x16x32_bf16 v[8:11], v[20:23], v[128:131], v[8:11]
v_dot2_f32_bf16 v16, v96, v2, 0
v_dot2_f32_bf16 v17, v100, v2, 0
v_dot2_f32_bf16 v18, v104, v2, 0
v_dot2_f32_bf16 v16, v97, v3, v16
v_dot2_f32_bf16 v17, v101, v3, v17
v_dot2_f32_bf16 v18, v105, v3, v18
v_dot2_f32_bf16 v16, v98, v4, v16
v_dot2_f32_bf16 v17, v102, v4, v17
v_dot2_f32_bf16 v18, v106, v4, v18
v_dot2_f32_bf16 v16, v99, v5, v16
v_dot2_f32_bf16 v17, v103, v5, v17
v_dot2_f32_bf16 v18, v107, v5, v18
s_add_u32 s3, s52, 0
s_mul_i32 s3, s3, 57344
s_lshl_b32 s4, s2, 8
s_add_u32 s3, s3, s4
s_add_u32 s3, s3, 4194304
v_subrev_u32 v20, s48, v1
v_and_b32 v20, 0xf0, v20
v_add_u32 v20, s3, v20
global_load_dwordx4 v[2:5], v20, s[28:29] sc1
v_add_f32_dpp v16, v16, v16 row_ror:8 row_mask:0xf bank_mask:0xf
v_add_f32_dpp v17, v17, v17 row_ror:8 row_mask:0xf bank_mask:0xf
v_add_f32_dpp v18, v18, v18 row_ror:8 row_mask:0xf bank_mask:0xf
v_add_f32_dpp v16, v16, v16 row_ror:4 row_mask:0xf bank_mask:0xf
v_add_f32_dpp v17, v17, v17 row_ror:4 row_mask:0xf bank_mask:0xf
v_add_f32_dpp v18, v18, v18 row_ror:4 row_mask:0xf bank_mask:0xf
v_add_f32_dpp v16, v16, v16 row_ror:2 row_mask:0xf bank_mask:0xf
v_add_f32_dpp v17, v17, v17 row_ror:2 row_mask:0xf bank_mask:0xf
v_add_f32_dpp v18, v18, v18 row_ror:2 row_mask:0xf bank_mask:0xf
v_add_f32_dpp v16, v16, v16 row_ror:1 row_mask:0xf bank_mask:0xf
v_add_f32_dpp v17, v17, v17 row_ror:1 row_mask:0xf bank_mask:0xf
v_add_f32_dpp v18, v18, v18 row_ror:1 row_mask:0xf bank_mask:0xf
v_max3_f32 v20, v16, v17, v18
v_max_f32 v20, v20, v6
v_mov_b32 v21, v20
s_nop 1
v_permlane16_swap_b32 v20, v21
v_max_f32 v20, v20, v21
v_mov_b32 v21, v20
s_nop 1
v_permlane32_swap_b32 v20, v21
v_max_f32 v20, v20, v21
v_sub_f32 v21, v6, v20
v_mul_f32 v21, s44, v21
v_exp_f32 v21, v21
v_mul_f32 v22, s44, v20
v_mov_b32 v6, v20
v_fma_f32 v16, v16, s44, -v22
v_fma_f32 v17, v17, s44, -v22
v_fma_f32 v18, v18, s44, -v22
v_exp_f32 v16, v16
v_exp_f32 v17, v17
v_exp_f32 v18, v18
v_mul_f32 v7, v7, v21
v_mul_f32 v8, v8, v21
v_mul_f32 v9, v9, v21
v_mul_f32 v10, v10, v21
v_mul_f32 v11, v11, v21
v_add_f32 v7, v7, v16
v_add_f32 v7, v7, v17
v_add_f32 v7, v7, v18
v_cvt_pk_bf16_f32 v16, v16, v16
v_cvt_pk_bf16_f32 v17, v17, v17
v_cvt_pk_bf16_f32 v18, v18, v18
v_and_b32 v20, v12, v16
v_and_b32 v21, v13, v16
v_and_b32 v22, v14, v16
v_and_b32 v23, v15, v16
s_nop 1
v_mfma_f32_16x16x32_bf16 v[8:11], v[20:23], v[132:135], v[8:11]
v_and_b32 v20, v12, v17
v_and_b32 v21, v13, v17
v_and_b32 v22, v14, v17
v_and_b32 v23, v15, v17
s_nop 1
v_mfma_f32_16x16x32_bf16 v[8:11], v[20:23], v[136:139], v[8:11]
v_and_b32 v20, v12, v18
v_and_b32 v21, v13, v18
v_and_b32 v22, v14, v18
v_and_b32 v23, v15, v18
s_nop 1
v_mfma_f32_16x16x32_bf16 v[8:11], v[20:23], v[140:143], v[8:11]
v_mul_f32 v6, s44, v6
v_mov_b32 v16, v7
s_nop 1
v_permlane16_swap_b32 v7, v16
v_add_f32 v7, v7, v16
v_mov_b32 v16, v7
s_nop 1
v_permlane32_swap_b32 v7, v16
v_add_f32 v7, v7, v16
v_subrev_u32 v16, s48, v1
v_and_b32 v17, 0xf0, v16
v_lshlrev_b32 v17, 1, v17
v_lshrrev_b32 v18, 8, v16
v_lshl_add_u32 v17, v18, 4, v17
s_mul_i32 s3, s30, 528
s_add_u32 s3, s3, 143360
v_add_u32 v17, s3, v17
s_mov_b32 exec_hi, 0
ds_write_b128 v17, v[8:11]
s_mov_b64 exec, 1
ds_write_b64 v17, v[6:7] offset:512
s_waitcnt lgkmcnt(0)
v_mov_b32 v18, 160256
v_mov_b32 v19, 1
ds_add_rtn_u32 v20, v18, v19
s_waitcnt lgkmcnt(0)
s_mov_b64 exec, -1
v_readfirstlane_b32 s3, v20
s_nop 0
s_and_b32 s3, s3, 7
s_cmp_lg_u32 s3, 7
s_cbranch_scc1 .L10
v_mov_b32 v10, 143872
ds_read_b64 v[16:17], v10 offset:0
ds_read_b64 v[18:19], v10 offset:528
ds_read_b64 v[20:21], v10 offset:1056
ds_read_b64 v[22:23], v10 offset:1584
ds_read_b64 v[24:25], v10 offset:2112
ds_read_b64 v[26:27], v10 offset:2640
ds_read_b64 v[28:29], v10 offset:3168
ds_read_b64 v[30:31], v10 offset:3696
v_subrev_u32 v11, s48, v1
v_lshrrev_b32 v11, 1, v11
v_add_u32 v10, 143360, v11
s_waitcnt lgkmcnt(0)
v_max3_f32 v6, v16, v18, v20
v_max3_f32 v6, v6, v22, v24
v_max3_f32 v6, v6, v26, v28
v_max_f32 v6, v6, v30
v_mov_b32 v7, 0
v_mov_b32 v8, 0
v_mov_b32 v9, 0
v_sub_f32 v16, v16, v6
v_exp_f32 v16, v16
v_sub_f32 v18, v18, v6
v_exp_f32 v18, v18
v_sub_f32 v20, v20, v6
v_exp_f32 v20, v20
v_sub_f32 v22, v22, v6
v_exp_f32 v22, v22
v_sub_f32 v24, v24, v6
v_exp_f32 v24, v24
v_sub_f32 v26, v26, v6
v_exp_f32 v26, v26
v_sub_f32 v28, v28, v6
v_exp_f32 v28, v28
v_sub_f32 v30, v30, v6
v_exp_f32 v30, v30
v_fmac_f32 v7, v16, v17
v_fmac_f32 v7, v18, v19
v_fmac_f32 v7, v20, v21
v_fmac_f32 v7, v22, v23
v_fmac_f32 v7, v24, v25
v_fmac_f32 v7, v26, v27
v_fmac_f32 v7, v28, v29
v_fmac_f32 v7, v30, v31
v_mov_b32 v17, v18
v_mov_b32 v18, v20
v_mov_b32 v19, v22
v_mov_b32 v20, v24
v_mov_b32 v21, v26
v_mov_b32 v22, v28
v_mov_b32 v23, v30
ds_read_b64 v[24:25], v10 offset:0
ds_read_b64 v[26:27], v10 offset:528
ds_read_b64 v[28:29], v10 offset:1056
ds_read_b64 v[30:31], v10 offset:1584
s_waitcnt lgkmcnt(0)
v_fmac_f32 v8, v16, v24
v_fmac_f32 v9, v16, v25
v_fmac_f32 v8, v17, v26
v_fmac_f32 v9, v17, v27
v_fmac_f32 v8, v18, v28
v_fmac_f32 v9, v18, v29
v_fmac_f32 v8, v19, v30
v_fmac_f32 v9, v19, v31
ds_read_b64 v[24:25], v10 offset:2112
ds_read_b64 v[26:27], v10 offset:2640
ds_read_b64 v[28:29], v10 offset:3168
ds_read_b64 v[30:31], v10 offset:3696
s_waitcnt lgkmcnt(0)
v_fmac_f32 v8, v20, v24
v_fmac_f32 v9, v20, v25
v_fmac_f32 v8, v21, v26
v_fmac_f32 v9, v21, v27
v_fmac_f32 v8, v22, v28
v_fmac_f32 v9, v22, v29
v_fmac_f32 v8, v23, v30
v_fmac_f32 v9, v23, v31
v_min_u32 v6, 0xfffffffe, v6
v_min_u32 v7, 0xfffffffe, v7
v_min_u32 v8, 0xfffffffe, v8
v_min_u32 v9, 0xfffffffe, v9
s_add_u32 s3, s51, 0
s_mul_i32 s3, s3, 224
s_add_u32 s3, s3, s2
s_mul_i32 s3, s3, 528
v_add_u32 v11, s3, v11
global_store_dwordx2 v11, v[8:9], s[28:29] offset:0 sc1
s_mov_b64 exec, 1
global_store_dwordx2 v11, v[6:7], s[28:29] offset:512 sc1
s_mov_b64 exec, -1
.L10:
s_nop 4
s_add_u32 s36, s36, 0x2000000
s_addc_u32 s37, s37, 0
s_add_u32 s40, s40, 0x2000000
s_addc_u32 s41, s41, 0
s_nop 7
s_mov_b32 s46, 0
buffer_load_dwordx4 v[144:147], v0, s[36:39], s46 offen nt
s_mov_b32 s46, 1024
buffer_load_dwordx4 v[148:151], v0, s[36:39], s46 offen nt
s_mov_b32 s46, 2048
buffer_load_dwordx4 v[152:155], v0, s[36:39], s46 offen nt
s_mov_b32 s46, 3072
buffer_load_dwordx4 v[156:159], v0, s[36:39], s46 offen nt
s_waitcnt vmcnt(4)
s_mov_b32 s46, 0
s_add_u32 s49, s48, 10240
s_mov_b32 m0, s49
s_nop 0
buffer_load_dwordx4 v0, s[40:43], s46 offen nt lds
s_waitcnt vmcnt(4)
s_mov_b32 s46, 1024
s_add_u32 s49, s48, 11264
s_mov_b32 m0, s49
s_nop 0
buffer_load_dwordx4 v0, s[40:43], s46 offen nt lds
s_waitcnt vmcnt(4)
s_mov_b32 s46, 2048
s_add_u32 s49, s48, 12288
s_mov_b32 m0, s49
s_nop 0
buffer_load_dwordx4 v0, s[40:43], s46 offen nt lds
s_waitcnt vmcnt(4)
s_mov_b32 s46, 3072
s_add_u32 s49, s48, 13312
s_mov_b32 m0, s49
s_nop 0
buffer_load_dwordx4 v0, s[40:43], s46 offen nt lds
s_nop 7
s_waitcnt vmcnt(4)
s_mov_b32 s46, 4096
buffer_load_dwordx4 v[160:163], v0, s[36:39], s46 offen nt
s_waitcnt vmcnt(4)
s_mov_b32 s46, 5120
buffer_load_dwordx4 v[164:167], v0, s[36:39], s46 offen nt
s_waitcnt vmcnt(4)
s_mov_b32 s46, 6144
buffer_load_dwordx4 v[168:171], v0, s[36:39], s46 offen nt
s_waitcnt vmcnt(4)
s_mov_b32 s46, 7168
buffer_load_dwordx4 v[172:175], v0, s[36:39], s46 offen nt
s_waitcnt vmcnt(4)
s_mov_b32 s46, 4096
s_add_u32 s49, s48, 14336
s_mov_b32 m0, s49
s_nop 0
buffer_load_dwordx4 v0, s[40:43], s46 offen nt lds
s_waitcnt vmcnt(4)
s_mov_b32 s46, 5120
s_add_u32 s49, s48, 15360
s_mov_b32 m0, s49
s_nop 0
buffer_load_dwordx4 v0, s[40:43], s46 offen nt lds
s_waitcnt vmcnt(4)
s_mov_b32 s46, 6144
s_add_u32 s49, s48, 16384
s_mov_b32 m0, s49
s_nop 0
buffer_load_dwordx4 v0, s[40:43], s46 offen nt lds
s_waitcnt vmcnt(4)
s_mov_b32 s46, 7168
s_add_u32 s49, s48, 17408
s_mov_b32 m0, s49
s_nop 0
buffer_load_dwordx4 v0, s[40:43], s46 offen nt lds
s_branch .L15
.L13:
s_nop 4
s_add_u32 s3, s52, 0
s_mul_i32 s3, s3, 57344
s_lshl_b32 s4, s2, 8
s_add_u32 s3, s3, s4
s_add_u32 s3, s3, 4194304
v_subrev_u32 v20, s48, v1
v_and_b32 v20, 0xf0, v20
v_add_u32 v20, s3, v20
global_load_dwordx4 v[2:5], v20, s[28:29] sc1
s_waitcnt vmcnt(0)
.L15:
s_nop 4
v_max3_u32 v17, v2, v3, v4
v_max_u32 v17, v17, v5
v_cmp_eq_u32 vcc, -1, v17
s_nop 0
s_cmp_eq_u64 vcc, 0
s_cbranch_scc1 .L14
s_sleep 2
s_add_u32 s47, s47, 1
s_cmp_lt_u32 s47, 262144
s_cbranch_scc1 .L13
s_endpgm
.L14:
s_nop 4
v_mov_b32 v6, 0xff800000
v_mov_b32 v7, 0
v_mov_b32 v8, 0
v_mov_b32 v9, 0
v_mov_b32 v10, 0
v_mov_b32 v11, 0
v_dot2_f32_bf16 v16, v144, v2, 0
v_dot2_f32_bf16 v17, v148, v2, 0
v_dot2_f32_bf16 v18, v152, v2, 0
v_dot2_f32_bf16 v19, v156, v2, 0
v_dot2_f32_bf16 v16, v145, v3, v16
v_dot2_f32_bf16 v17, v149, v3, v17
v_dot2_f32_bf16 v18, v153, v3, v18
v_dot2_f32_bf16 v19, v157, v3, v19
v_dot2_f32_bf16 v16, v146, v4, v16
v_dot2_f32_bf16 v17, v150, v4, v17
v_dot2_f32_bf16 v18, v154, v4, v18
v_dot2_f32_bf16 v19, v158, v4, v19
v_dot2_f32_bf16 v16, v147, v5, v16
v_dot2_f32_bf16 v17, v151, v5, v17
v_dot2_f32_bf16 v18, v155, v5, v18
v_dot2_f32_bf16 v19, v159, v5, v19
ds_read_b128 v[24:27], v1 offset:10240
ds_read_b128 v[28:31], v1 offset:11264
v_add_f32_dpp v16, v16, v16 row_ror:8 row_mask:0xf bank_mask:0xf
v_add_f32_dpp v17, v17, v17 row_ror:8 row_mask:0xf bank_mask:0xf
v_add_f32_dpp v18, v18, v18 row_ror:8 row_mask:0xf bank_mask:0xf
v_add_f32_dpp v19, v19, v19 row_ror:8 row_mask:0xf bank_mask:0xf
v_add_f32_dpp v16, v16, v16 row_ror:4 row_mask:0xf bank_mask:0xf
v_add_f32_dpp v17, v17, v17 row_ror:4 row_mask:0xf bank_mask:0xf
v_add_f32_dpp v18, v18, v18 row_ror:4 row_mask:0xf bank_mask:0xf
v_add_f32_dpp v19, v19, v19 row_ror:4 row_mask:0xf bank_mask:0xf
v_add_f32_dpp v16, v16, v16 row_ror:2 row_mask:0xf bank_mask:0xf
v_add_f32_dpp v17, v17, v17 row_ror:2 row_mask:0xf bank_mask:0xf
v_add_f32_dpp v18, v18, v18 row_ror:2 row_mask:0xf bank_mask:0xf
v_add_f32_dpp v19, v19, v19 row_ror:2 row_mask:0xf bank_mask:0xf
v_add_f32_dpp v16, v16, v16 row_ror:1 row_mask:0xf bank_mask:0xf
v_add_f32_dpp v17, v17, v17 row_ror:1 row_mask:0xf bank_mask:0xf
v_add_f32_dpp v18, v18, v18 row_ror:1 row_mask:0xf bank_mask:0xf
v_add_f32_dpp v19, v19, v19 row_ror:1 row_mask:0xf bank_mask:0xf
v_max3_f32 v20, v16, v17, v18
v_max3_f32 v20, v20, v19, v6
v_mov_b32 v21, v20
s_nop 1
v_permlane16_swap_b32 v20, v21
v_max_f32 v20, v20, v21
v_mov_b32 v21, v20
s_nop 1
v_permlane32_swap_b32 v20, v21
v_max_f32 v20, v20, v21
v_sub_f32 v21, v6, v20
v_mul_f32 v21, s44, v21
v_exp_f32 v21, v21
v_mul_f32 v22, s44, v20
v_mov_b32 v6, v20
v_fma_f32 v16, v16, s44, -v22
v_fma_f32 v17, v17, s44, -v22
v_fma_f32 v18, v18, s44, -v22
v_fma_f32 v19, v19, s44, -v22
v_exp_f32 v16, v16
v_exp_f32 v17, v17
v_exp_f32 v18, v18
v_exp_f32 v19, v19
v_mul_f32 v7, v7, v21
v_mul_f32 v8, v8, v21
v_mul_f32 v9, v9, v21
v_mul_f32 v10, v10, v21
v_mul_f32 v11, v11, v21
v_add_f32 v7, v7, v16
v_add_f32 v7, v7, v17
v_add_f32 v7, v7, v18
v_add_f32 v7, v7, v19
v_cvt_pk_bf16_f32 v16, v16, v16
v_cvt_pk_bf16_f32 v17, v17, v17
v_cvt_pk_bf16_f32 v18, v18, v18
v_cvt_pk_bf16_f32 v19, v19, v19
s_waitcnt lgkmcnt(0)
v_and_b32 v20, v12, v16
v_and_b32 v21, v13, v16
v_and_b32 v22, v14, v16
v_and_b32 v23, v15, v16
s_nop 1
v_mfma_f32_16x16x32_bf16 v[8:11], v[20:23], v[24:27], v[8:11]
s_nop 7
ds_read_b128 v[24:27], v1 offset:12288
s_waitcnt lgkmcnt(0)
v_and_b32 v20, v12, v17
v_and_b32 v21, v13, v17
v_and_b32 v22, v14, v17
v_and_b32 v23, v15, v17
s_nop 1
v_mfma_f32_16x16x32_bf16 v[8:11], v[20:23], v[28:31], v[8:11]
s_nop 7
ds_read_b128 v[28:31], v1 offset:13312
s_waitcnt lgkmcnt(0)
v_and_b32 v20, v12, v18
v_and_b32 v21, v13, v18
v_and_b32 v22, v14, v18
v_and_b32 v23, v15, v18
s_nop 1
v_mfma_f32_16x16x32_bf16 v[8:11], v[20:23], v[24:27], v[8:11]
s_waitcnt lgkmcnt(0)
v_and_b32 v20, v12, v19
v_and_b32 v21, v13, v19
v_and_b32 v22, v14, v19
v_and_b32 v23, v15, v19
s_nop 1
v_mfma_f32_16x16x32_bf16 v[8:11], v[20:23], v[28:31], v[8:11]
s_nop 7
s_waitcnt vmcnt(4)
s_mov_b32 s46, 8192
buffer_load_dwordx4 v[176:179], v0, s[36:39], s46 offen nt
s_waitcnt vmcnt(4)
s_mov_b32 s46, 9216
buffer_load_dwordx4 v[180:183], v0, s[36:39], s46 offen nt
s_waitcnt vmcnt(4)
s_mov_b32 s46, 10240
buffer_load_dwordx4 v[184:187], v0, s[36:39], s46 offen nt
s_waitcnt vmcnt(4)
s_mov_b32 s46, 11264
buffer_load_dwordx4 v[188:191], v0, s[36:39], s46 offen nt
s_waitcnt vmcnt(4)
s_mov_b32 s46, 8192
s_add_u32 s49, s48, 18432
s_mov_b32 m0, s49
s_nop 0
buffer_load_dwordx4 v0, s[40:43], s46 offen nt lds
s_waitcnt vmcnt(4)
s_mov_b32 s46, 9216
s_add_u32 s49, s48, 19456
s_mov_b32 m0, s49
s_nop 0
buffer_load_dwordx4 v0, s[40:43], s46 offen nt lds
s_waitcnt vmcnt(4)
s_mov_b32 s46, 10240
buffer_load_dwordx4 v[220:223], v0, s[40:43], s46 offen nt
s_waitcnt vmcnt(4)
s_mov_b32 s46, 11264
buffer_load_dwordx4 v[224:227], v0, s[40:43], s46 offen nt
v_dot2_f32_bf16 v16, v160, v2, 0
v_dot2_f32_bf16 v17, v164, v2, 0
v_dot2_f32_bf16 v18, v168, v2, 0
v_dot2_f32_bf16 v19, v172, v2, 0
v_dot2_f32_bf16 v16, v161, v3, v16
v_dot2_f32_bf16 v17, v165, v3, v17
v_dot2_f32_bf16 v18, v169, v3, v18
v_dot2_f32_bf16 v19, v173, v3, v19
v_dot2_f32_bf16 v16, v162, v4, v16
v_dot2_f32_bf16 v17, v166, v4, v17
v_dot2_f32_bf16 v18, v170, v4, v18
v_dot2_f32_bf16 v19, v174, v4, v19
v_dot2_f32_bf16 v16, v163, v5, v16
v_dot2_f32_bf16 v17, v167, v5, v17
v_dot2_f32_bf16 v18, v171, v5, v18
v_dot2_f32_bf16 v19, v175, v5, v19
ds_read_b128 v[24:27], v1 offset:14336
ds_read_b128 v[28:31], v1 offset:15360
v_add_f32_dpp v16, v16, v16 row_ror:8 row_mask:0xf bank_mask:0xf
v_add_f32_dpp v17, v17, v17 row_ror:8 row_mask:0xf bank_mask:0xf
v_add_f32_dpp v18, v18, v18 row_ror:8 row_mask:0xf bank_mask:0xf
v_add_f32_dpp v19, v19, v19 row_ror:8 row_mask:0xf bank_mask:0xf
v_add_f32_dpp v16, v16, v16 row_ror:4 row_mask:0xf bank_mask:0xf
v_add_f32_dpp v17, v17, v17 row_ror:4 row_mask:0xf bank_mask:0xf
v_add_f32_dpp v18, v18, v18 row_ror:4 row_mask:0xf bank_mask:0xf
v_add_f32_dpp v19, v19, v19 row_ror:4 row_mask:0xf bank_mask:0xf
v_add_f32_dpp v16, v16, v16 row_ror:2 row_mask:0xf bank_mask:0xf
v_add_f32_dpp v17, v17, v17 row_ror:2 row_mask:0xf bank_mask:0xf
v_add_f32_dpp v18, v18, v18 row_ror:2 row_mask:0xf bank_mask:0xf
v_add_f32_dpp v19, v19, v19 row_ror:2 row_mask:0xf bank_mask:0xf
v_add_f32_dpp v16, v16, v16 row_ror:1 row_mask:0xf bank_mask:0xf
v_add_f32_dpp v17, v17, v17 row_ror:1 row_mask:0xf bank_mask:0xf
v_add_f32_dpp v18, v18, v18 row_ror:1 row_mask:0xf bank_mask:0xf
v_add_f32_dpp v19, v19, v19 row_ror:1 row_mask:0xf bank_mask:0xf
v_max3_f32 v20, v16, v17, v18
v_max3_f32 v20, v20, v19, v6
v_mov_b32 v21, v20
s_nop 1
v_permlane16_swap_b32 v20, v21
v_max_f32 v20, v20, v21
v_mov_b32 v21, v20
s_nop 1
v_permlane32_swap_b32 v20, v21
v_max_f32 v20, v20, v21
v_sub_f32 v21, v6, v20
v_mul_f32 v21, s44, v21
v_exp_f32 v21, v21
v_mul_f32 v22, s44, v20
v_mov_b32 v6, v20
v_fma_f32 v16, v16, s44, -v22
v_fma_f32 v17, v17, s44, -v22
v_fma_f32 v18, v18, s44, -v22
v_fma_f32 v19, v19, s44, -v22
v_exp_f32 v16, v16
v_exp_f32 v17, v17
v_exp_f32 v18, v18
v_exp_f32 v19, v19
v_mul_f32 v7, v7, v21
v_mul_f32 v8, v8, v21
v_mul_f32 v9, v9, v21
v_mul_f32 v10, v10, v21
v_mul_f32 v11, v11, v21
v_add_f32 v7, v7, v16
v_add_f32 v7, v7, v17
v_add_f32 v7, v7, v18
v_add_f32 v7, v7, v19
v_cvt_pk_bf16_f32 v16, v16, v16
v_cvt_pk_bf16_f32 v17, v17, v17
v_cvt_pk_bf16_f32 v18, v18, v18
v_cvt_pk_bf16_f32 v19, v19, v19
s_waitcnt lgkmcnt(0)
v_and_b32 v20, v12, v16
v_and_b32 v21, v13, v16
v_and_b32 v22, v14, v16
v_and_b32 v23, v15, v16
s_nop 1
v_mfma_f32_16x16x32_bf16 v[8:11], v[20:23], v[24:27], v[8:11]
s_nop 7
ds_read_b128 v[24:27], v1 offset:16384
s_waitcnt lgkmcnt(0)
v_and_b32 v20, v12, v17
v_and_b32 v21, v13, v17
v_and_b32 v22, v14, v17
v_and_b32 v23, v15, v17
s_nop 1
v_mfma_f32_16x16x32_bf16 v[8:11], v[20:23], v[28:31], v[8:11]
s_nop 7
ds_read_b128 v[28:31], v1 offset:17408
s_waitcnt lgkmcnt(0)
v_and_b32 v20, v12, v18
v_and_b32 v21, v13, v18
v_and_b32 v22, v14, v18
v_and_b32 v23, v15, v18
s_nop 1
v_mfma_f32_16x16x32_bf16 v[8:11], v[20:23], v[24:27], v[8:11]
s_waitcnt lgkmcnt(0)
v_and_b32 v20, v12, v19
v_and_b32 v21, v13, v19
v_and_b32 v22, v14, v19
v_and_b32 v23, v15, v19
s_nop 1
v_mfma_f32_16x16x32_bf16 v[8:11], v[20:23], v[28:31], v[8:11]
s_nop 7
s_waitcnt vmcnt(4)
s_mov_b32 s46, 12288
buffer_load_dwordx4 v[192:195], v0, s[36:39], s46 offen nt
s_waitcnt vmcnt(4)
s_mov_b32 s46, 13312
buffer_load_dwordx4 v[196:199], v0, s[36:39], s46 offen nt
s_waitcnt vmcnt(4)
s_mov_b32 s46, 14336
buffer_load_dwordx4 v[200:203], v0, s[36:39], s46 offen nt
s_waitcnt vmcnt(4)
s_mov_b32 s46, 15360
buffer_load_dwordx4 v[204:207], v0, s[36:39], s46 offen nt
s_waitcnt vmcnt(4)
s_mov_b32 s46, 12288
buffer_load_dwordx4 v[228:231], v0, s[40:43], s46 offen nt
s_waitcnt vmcnt(4)
s_mov_b32 s46, 13312
buffer_load_dwordx4 v[232:235], v0, s[40:43], s46 offen nt
s_waitcnt vmcnt(4)
s_mov_b32 s46, 14336
buffer_load_dwordx4 v[236:239], v0, s[40:43], s46 offen nt
s_waitcnt vmcnt(4)
s_mov_b32 s46, 15360
buffer_load_dwordx4 v[240:243], v0, s[40:43], s46 offen nt
v_dot2_f32_bf16 v16, v176, v2, 0
v_dot2_f32_bf16 v17, v180, v2, 0
v_dot2_f32_bf16 v18, v184, v2, 0
v_dot2_f32_bf16 v19, v188, v2, 0
v_dot2_f32_bf16 v16, v177, v3, v16
v_dot2_f32_bf16 v17, v181, v3, v17
v_dot2_f32_bf16 v18, v185, v3, v18
v_dot2_f32_bf16 v19, v189, v3, v19
v_dot2_f32_bf16 v16, v178, v4, v16
v_dot2_f32_bf16 v17, v182, v4, v17
v_dot2_f32_bf16 v18, v186, v4, v18
v_dot2_f32_bf16 v19, v190, v4, v19
v_dot2_f32_bf16 v16, v179, v5, v16
v_dot2_f32_bf16 v17, v183, v5, v17
v_dot2_f32_bf16 v18, v187, v5, v18
v_dot2_f32_bf16 v19, v191, v5, v19
ds_read_b128 v[24:27], v1 offset:18432
ds_read_b128 v[28:31], v1 offset:19456
v_add_f32_dpp v16, v16, v16 row_ror:8 row_mask:0xf bank_mask:0xf
v_add_f32_dpp v17, v17, v17 row_ror:8 row_mask:0xf bank_mask:0xf
v_add_f32_dpp v18, v18, v18 row_ror:8 row_mask:0xf bank_mask:0xf
v_add_f32_dpp v19, v19, v19 row_ror:8 row_mask:0xf bank_mask:0xf
v_add_f32_dpp v16, v16, v16 row_ror:4 row_mask:0xf bank_mask:0xf
v_add_f32_dpp v17, v17, v17 row_ror:4 row_mask:0xf bank_mask:0xf
v_add_f32_dpp v18, v18, v18 row_ror:4 row_mask:0xf bank_mask:0xf
v_add_f32_dpp v19, v19, v19 row_ror:4 row_mask:0xf bank_mask:0xf
v_add_f32_dpp v16, v16, v16 row_ror:2 row_mask:0xf bank_mask:0xf
v_add_f32_dpp v17, v17, v17 row_ror:2 row_mask:0xf bank_mask:0xf
v_add_f32_dpp v18, v18, v18 row_ror:2 row_mask:0xf bank_mask:0xf
v_add_f32_dpp v19, v19, v19 row_ror:2 row_mask:0xf bank_mask:0xf
v_add_f32_dpp v16, v16, v16 row_ror:1 row_mask:0xf bank_mask:0xf
v_add_f32_dpp v17, v17, v17 row_ror:1 row_mask:0xf bank_mask:0xf
v_add_f32_dpp v18, v18, v18 row_ror:1 row_mask:0xf bank_mask:0xf
v_add_f32_dpp v19, v19, v19 row_ror:1 row_mask:0xf bank_mask:0xf
v_max3_f32 v20, v16, v17, v18
v_max3_f32 v20, v20, v19, v6
v_mov_b32 v21, v20
s_nop 1
v_permlane16_swap_b32 v20, v21
v_max_f32 v20, v20, v21
v_mov_b32 v21, v20
s_nop 1
v_permlane32_swap_b32 v20, v21
v_max_f32 v20, v20, v21
v_sub_f32 v21, v6, v20
v_mul_f32 v21, s44, v21
v_exp_f32 v21, v21
v_mul_f32 v22, s44, v20
v_mov_b32 v6, v20
v_fma_f32 v16, v16, s44, -v22
v_fma_f32 v17, v17, s44, -v22
v_fma_f32 v18, v18, s44, -v22
v_fma_f32 v19, v19, s44, -v22
v_exp_f32 v16, v16
v_exp_f32 v17, v17
v_exp_f32 v18, v18
v_exp_f32 v19, v19
v_mul_f32 v7, v7, v21
v_mul_f32 v8, v8, v21
v_mul_f32 v9, v9, v21
v_mul_f32 v10, v10, v21
v_mul_f32 v11, v11, v21
v_add_f32 v7, v7, v16
v_add_f32 v7, v7, v17
v_add_f32 v7, v7, v18
v_add_f32 v7, v7, v19
v_cvt_pk_bf16_f32 v16, v16, v16
v_cvt_pk_bf16_f32 v17, v17, v17
v_cvt_pk_bf16_f32 v18, v18, v18
v_cvt_pk_bf16_f32 v19, v19, v19
s_waitcnt lgkmcnt(0)
v_and_b32 v20, v12, v16
v_and_b32 v21, v13, v16
v_and_b32 v22, v14, v16
v_and_b32 v23, v15, v16
s_nop 1
v_mfma_f32_16x16x32_bf16 v[8:11], v[20:23], v[24:27], v[8:11]
s_waitcnt lgkmcnt(0)
v_and_b32 v20, v12, v17
v_and_b32 v21, v13, v17
v_and_b32 v22, v14, v17
v_and_b32 v23, v15, v17
s_nop 1
v_mfma_f32_16x16x32_bf16 v[8:11], v[20:23], v[28:31], v[8:11]
v_and_b32 v20, v12, v18
v_and_b32 v21, v13, v18
v_and_b32 v22, v14, v18
v_and_b32 v23, v15, v18
s_nop 1
v_mfma_f32_16x16x32_bf16 v[8:11], v[20:23], v[220:223], v[8:11]
v_and_b32 v20, v12, v19
v_and_b32 v21, v13, v19
v_and_b32 v22, v14, v19
v_and_b32 v23, v15, v19
s_nop 1
v_mfma_f32_16x16x32_bf16 v[8:11], v[20:23], v[224:227], v[8:11]
s_nop 7
s_waitcnt vmcnt(4)
s_mov_b32 s46, 16384
buffer_load_dwordx4 v[208:211], v0, s[36:39], s46 offen nt
s_waitcnt vmcnt(4)
s_mov_b32 s46, 17408
buffer_load_dwordx4 v[212:215], v0, s[36:39], s46 offen nt
s_waitcnt vmcnt(4)
s_mov_b32 s46, 18432
buffer_load_dwordx4 v[216:219], v0, s[36:39], s46 offen nt
s_waitcnt vmcnt(4)
s_mov_b32 s46, 16384
buffer_load_dwordx4 v[244:247], v0, s[40:43], s46 offen nt
s_waitcnt vmcnt(4)
s_mov_b32 s46, 17408
buffer_load_dwordx4 v[248:251], v0, s[40:43], s46 offen nt
s_waitcnt vmcnt(4)
s_mov_b32 s46, 18432
buffer_load_dwordx4 v[252:255], v0, s[40:43], s46 offen nt
v_dot2_f32_bf16 v16, v192, v2, 0
v_dot2_f32_bf16 v17, v196, v2, 0
v_dot2_f32_bf16 v18, v200, v2, 0
v_dot2_f32_bf16 v19, v204, v2, 0
v_dot2_f32_bf16 v16, v193, v3, v16
v_dot2_f32_bf16 v17, v197, v3, v17
v_dot2_f32_bf16 v18, v201, v3, v18
v_dot2_f32_bf16 v19, v205, v3, v19
v_dot2_f32_bf16 v16, v194, v4, v16
v_dot2_f32_bf16 v17, v198, v4, v17
v_dot2_f32_bf16 v18, v202, v4, v18
v_dot2_f32_bf16 v19, v206, v4, v19
v_dot2_f32_bf16 v16, v195, v5, v16
v_dot2_f32_bf16 v17, v199, v5, v17
v_dot2_f32_bf16 v18, v203, v5, v18
v_dot2_f32_bf16 v19, v207, v5, v19
v_add_f32_dpp v16, v16, v16 row_ror:8 row_mask:0xf bank_mask:0xf
v_add_f32_dpp v17, v17, v17 row_ror:8 row_mask:0xf bank_mask:0xf
v_add_f32_dpp v18, v18, v18 row_ror:8 row_mask:0xf bank_mask:0xf
v_add_f32_dpp v19, v19, v19 row_ror:8 row_mask:0xf bank_mask:0xf
v_add_f32_dpp v16, v16, v16 row_ror:4 row_mask:0xf bank_mask:0xf
v_add_f32_dpp v17, v17, v17 row_ror:4 row_mask:0xf bank_mask:0xf
v_add_f32_dpp v18, v18, v18 row_ror:4 row_mask:0xf bank_mask:0xf
v_add_f32_dpp v19, v19, v19 row_ror:4 row_mask:0xf bank_mask:0xf
v_add_f32_dpp v16, v16, v16 row_ror:2 row_mask:0xf bank_mask:0xf
v_add_f32_dpp v17, v17, v17 row_ror:2 row_mask:0xf bank_mask:0xf
v_add_f32_dpp v18, v18, v18 row_ror:2 row_mask:0xf bank_mask:0xf
v_add_f32_dpp v19, v19, v19 row_ror:2 row_mask:0xf bank_mask:0xf
v_add_f32_dpp v16, v16, v16 row_ror:1 row_mask:0xf bank_mask:0xf
v_add_f32_dpp v17, v17, v17 row_ror:1 row_mask:0xf bank_mask:0xf
v_add_f32_dpp v18, v18, v18 row_ror:1 row_mask:0xf bank_mask:0xf
v_add_f32_dpp v19, v19, v19 row_ror:1 row_mask:0xf bank_mask:0xf
v_max3_f32 v20, v16, v17, v18
v_max3_f32 v20, v20, v19, v6
v_mov_b32 v21, v20
s_nop 1
v_permlane16_swap_b32 v20, v21
v_max_f32 v20, v20, v21
v_mov_b32 v21, v20
s_nop 1
v_permlane32_swap_b32 v20, v21
v_max_f32 v20, v20, v21
v_sub_f32 v21, v6, v20
v_mul_f32 v21, s44, v21
v_exp_f32 v21, v21
v_mul_f32 v22, s44, v20
v_mov_b32 v6, v20
v_fma_f32 v16, v16, s44, -v22
v_fma_f32 v17, v17, s44, -v22
v_fma_f32 v18, v18, s44, -v22
v_fma_f32 v19, v19, s44, -v22
v_exp_f32 v16, v16
v_exp_f32 v17, v17
v_exp_f32 v18, v18
v_exp_f32 v19, v19
v_mul_f32 v7, v7, v21
v_mul_f32 v8, v8, v21
v_mul_f32 v9, v9, v21
v_mul_f32 v10, v10, v21
v_mul_f32 v11, v11, v21
v_add_f32 v7, v7, v16
v_add_f32 v7, v7, v17
v_add_f32 v7, v7, v18
v_add_f32 v7, v7, v19
v_cvt_pk_bf16_f32 v16, v16, v16
v_cvt_pk_bf16_f32 v17, v17, v17
v_cvt_pk_bf16_f32 v18, v18, v18
v_cvt_pk_bf16_f32 v19, v19, v19
v_and_b32 v20, v12, v16
v_and_b32 v21, v13, v16
v_and_b32 v22, v14, v16
v_and_b32 v23, v15, v16
s_nop 1
v_mfma_f32_16x16x32_bf16 v[8:11], v[20:23], v[228:231], v[8:11]
v_and_b32 v20, v12, v17
v_and_b32 v21, v13, v17
v_and_b32 v22, v14, v17
v_and_b32 v23, v15, v17
s_nop 1
v_mfma_f32_16x16x32_bf16 v[8:11], v[20:23], v[232:235], v[8:11]
v_and_b32 v20, v12, v18
v_and_b32 v21, v13, v18
v_and_b32 v22, v14, v18
v_and_b32 v23, v15, v18
s_nop 1
v_mfma_f32_16x16x32_bf16 v[8:11], v[20:23], v[236:239], v[8:11]
v_and_b32 v20, v12, v19
v_and_b32 v21, v13, v19
v_and_b32 v22, v14, v19
v_and_b32 v23, v15, v19
s_nop 1
v_mfma_f32_16x16x32_bf16 v[8:11], v[20:23], v[240:243], v[8:11]
s_waitcnt vmcnt(3)
v_dot2_f32_bf16 v16, v208, v2, 0
v_dot2_f32_bf16 v17, v212, v2, 0
v_dot2_f32_bf16 v18, v216, v2, 0
v_dot2_f32_bf16 v16, v209, v3, v16
v_dot2_f32_bf16 v17, v213, v3, v17
v_dot2_f32_bf16 v18, v217, v3, v18
v_dot2_f32_bf16 v16, v210, v4, v16
v_dot2_f32_bf16 v17, v214, v4, v17
v_dot2_f32_bf16 v18, v218, v4, v18
v_dot2_f32_bf16 v16, v211, v5, v16
v_dot2_f32_bf16 v17, v215, v5, v17
v_dot2_f32_bf16 v18, v219, v5, v18
s_add_u32 s3, s51, 8
s_mul_i32 s3, s3, 57344
s_lshl_b32 s4, s2, 8
s_add_u32 s3, s3, s4
s_add_u32 s3, s3, 4194304
v_subrev_u32 v20, s48, v1
v_and_b32 v20, 0xf0, v20
v_add_u32 v20, s3, v20
global_load_dwordx4 v[2:5], v20, s[28:29] sc1
s_waitcnt vmcnt(1)
v_add_f32_dpp v16, v16, v16 row_ror:8 row_mask:0xf bank_mask:0xf
v_add_f32_dpp v17, v17, v17 row_ror:8 row_mask:0xf bank_mask:0xf
v_add_f32_dpp v18, v18, v18 row_ror:8 row_mask:0xf bank_mask:0xf
v_add_f32_dpp v16, v16, v16 row_ror:4 row_mask:0xf bank_mask:0xf
v_add_f32_dpp v17, v17, v17 row_ror:4 row_mask:0xf bank_mask:0xf
v_add_f32_dpp v18, v18, v18 row_ror:4 row_mask:0xf bank_mask:0xf
v_add_f32_dpp v16, v16, v16 row_ror:2 row_mask:0xf bank_mask:0xf
v_add_f32_dpp v17, v17, v17 row_ror:2 row_mask:0xf bank_mask:0xf
v_add_f32_dpp v18, v18, v18 row_ror:2 row_mask:0xf bank_mask:0xf
v_add_f32_dpp v16, v16, v16 row_ror:1 row_mask:0xf bank_mask:0xf
v_add_f32_dpp v17, v17, v17 row_ror:1 row_mask:0xf bank_mask:0xf
v_add_f32_dpp v18, v18, v18 row_ror:1 row_mask:0xf bank_mask:0xf
v_max3_f32 v20, v16, v17, v18
v_max_f32 v20, v20, v6
v_mov_b32 v21, v20
s_nop 1
v_permlane16_swap_b32 v20, v21
v_max_f32 v20, v20, v21
v_mov_b32 v21, v20
s_nop 1
v_permlane32_swap_b32 v20, v21
v_max_f32 v20, v20, v21
v_sub_f32 v21, v6, v20
v_mul_f32 v21, s44, v21
v_exp_f32 v21, v21
v_mul_f32 v22, s44, v20
v_mov_b32 v6, v20
v_fma_f32 v16, v16, s44, -v22
v_fma_f32 v17, v17, s44, -v22
v_fma_f32 v18, v18, s44, -v22
v_exp_f32 v16, v16
v_exp_f32 v17, v17
v_exp_f32 v18, v18
v_mul_f32 v7, v7, v21
v_mul_f32 v8, v8, v21
v_mul_f32 v9, v9, v21
v_mul_f32 v10, v10, v21
v_mul_f32 v11, v11, v21
v_add_f32 v7, v7, v16
v_add_f32 v7, v7, v17
v_add_f32 v7, v7, v18
v_cvt_pk_bf16_f32 v16, v16, v16
v_cvt_pk_bf16_f32 v17, v17, v17
v_cvt_pk_bf16_f32 v18, v18, v18
v_and_b32 v20, v12, v16
v_and_b32 v21, v13, v16
v_and_b32 v22, v14, v16
v_and_b32 v23, v15, v16
s_nop 1
v_mfma_f32_16x16x32_bf16 v[8:11], v[20:23], v[244:247], v[8:11]
v_and_b32 v20, v12, v17
v_and_b32 v21, v13, v17
v_and_b32 v22, v14, v17
v_and_b32 v23, v15, v17
s_nop 1
v_mfma_f32_16x16x32_bf16 v[8:11], v[20:23], v[248:251], v[8:11]
v_and_b32 v20, v12, v18
v_and_b32 v21, v13, v18
v_and_b32 v22, v14, v18
v_and_b32 v23, v15, v18
s_nop 1
v_mfma_f32_16x16x32_bf16 v[8:11], v[20:23], v[252:255], v[8:11]
v_mul_f32 v6, s44, v6
v_mov_b32 v16, v7
s_nop 1
v_permlane16_swap_b32 v7, v16
v_add_f32 v7, v7, v16
v_mov_b32 v16, v7
s_nop 1
v_permlane32_swap_b32 v7, v16
v_add_f32 v7, v7, v16
v_subrev_u32 v16, s48, v1
v_and_b32 v17, 0xf0, v16
v_lshlrev_b32 v17, 1, v17
v_lshrrev_b32 v18, 8, v16
v_lshl_add_u32 v17, v18, 4, v17
s_mul_i32 s3, s30, 528
s_add_u32 s3, s3, 147584
v_add_u32 v17, s3, v17
s_mov_b32 exec_hi, 0
ds_write_b128 v17, v[8:11]
s_mov_b64 exec, 1
ds_write_b64 v17, v[6:7] offset:512
s_waitcnt lgkmcnt(0)
v_mov_b32 v18, 160260
v_mov_b32 v19, 1
ds_add_rtn_u32 v20, v18, v19
s_waitcnt lgkmcnt(0)
s_mov_b64 exec, -1
v_readfirstlane_b32 s3, v20
s_nop 0
s_and_b32 s3, s3, 7
s_cmp_lg_u32 s3, 7
s_cbranch_scc1 .L19
v_mov_b32 v10, 148096
ds_read_b64 v[16:17], v10 offset:0
ds_read_b64 v[18:19], v10 offset:528
ds_read_b64 v[20:21], v10 offset:1056
ds_read_b64 v[22:23], v10 offset:1584
ds_read_b64 v[24:25], v10 offset:2112
ds_read_b64 v[26:27], v10 offset:2640
ds_read_b64 v[28:29], v10 offset:3168
ds_read_b64 v[30:31], v10 offset:3696
v_subrev_u32 v11, s48, v1
v_lshrrev_b32 v11, 1, v11
v_add_u32 v10, 147584, v11
s_waitcnt lgkmcnt(0)
v_max3_f32 v6, v16, v18, v20
v_max3_f32 v6, v6, v22, v24
v_max3_f32 v6, v6, v26, v28
v_max_f32 v6, v6, v30
v_mov_b32 v7, 0
v_mov_b32 v8, 0
v_mov_b32 v9, 0
v_sub_f32 v16, v16, v6
v_exp_f32 v16, v16
v_sub_f32 v18, v18, v6
v_exp_f32 v18, v18
v_sub_f32 v20, v20, v6
v_exp_f32 v20, v20
v_sub_f32 v22, v22, v6
v_exp_f32 v22, v22
v_sub_f32 v24, v24, v6
v_exp_f32 v24, v24
v_sub_f32 v26, v26, v6
v_exp_f32 v26, v26
v_sub_f32 v28, v28, v6
v_exp_f32 v28, v28
v_sub_f32 v30, v30, v6
v_exp_f32 v30, v30
v_fmac_f32 v7, v16, v17
v_fmac_f32 v7, v18, v19
v_fmac_f32 v7, v20, v21
v_fmac_f32 v7, v22, v23
v_fmac_f32 v7, v24, v25
v_fmac_f32 v7, v26, v27
v_fmac_f32 v7, v28, v29
v_fmac_f32 v7, v30, v31
v_mov_b32 v17, v18
v_mov_b32 v18, v20
v_mov_b32 v19, v22
v_mov_b32 v20, v24
v_mov_b32 v21, v26
v_mov_b32 v22, v28
v_mov_b32 v23, v30
ds_read_b64 v[24:25], v10 offset:0
ds_read_b64 v[26:27], v10 offset:528
ds_read_b64 v[28:29], v10 offset:1056
ds_read_b64 v[30:31], v10 offset:1584
s_waitcnt lgkmcnt(0)
v_fmac_f32 v8, v16, v24
v_fmac_f32 v9, v16, v25
v_fmac_f32 v8, v17, v26
v_fmac_f32 v9, v17, v27
v_fmac_f32 v8, v18, v28
v_fmac_f32 v9, v18, v29
v_fmac_f32 v8, v19, v30
v_fmac_f32 v9, v19, v31
ds_read_b64 v[24:25], v10 offset:2112
ds_read_b64 v[26:27], v10 offset:2640
ds_read_b64 v[28:29], v10 offset:3168
ds_read_b64 v[30:31], v10 offset:3696
s_waitcnt lgkmcnt(0)
v_fmac_f32 v8, v20, v24
v_fmac_f32 v9, v20, v25
v_fmac_f32 v8, v21, v26
v_fmac_f32 v9, v21, v27
v_fmac_f32 v8, v22, v28
v_fmac_f32 v9, v22, v29
v_fmac_f32 v8, v23, v30
v_fmac_f32 v9, v23, v31
v_min_u32 v6, 0xfffffffe, v6
v_min_u32 v7, 0xfffffffe, v7
v_min_u32 v8, 0xfffffffe, v8
v_min_u32 v9, 0xfffffffe, v9
s_add_u32 s3, s52, 0
s_mul_i32 s3, s3, 224
s_add_u32 s3, s3, s2
s_mul_i32 s3, s3, 528
v_add_u32 v11, s3, v11
global_store_dwordx2 v11, v[8:9], s[28:29] offset:0 sc1
s_mov_b64 exec, 1
global_store_dwordx2 v11, v[6:7], s[28:29] offset:512 sc1
s_mov_b64 exec, -1
.L19:
s_nop 4
s_add_u32 s36, s36, 0x2000000
s_addc_u32 s37, s37, 0
s_add_u32 s40, s40, 0x2000000
s_addc_u32 s41, s41, 0
L_loop_a:
s_nop 4
s_cmp_ge_u32 s51, 6
s_cselect_b32 s54, 1, 0
s_add_u32 s52, s51, 2
s_add_u32 s53, s51, 1
s_waitcnt vmcnt(0)
s_branch .L22
.L20:
s_nop 4
s_add_u32 s3, s51, 8
s_mul_i32 s3, s3, 57344
s_lshl_b32 s4, s2, 8
s_add_u32 s3, s3, s4
s_add_u32 s3, s3, 4194304
v_subrev_u32 v20, s48, v1
v_and_b32 v20, 0xf0, v20
v_add_u32 v20, s3, v20
global_load_dwordx4 v[2:5], v20, s[28:29] sc1
s_waitcnt vmcnt(0)
.L22:
s_nop 4
v_max3_u32 v17, v2, v3, v4
v_max_u32 v17, v17, v5
v_cmp_eq_u32 vcc, -1, v17
s_nop 0
s_cmp_eq_u64 vcc, 0
s_cbranch_scc1 .L21
s_sleep 2
s_add_u32 s47, s47, 1
s_cmp_lt_u32 s47, 262144
s_cbranch_scc1 .L20
s_endpgm
.L21:
s_nop 4
v_mov_b32 v6, 0xff800000
v_mov_b32 v7, 0
v_mov_b32 v8, 0
v_mov_b32 v9, 0
v_mov_b32 v10, 0
v_mov_b32 v11, 0
v_dot2_f32_bf16 v16, v32, v2, 0
v_dot2_f32_bf16 v17, v36, v2, 0
v_dot2_f32_bf16 v18, v40, v2, 0
v_dot2_f32_bf16 v19, v44, v2, 0
v_dot2_f32_bf16 v16, v33, v3, v16
v_dot2_f32_bf16 v17, v37, v3, v17
v_dot2_f32_bf16 v18, v41, v3, v18
v_dot2_f32_bf16 v19, v45, v3, v19
v_dot2_f32_bf16 v16, v34, v4, v16
v_dot2_f32_bf16 v17, v38, v4, v17
v_dot2_f32_bf16 v18, v42, v4, v18
v_dot2_f32_bf16 v19, v46, v4, v19
v_dot2_f32_bf16 v16, v35, v5, v16
v_dot2_f32_bf16 v17, v39, v5, v17
v_dot2_f32_bf16 v18, v43, v5, v18
v_dot2_f32_bf16 v19, v47, v5, v19
ds_read_b128 v[24:27], v1 offset:0
ds_read_b128 v[28:31], v1 offset:1024
v_add_f32_dpp v16, v16, v16 row_ror:8 row_mask:0xf bank_mask:0xf
v_add_f32_dpp v17, v17, v17 row_ror:8 row_mask:0xf bank_mask:0xf
v_add_f32_dpp v18, v18, v18 row_ror:8 row_mask:0xf bank_mask:0xf
v_add_f32_dpp v19, v19, v19 row_ror:8 row_mask:0xf bank_mask:0xf
v_add_f32_dpp v16, v16, v16 row_ror:4 row_mask:0xf bank_mask:0xf
v_add_f32_dpp v17, v17, v17 row_ror:4 row_mask:0xf bank_mask:0xf
v_add_f32_dpp v18, v18, v18 row_ror:4 row_mask:0xf bank_mask:0xf
v_add_f32_dpp v19, v19, v19 row_ror:4 row_mask:0xf bank_mask:0xf
v_add_f32_dpp v16, v16, v16 row_ror:2 row_mask:0xf bank_mask:0xf
v_add_f32_dpp v17, v17, v17 row_ror:2 row_mask:0xf bank_mask:0xf
v_add_f32_dpp v18, v18, v18 row_ror:2 row_mask:0xf bank_mask:0xf
v_add_f32_dpp v19, v19, v19 row_ror:2 row_mask:0xf bank_mask:0xf
v_add_f32_dpp v16, v16, v16 row_ror:1 row_mask:0xf bank_mask:0xf
v_add_f32_dpp v17, v17, v17 row_ror:1 row_mask:0xf bank_mask:0xf
v_add_f32_dpp v18, v18, v18 row_ror:1 row_mask:0xf bank_mask:0xf
v_add_f32_dpp v19, v19, v19 row_ror:1 row_mask:0xf bank_mask:0xf
v_max3_f32 v20, v16, v17, v18
v_max3_f32 v20, v20, v19, v6
v_mov_b32 v21, v20
s_nop 1
v_permlane16_swap_b32 v20, v21
v_max_f32 v20, v20, v21
v_mov_b32 v21, v20
s_nop 1
v_permlane32_swap_b32 v20, v21
v_max_f32 v20, v20, v21
v_sub_f32 v21, v6, v20
v_mul_f32 v21, s44, v21
v_exp_f32 v21, v21
v_mul_f32 v22, s44, v20
v_mov_b32 v6, v20
v_fma_f32 v16, v16, s44, -v22
v_fma_f32 v17, v17, s44, -v22
v_fma_f32 v18, v18, s44, -v22
v_fma_f32 v19, v19, s44, -v22
v_exp_f32 v16, v16
v_exp_f32 v17, v17
v_exp_f32 v18, v18
v_exp_f32 v19, v19
v_mul_f32 v7, v7, v21
v_mul_f32 v8, v8, v21
v_mul_f32 v9, v9, v21
v_mul_f32 v10, v10, v21
v_mul_f32 v11, v11, v21
v_add_f32 v7, v7, v16
v_add_f32 v7, v7, v17
v_add_f32 v7, v7, v18
v_add_f32 v7, v7, v19
v_cvt_pk_bf16_f32 v16, v16, v16
v_cvt_pk_bf16_f32 v17, v17, v17
v_cvt_pk_bf16_f32 v18, v18, v18
v_cvt_pk_bf16_f32 v19, v19, v19
s_waitcnt lgkmcnt(0)
v_and_b32 v20, v12, v16
v_and_b32 v21, v13, v16
v_and_b32 v22, v14, v16
v_and_b32 v23, v15, v16
s_nop 1
v_mfma_f32_16x16x32_bf16 v[8:11], v[20:23], v[24:27], v[8:11]
s_nop 7
ds_read_b128 v[24:27], v1 offset:2048
s_waitcnt lgkmcnt(0)
v_and_b32 v20, v12, v17
v_and_b32 v21, v13, v17
v_and_b32 v22, v14, v17
v_and_b32 v23, v15, v17
s_nop 1
v_mfma_f32_16x16x32_bf16 v[8:11], v[20:23], v[28:31], v[8:11]
s_nop 7
ds_read_b128 v[28:31], v1 offset:3072
s_waitcnt lgkmcnt(0)
v_and_b32 v20, v12, v18
v_and_b32 v21, v13, v18
v_and_b32 v22, v14, v18
v_and_b32 v23, v15, v18
s_nop 1
v_mfma_f32_16x16x32_bf16 v[8:11], v[20:23], v[24:27], v[8:11]
s_waitcnt lgkmcnt(0)
v_and_b32 v20, v12, v19
v_and_b32 v21, v13, v19
v_and_b32 v22, v14, v19
v_and_b32 v23, v15, v19
s_nop 1
v_mfma_f32_16x16x32_bf16 v[8:11], v[20:23], v[28:31], v[8:11]
s_cmp_lg_u32 s54, 0
s_cbranch_scc1 .L23
s_nop 7
s_mov_b32 s46, 0
buffer_load_dwordx4 v[32:35], v0, s[36:39], s46 offen nt
s_mov_b32 s46, 1024
buffer_load_dwordx4 v[36:39], v0, s[36:39], s46 offen nt
s_mov_b32 s46, 2048
buffer_load_dwordx4 v[40:43], v0, s[36:39], s46 offen nt
s_mov_b32 s46, 3072
buffer_load_dwordx4 v[44:47], v0, s[36:39], s46 offen nt
s_mov_b32 s46, 0
s_add_u32 s49, s48, 0
s_mov_b32 m0, s49
s_nop 0
buffer_load_dwordx4 v0, s[40:43], s46 offen nt lds
s_waitcnt vmcnt(4)
s_mov_b32 s46, 1024
s_add_u32 s49, s48, 1024
s_mov_b32 m0, s49
s_nop 0
buffer_load_dwordx4 v0, s[40:43], s46 offen nt lds
s_waitcnt vmcnt(4)
s_mov_b32 s46, 2048
s_add_u32 s49, s48, 2048
s_mov_b32 m0, s49
s_nop 0
buffer_load_dwordx4 v0, s[40:43], s46 offen nt lds
s_waitcnt vmcnt(4)
s_mov_b32 s46, 3072
s_add_u32 s49, s48, 3072
s_mov_b32 m0, s49
s_nop 0
buffer_load_dwordx4 v0, s[40:43], s46 offen nt lds
.L23:
s_nop 4
v_dot2_f32_bf16 v16, v48, v2, 0
v_dot2_f32_bf16 v17, v52, v2, 0
v_dot2_f32_bf16 v18, v56, v2, 0
v_dot2_f32_bf16 v19, v60, v2, 0
v_dot2_f32_bf16 v16, v49, v3, v16
v_dot2_f32_bf16 v17, v53, v3, v17
v_dot2_f32_bf16 v18, v57, v3, v18
v_dot2_f32_bf16 v19, v61, v3, v19
v_dot2_f32_bf16 v16, v50, v4, v16
v_dot2_f32_bf16 v17, v54, v4, v17
v_dot2_f32_bf16 v18, v58, v4, v18
v_dot2_f32_bf16 v19, v62, v4, v19
v_dot2_f32_bf16 v16, v51, v5, v16
v_dot2_f32_bf16 v17, v55, v5, v17
v_dot2_f32_bf16 v18, v59, v5, v18
v_dot2_f32_bf16 v19, v63, v5, v19
ds_read_b128 v[24:27], v1 offset:4096
ds_read_b128 v[28:31], v1 offset:5120
v_add_f32_dpp v16, v16, v16 row_ror:8 row_mask:0xf bank_mask:0xf
v_add_f32_dpp v17, v17, v17 row_ror:8 row_mask:0xf bank_mask:0xf
v_add_f32_dpp v18, v18, v18 row_ror:8 row_mask:0xf bank_mask:0xf
v_add_f32_dpp v19, v19, v19 row_ror:8 row_mask:0xf bank_mask:0xf
v_add_f32_dpp v16, v16, v16 row_ror:4 row_mask:0xf bank_mask:0xf
v_add_f32_dpp v17, v17, v17 row_ror:4 row_mask:0xf bank_mask:0xf
v_add_f32_dpp v18, v18, v18 row_ror:4 row_mask:0xf bank_mask:0xf
v_add_f32_dpp v19, v19, v19 row_ror:4 row_mask:0xf bank_mask:0xf
v_add_f32_dpp v16, v16, v16 row_ror:2 row_mask:0xf bank_mask:0xf
v_add_f32_dpp v17, v17, v17 row_ror:2 row_mask:0xf bank_mask:0xf
v_add_f32_dpp v18, v18, v18 row_ror:2 row_mask:0xf bank_mask:0xf
v_add_f32_dpp v19, v19, v19 row_ror:2 row_mask:0xf bank_mask:0xf
v_add_f32_dpp v16, v16, v16 row_ror:1 row_mask:0xf bank_mask:0xf
v_add_f32_dpp v17, v17, v17 row_ror:1 row_mask:0xf bank_mask:0xf
v_add_f32_dpp v18, v18, v18 row_ror:1 row_mask:0xf bank_mask:0xf
v_add_f32_dpp v19, v19, v19 row_ror:1 row_mask:0xf bank_mask:0xf
v_max3_f32 v20, v16, v17, v18
v_max3_f32 v20, v20, v19, v6
v_mov_b32 v21, v20
s_nop 1
v_permlane16_swap_b32 v20, v21
v_max_f32 v20, v20, v21
v_mov_b32 v21, v20
s_nop 1
v_permlane32_swap_b32 v20, v21
v_max_f32 v20, v20, v21
v_sub_f32 v21, v6, v20
v_mul_f32 v21, s44, v21
v_exp_f32 v21, v21
v_mul_f32 v22, s44, v20
v_mov_b32 v6, v20
v_fma_f32 v16, v16, s44, -v22
v_fma_f32 v17, v17, s44, -v22
v_fma_f32 v18, v18, s44, -v22
v_fma_f32 v19, v19, s44, -v22
v_exp_f32 v16, v16
v_exp_f32 v17, v17
v_exp_f32 v18, v18
v_exp_f32 v19, v19
v_mul_f32 v7, v7, v21
v_mul_f32 v8, v8, v21
v_mul_f32 v9, v9, v21
v_mul_f32 v10, v10, v21
v_mul_f32 v11, v11, v21
v_add_f32 v7, v7, v16
v_add_f32 v7, v7, v17
v_add_f32 v7, v7, v18
v_add_f32 v7, v7, v19
v_cvt_pk_bf16_f32 v16, v16, v16
v_cvt_pk_bf16_f32 v17, v17, v17
v_cvt_pk_bf16_f32 v18, v18, v18
v_cvt_pk_bf16_f32 v19, v19, v19
s_waitcnt lgkmcnt(0)
v_and_b32 v20, v12, v16
v_and_b32 v21, v13, v16
v_and_b32 v22, v14, v16
v_and_b32 v23, v15, v16
s_nop 1
v_mfma_f32_16x16x32_bf16 v[8:11], v[20:23], v[24:27], v[8:11]
s_nop 7
ds_read_b128 v[24:27], v1 offset:6144
s_waitcnt lgkmcnt(0)
v_and_b32 v20, v12, v17
v_and_b32 v21, v13, v17
v_and_b32 v22, v14, v17
v_and_b32 v23, v15, v17
s_nop 1
v_mfma_f32_16x16x32_bf16 v[8:11], v[20:23], v[28:31], v[8:11]
s_nop 7
ds_read_b128 v[28:31], v1 offset:7168
s_waitcnt lgkmcnt(0)
v_and_b32 v20, v12, v18
v_and_b32 v21, v13, v18
v_and_b32 v22, v14, v18
v_and_b32 v23, v15, v18
s_nop 1
v_mfma_f32_16x16x32_bf16 v[8:11], v[20:23], v[24:27], v[8:11]
s_waitcnt lgkmcnt(0)
v_and_b32 v20, v12, v19
v_and_b32 v21, v13, v19
v_and_b32 v22, v14, v19
v_and_b32 v23, v15, v19
s_nop 1
v_mfma_f32_16x16x32_bf16 v[8:11], v[20:23], v[28:31], v[8:11]
v_dot2_f32_bf16 v16, v64, v2, 0
v_dot2_f32_bf16 v17, v68, v2, 0
v_dot2_f32_bf16 v18, v72, v2, 0
v_dot2_f32_bf16 v19, v76, v2, 0
v_dot2_f32_bf16 v16, v65, v3, v16
v_dot2_f32_bf16 v17, v69, v3, v17
v_dot2_f32_bf16 v18, v73, v3, v18
v_dot2_f32_bf16 v19, v77, v3, v19
v_dot2_f32_bf16 v16, v66, v4, v16
v_dot2_f32_bf16 v17, v70, v4, v17
v_dot2_f32_bf16 v18, v74, v4, v18
v_dot2_f32_bf16 v19, v78, v4, v19
v_dot2_f32_bf16 v16, v67, v5, v16
v_dot2_f32_bf16 v17, v71, v5, v17
v_dot2_f32_bf16 v18, v75, v5, v18
v_dot2_f32_bf16 v19, v79, v5, v19
ds_read_b128 v[24:27], v1 offset:8192
ds_read_b128 v[28:31], v1 offset:9216
v_add_f32_dpp v16, v16, v16 row_ror:8 row_mask:0xf bank_mask:0xf
v_add_f32_dpp v17, v17, v17 row_ror:8 row_mask:0xf bank_mask:0xf
v_add_f32_dpp v18, v18, v18 row_ror:8 row_mask:0xf bank_mask:0xf
v_add_f32_dpp v19, v19, v19 row_ror:8 row_mask:0xf bank_mask:0xf
v_add_f32_dpp v16, v16, v16 row_ror:4 row_mask:0xf bank_mask:0xf
v_add_f32_dpp v17, v17, v17 row_ror:4 row_mask:0xf bank_mask:0xf
v_add_f32_dpp v18, v18, v18 row_ror:4 row_mask:0xf bank_mask:0xf
v_add_f32_dpp v19, v19, v19 row_ror:4 row_mask:0xf bank_mask:0xf
v_add_f32_dpp v16, v16, v16 row_ror:2 row_mask:0xf bank_mask:0xf
v_add_f32_dpp v17, v17, v17 row_ror:2 row_mask:0xf bank_mask:0xf
v_add_f32_dpp v18, v18, v18 row_ror:2 row_mask:0xf bank_mask:0xf
v_add_f32_dpp v19, v19, v19 row_ror:2 row_mask:0xf bank_mask:0xf
v_add_f32_dpp v16, v16, v16 row_ror:1 row_mask:0xf bank_mask:0xf
v_add_f32_dpp v17, v17, v17 row_ror:1 row_mask:0xf bank_mask:0xf
v_add_f32_dpp v18, v18, v18 row_ror:1 row_mask:0xf bank_mask:0xf
v_add_f32_dpp v19, v19, v19 row_ror:1 row_mask:0xf bank_mask:0xf
v_max3_f32 v20, v16, v17, v18
v_max3_f32 v20, v20, v19, v6
v_mov_b32 v21, v20
s_nop 1
v_permlane16_swap_b32 v20, v21
v_max_f32 v20, v20, v21
v_mov_b32 v21, v20
s_nop 1
v_permlane32_swap_b32 v20, v21
v_max_f32 v20, v20, v21
v_sub_f32 v21, v6, v20
v_mul_f32 v21, s44, v21
v_exp_f32 v21, v21
v_mul_f32 v22, s44, v20
v_mov_b32 v6, v20
v_fma_f32 v16, v16, s44, -v22
v_fma_f32 v17, v17, s44, -v22
v_fma_f32 v18, v18, s44, -v22
v_fma_f32 v19, v19, s44, -v22
v_exp_f32 v16, v16
v_exp_f32 v17, v17
v_exp_f32 v18, v18
v_exp_f32 v19, v19
v_mul_f32 v7, v7, v21
v_mul_f32 v8, v8, v21
v_mul_f32 v9, v9, v21
v_mul_f32 v10, v10, v21
v_mul_f32 v11, v11, v21
v_add_f32 v7, v7, v16
v_add_f32 v7, v7, v17
v_add_f32 v7, v7, v18
v_add_f32 v7, v7, v19
v_cvt_pk_bf16_f32 v16, v16, v16
v_cvt_pk_bf16_f32 v17, v17, v17
v_cvt_pk_bf16_f32 v18, v18, v18
v_cvt_pk_bf16_f32 v19, v19, v19
s_waitcnt lgkmcnt(0)
v_and_b32 v20, v12, v16
v_and_b32 v21, v13, v16
v_and_b32 v22, v14, v16
v_and_b32 v23, v15, v16
s_nop 1
v_mfma_f32_16x16x32_bf16 v[8:11], v[20:23], v[24:27], v[8:11]
s_waitcnt lgkmcnt(0)
v_and_b32 v20, v12, v17
v_and_b32 v21, v13, v17
v_and_b32 v22, v14, v17
v_and_b32 v23, v15, v17
s_nop 1
v_mfma_f32_16x16x32_bf16 v[8:11], v[20:23], v[28:31], v[8:11]
v_and_b32 v20, v12, v18
v_and_b32 v21, v13, v18
v_and_b32 v22, v14, v18
v_and_b32 v23, v15, v18
s_nop 1
v_mfma_f32_16x16x32_bf16 v[8:11], v[20:23], v[108:111], v[8:11]
v_and_b32 v20, v12, v19
v_and_b32 v21, v13, v19
v_and_b32 v22, v14, v19
v_and_b32 v23, v15, v19
s_nop 1
v_mfma_f32_16x16x32_bf16 v[8:11], v[20:23], v[112:115], v[8:11]
v_dot2_f32_bf16 v16, v80, v2, 0
v_dot2_f32_bf16 v17, v84, v2, 0
v_dot2_f32_bf16 v18, v88, v2, 0
v_dot2_f32_bf16 v19, v92, v2, 0
v_dot2_f32_bf16 v16, v81, v3, v16
v_dot2_f32_bf16 v17, v85, v3, v17
v_dot2_f32_bf16 v18, v89, v3, v18
v_dot2_f32_bf16 v19, v93, v3, v19
v_dot2_f32_bf16 v16, v82, v4, v16
v_dot2_f32_bf16 v17, v86, v4, v17
v_dot2_f32_bf16 v18, v90, v4, v18
v_dot2_f32_bf16 v19, v94, v4, v19
v_dot2_f32_bf16 v16, v83, v5, v16
v_dot2_f32_bf16 v17, v87, v5, v17
v_dot2_f32_bf16 v18, v91, v5, v18
v_dot2_f32_bf16 v19, v95, v5, v19
v_add_f32_dpp v16, v16, v16 row_ror:8 row_mask:0xf bank_mask:0xf
v_add_f32_dpp v17, v17, v17 row_ror:8 row_mask:0xf bank_mask:0xf
v_add_f32_dpp v18, v18, v18 row_ror:8 row_mask:0xf bank_mask:0xf
v_add_f32_dpp v19, v19, v19 row_ror:8 row_mask:0xf bank_mask:0xf
v_add_f32_dpp v16, v16, v16 row_ror:4 row_mask:0xf bank_mask:0xf
v_add_f32_dpp v17, v17, v17 row_ror:4 row_mask:0xf bank_mask:0xf
v_add_f32_dpp v18, v18, v18 row_ror:4 row_mask:0xf bank_mask:0xf
v_add_f32_dpp v19, v19, v19 row_ror:4 row_mask:0xf bank_mask:0xf
v_add_f32_dpp v16, v16, v16 row_ror:2 row_mask:0xf bank_mask:0xf
v_add_f32_dpp v17, v17, v17 row_ror:2 row_mask:0xf bank_mask:0xf
v_add_f32_dpp v18, v18, v18 row_ror:2 row_mask:0xf bank_mask:0xf
v_add_f32_dpp v19, v19, v19 row_ror:2 row_mask:0xf bank_mask:0xf
v_add_f32_dpp v16, v16, v16 row_ror:1 row_mask:0xf bank_mask:0xf
v_add_f32_dpp v17, v17, v17 row_ror:1 row_mask:0xf bank_mask:0xf
v_add_f32_dpp v18, v18, v18 row_ror:1 row_mask:0xf bank_mask:0xf
v_add_f32_dpp v19, v19, v19 row_ror:1 row_mask:0xf bank_mask:0xf
v_max3_f32 v20, v16, v17, v18
v_max3_f32 v20, v20, v19, v6
v_mov_b32 v21, v20
s_nop 1
v_permlane16_swap_b32 v20, v21
v_max_f32 v20, v20, v21
v_mov_b32 v21, v20
s_nop 1
v_permlane32_swap_b32 v20, v21
v_max_f32 v20, v20, v21
v_sub_f32 v21, v6, v20
v_mul_f32 v21, s44, v21
v_exp_f32 v21, v21
v_mul_f32 v22, s44, v20
v_mov_b32 v6, v20
v_fma_f32 v16, v16, s44, -v22
v_fma_f32 v17, v17, s44, -v22
v_fma_f32 v18, v18, s44, -v22
v_fma_f32 v19, v19, s44, -v22
v_exp_f32 v16, v16
v_exp_f32 v17, v17
v_exp_f32 v18, v18
v_exp_f32 v19, v19
v_mul_f32 v7, v7, v21
v_mul_f32 v8, v8, v21
v_mul_f32 v9, v9, v21
v_mul_f32 v10, v10, v21
v_mul_f32 v11, v11, v21
v_add_f32 v7, v7, v16
v_add_f32 v7, v7, v17
v_add_f32 v7, v7, v18
v_add_f32 v7, v7, v19
v_cvt_pk_bf16_f32 v16, v16, v16
v_cvt_pk_bf16_f32 v17, v17, v17
v_cvt_pk_bf16_f32 v18, v18, v18
v_cvt_pk_bf16_f32 v19, v19, v19
v_and_b32 v20, v12, v16
v_and_b32 v21, v13, v16
v_and_b32 v22, v14, v16
v_and_b32 v23, v15, v16
s_nop 1
v_mfma_f32_16x16x32_bf16 v[8:11], v[20:23], v[116:119], v[8:11]
v_and_b32 v20, v12, v17
v_and_b32 v21, v13, v17
v_and_b32 v22, v14, v17
v_and_b32 v23, v15, v17
s_nop 1
v_mfma_f32_16x16x32_bf16 v[8:11], v[20:23], v[120:123], v[8:11]
v_and_b32 v20, v12, v18
v_and_b32 v21, v13, v18
v_and_b32 v22, v14, v18
v_and_b32 v23, v15, v18
s_nop 1
v_mfma_f32_16x16x32_bf16 v[8:11], v[20:23], v[124:127], v[8:11]
v_and_b32 v20, v12, v19
v_and_b32 v21, v13, v19
v_and_b32 v22, v14, v19
v_and_b32 v23, v15, v19
s_nop 1
v_mfma_f32_16x16x32_bf16 v[8:11], v[20:23], v[128:131], v[8:11]
v_dot2_f32_bf16 v16, v96, v2, 0
v_dot2_f32_bf16 v17, v100, v2, 0
v_dot2_f32_bf16 v18, v104, v2, 0
v_dot2_f32_bf16 v16, v97, v3, v16
v_dot2_f32_bf16 v17, v101, v3, v17
v_dot2_f32_bf16 v18, v105, v3, v18
v_dot2_f32_bf16 v16, v98, v4, v16
v_dot2_f32_bf16 v17, v102, v4, v17
v_dot2_f32_bf16 v18, v106, v4, v18
v_dot2_f32_bf16 v16, v99, v5, v16
v_dot2_f32_bf16 v17, v103, v5, v17
v_dot2_f32_bf16 v18, v107, v5, v18
s_cmp_lg_u32 s54, 0
s_cbranch_scc1 .L24
s_add_u32 s3, s52, 0
s_mul_i32 s3, s3, 57344
s_lshl_b32 s4, s2, 8
s_add_u32 s3, s3, s4
s_add_u32 s3, s3, 4194304
v_subrev_u32 v20, s48, v1
v_and_b32 v20, 0xf0, v20
v_add_u32 v20, s3, v20
s_branch .L25
.L24:
s_nop 4
s_min_u32 s53, s53, 7
s_add_u32 s3, s53, 8
s_mul_i32 s3, s3, 57344
s_lshl_b32 s4, s2, 8
s_add_u32 s3, s3, s4
s_add_u32 s3, s3, 4194304
v_subrev_u32 v20, s48, v1
v_and_b32 v20, 0xf0, v20
v_add_u32 v20, s3, v20
.L25:
s_nop 4
global_load_dwordx4 v[2:5], v20, s[28:29] sc1
v_add_f32_dpp v16, v16, v16 row_ror:8 row_mask:0xf bank_mask:0xf
v_add_f32_dpp v17, v17, v17 row_ror:8 row_mask:0xf bank_mask:0xf
v_add_f32_dpp v18, v18, v18 row_ror:8 row_mask:0xf bank_mask:0xf
v_add_f32_dpp v16, v16, v16 row_ror:4 row_mask:0xf bank_mask:0xf
v_add_f32_dpp v17, v17, v17 row_ror:4 row_mask:0xf bank_mask:0xf
v_add_f32_dpp v18, v18, v18 row_ror:4 row_mask:0xf bank_mask:0xf
v_add_f32_dpp v16, v16, v16 row_ror:2 row_mask:0xf bank_mask:0xf
v_add_f32_dpp v17, v17, v17 row_ror:2 row_mask:0xf bank_mask:0xf
v_add_f32_dpp v18, v18, v18 row_ror:2 row_mask:0xf bank_mask:0xf
v_add_f32_dpp v16, v16, v16 row_ror:1 row_mask:0xf bank_mask:0xf
v_add_f32_dpp v17, v17, v17 row_ror:1 row_mask:0xf bank_mask:0xf
v_add_f32_dpp v18, v18, v18 row_ror:1 row_mask:0xf bank_mask:0xf
v_max3_f32 v20, v16, v17, v18
v_max_f32 v20, v20, v6
v_mov_b32 v21, v20
s_nop 1
v_permlane16_swap_b32 v20, v21
v_max_f32 v20, v20, v21
v_mov_b32 v21, v20
s_nop 1
v_permlane32_swap_b32 v20, v21
v_max_f32 v20, v20, v21
v_sub_f32 v21, v6, v20
v_mul_f32 v21, s44, v21
v_exp_f32 v21, v21
v_mul_f32 v22, s44, v20
v_mov_b32 v6, v20
v_fma_f32 v16, v16, s44, -v22
v_fma_f32 v17, v17, s44, -v22
v_fma_f32 v18, v18, s44, -v22
v_exp_f32 v16, v16
v_exp_f32 v17, v17
v_exp_f32 v18, v18
v_mul_f32 v7, v7, v21
v_mul_f32 v8, v8, v21
v_mul_f32 v9, v9, v21
v_mul_f32 v10, v10, v21
v_mul_f32 v11, v11, v21
v_add_f32 v7, v7, v16
v_add_f32 v7, v7, v17
v_add_f32 v7, v7, v18
v_cvt_pk_bf16_f32 v16, v16, v16
v_cvt_pk_bf16_f32 v17, v17, v17
v_cvt_pk_bf16_f32 v18, v18, v18
v_and_b32 v20, v12, v16
v_and_b32 v21, v13, v16
v_and_b32 v22, v14, v16
v_and_b32 v23, v15, v16
s_nop 1
v_mfma_f32_16x16x32_bf16 v[8:11], v[20:23], v[132:135], v[8:11]
v_and_b32 v20, v12, v17
v_and_b32 v21, v13, v17
v_and_b32 v22, v14, v17
v_and_b32 v23, v15, v17
s_nop 1
v_mfma_f32_16x16x32_bf16 v[8:11], v[20:23], v[136:139], v[8:11]
v_and_b32 v20, v12, v18
v_and_b32 v21, v13, v18
v_and_b32 v22, v14, v18
v_and_b32 v23, v15, v18
s_nop 1
v_mfma_f32_16x16x32_bf16 v[8:11], v[20:23], v[140:143], v[8:11]
s_cmp_lg_u32 s54, 0
s_cbranch_scc1 .L26
s_nop 7
s_waitcnt vmcnt(4)
s_mov_b32 s46, 4096
buffer_load_dwordx4 v[48:51], v0, s[36:39], s46 offen nt
s_waitcnt vmcnt(4)
s_mov_b32 s46, 5120
buffer_load_dwordx4 v[52:55], v0, s[36:39], s46 offen nt
s_waitcnt vmcnt(4)
s_mov_b32 s46, 6144
buffer_load_dwordx4 v[56:59], v0, s[36:39], s46 offen nt
s_waitcnt vmcnt(4)
s_mov_b32 s46, 7168
buffer_load_dwordx4 v[60:63], v0, s[36:39], s46 offen nt
s_waitcnt vmcnt(4)
s_mov_b32 s46, 4096
s_add_u32 s49, s48, 4096
s_mov_b32 m0, s49
s_nop 0
buffer_load_dwordx4 v0, s[40:43], s46 offen nt lds
s_waitcnt vmcnt(4)
s_mov_b32 s46, 5120
s_add_u32 s49, s48, 5120
s_mov_b32 m0, s49
s_nop 0
buffer_load_dwordx4 v0, s[40:43], s46 offen nt lds
s_waitcnt vmcnt(4)
s_mov_b32 s46, 6144
s_add_u32 s49, s48, 6144
s_mov_b32 m0, s49
s_nop 0
buffer_load_dwordx4 v0, s[40:43], s46 offen nt lds
s_waitcnt vmcnt(4)
s_mov_b32 s46, 7168
s_add_u32 s49, s48, 7168
s_mov_b32 m0, s49
s_nop 0
buffer_load_dwordx4 v0, s[40:43], s46 offen nt lds
.L26:
s_nop 4
v_mul_f32 v6, s44, v6
v_mov_b32 v16, v7
s_nop 1
v_permlane16_swap_b32 v7, v16
v_add_f32 v7, v7, v16
v_mov_b32 v16, v7
s_nop 1
v_permlane32_swap_b32 v7, v16
v_add_f32 v7, v7, v16
v_subrev_u32 v16, s48, v1
v_and_b32 v17, 0xf0, v16
v_lshlrev_b32 v17, 1, v17
v_lshrrev_b32 v18, 8, v16
v_lshl_add_u32 v17, v18, 4, v17
s_mul_i32 s3, s30, 528
s_add_u32 s3, s3, 151808
v_add_u32 v17, s3, v17
s_mov_b32 exec_hi, 0
ds_write_b128 v17, v[8:11]
s_mov_b64 exec, 1
ds_write_b64 v17, v[6:7] offset:512
s_waitcnt lgkmcnt(0)
v_mov_b32 v18, 160264
v_mov_b32 v19, 1
ds_add_rtn_u32 v20, v18, v19
s_waitcnt lgkmcnt(0)
s_mov_b64 exec, -1
v_readfirstlane_b32 s3, v20
s_nop 0
s_and_b32 s3, s3, 7
s_cmp_lg_u32 s3, 7
s_cbranch_scc1 .L27
v_mov_b32 v10, 152320
ds_read_b64 v[16:17], v10 offset:0
ds_read_b64 v[18:19], v10 offset:528
ds_read_b64 v[20:21], v10 offset:1056
ds_read_b64 v[22:23], v10 offset:1584
ds_read_b64 v[24:25], v10 offset:2112
ds_read_b64 v[26:27], v10 offset:2640
ds_read_b64 v[28:29], v10 offset:3168
ds_read_b64 v[30:31], v10 offset:3696
v_subrev_u32 v11, s48, v1
v_lshrrev_b32 v11, 1, v11
v_add_u32 v10, 151808, v11
s_waitcnt lgkmcnt(0)
v_max3_f32 v6, v16, v18, v20
v_max3_f32 v6, v6, v22, v24
v_max3_f32 v6, v6, v26, v28
v_max_f32 v6, v6, v30
v_mov_b32 v7, 0
v_mov_b32 v8, 0
v_mov_b32 v9, 0
v_sub_f32 v16, v16, v6
v_exp_f32 v16, v16
v_sub_f32 v18, v18, v6
v_exp_f32 v18, v18
v_sub_f32 v20, v20, v6
v_exp_f32 v20, v20
v_sub_f32 v22, v22, v6
v_exp_f32 v22, v22
v_sub_f32 v24, v24, v6
v_exp_f32 v24, v24
v_sub_f32 v26, v26, v6
v_exp_f32 v26, v26
v_sub_f32 v28, v28, v6
v_exp_f32 v28, v28
v_sub_f32 v30, v30, v6
v_exp_f32 v30, v30
v_fmac_f32 v7, v16, v17
v_fmac_f32 v7, v18, v19
v_fmac_f32 v7, v20, v21
v_fmac_f32 v7, v22, v23
v_fmac_f32 v7, v24, v25
v_fmac_f32 v7, v26, v27
v_fmac_f32 v7, v28, v29
v_fmac_f32 v7, v30, v31
v_mov_b32 v17, v18
v_mov_b32 v18, v20
v_mov_b32 v19, v22
v_mov_b32 v20, v24
v_mov_b32 v21, v26
v_mov_b32 v22, v28
v_mov_b32 v23, v30
ds_read_b64 v[24:25], v10 offset:0
ds_read_b64 v[26:27], v10 offset:528
ds_read_b64 v[28:29], v10 offset:1056
ds_read_b64 v[30:31], v10 offset:1584
s_waitcnt lgkmcnt(0)
v_fmac_f32 v8, v16, v24
v_fmac_f32 v9, v16, v25
v_fmac_f32 v8, v17, v26
v_fmac_f32 v9, v17, v27
v_fmac_f32 v8, v18, v28
v_fmac_f32 v9, v18, v29
v_fmac_f32 v8, v19, v30
v_fmac_f32 v9, v19, v31
ds_read_b64 v[24:25], v10 offset:2112
ds_read_b64 v[26:27], v10 offset:2640
ds_read_b64 v[28:29], v10 offset:3168
ds_read_b64 v[30:31], v10 offset:3696
s_waitcnt lgkmcnt(0)
v_fmac_f32 v8, v20, v24
v_fmac_f32 v9, v20, v25
v_fmac_f32 v8, v21, v26
v_fmac_f32 v9, v21, v27
v_fmac_f32 v8, v22, v28
v_fmac_f32 v9, v22, v29
v_fmac_f32 v8, v23, v30
v_fmac_f32 v9, v23, v31
v_min_u32 v6, 0xfffffffe, v6
v_min_u32 v7, 0xfffffffe, v7
v_min_u32 v8, 0xfffffffe, v8
v_min_u32 v9, 0xfffffffe, v9
s_add_u32 s3, s51, 8
s_mul_i32 s3, s3, 224
s_add_u32 s3, s3, s2
s_mul_i32 s3, s3, 528
v_add_u32 v11, s3, v11
global_store_dwordx2 v11, v[8:9], s[28:29] offset:0 sc1
s_mov_b64 exec, 1
global_store_dwordx2 v11, v[6:7], s[28:29] offset:512 sc1
s_mov_b64 exec, -1
.L27:
s_nop 4
s_cmp_lg_u32 s54, 0
s_cbranch_scc1 .L28
s_branch .L31
.L29:
s_nop 4
s_add_u32 s3, s52, 0
s_mul_i32 s3, s3, 57344
s_lshl_b32 s4, s2, 8
s_add_u32 s3, s3, s4
s_add_u32 s3, s3, 4194304
v_subrev_u32 v20, s48, v1
v_and_b32 v20, 0xf0, v20
v_add_u32 v20, s3, v20
global_load_dwordx4 v[2:5], v20, s[28:29] sc1
s_waitcnt vmcnt(0)
.L31:
s_nop 4
v_max3_u32 v17, v2, v3, v4
v_max_u32 v17, v17, v5
v_cmp_eq_u32 vcc, -1, v17
s_nop 0
s_cmp_eq_u64 vcc, 0
s_cbranch_scc1 .L30
s_sleep 2
s_add_u32 s47, s47, 1
s_cmp_lt_u32 s47, 262144
s_cbranch_scc1 .L29
s_endpgm
.L30:
s_nop 4
v_mov_b32 v6, 0xff800000
v_mov_b32 v7, 0
v_mov_b32 v8, 0
v_mov_b32 v9, 0
v_mov_b32 v10, 0
v_mov_b32 v11, 0
v_dot2_f32_bf16 v16, v32, v2, 0
v_dot2_f32_bf16 v17, v36, v2, 0
v_dot2_f32_bf16 v18, v40, v2, 0
v_dot2_f32_bf16 v19, v44, v2, 0
v_dot2_f32_bf16 v16, v33, v3, v16
v_dot2_f32_bf16 v17, v37, v3, v17
v_dot2_f32_bf16 v18, v41, v3, v18
v_dot2_f32_bf16 v19, v45, v3, v19
v_dot2_f32_bf16 v16, v34, v4, v16
v_dot2_f32_bf16 v17, v38, v4, v17
v_dot2_f32_bf16 v18, v42, v4, v18
v_dot2_f32_bf16 v19, v46, v4, v19
v_dot2_f32_bf16 v16, v35, v5, v16
v_dot2_f32_bf16 v17, v39, v5, v17
v_dot2_f32_bf16 v18, v43, v5, v18
v_dot2_f32_bf16 v19, v47, v5, v19
ds_read_b128 v[24:27], v1 offset:0
ds_read_b128 v[28:31], v1 offset:1024
v_add_f32_dpp v16, v16, v16 row_ror:8 row_mask:0xf bank_mask:0xf
v_add_f32_dpp v17, v17, v17 row_ror:8 row_mask:0xf bank_mask:0xf
v_add_f32_dpp v18, v18, v18 row_ror:8 row_mask:0xf bank_mask:0xf
v_add_f32_dpp v19, v19, v19 row_ror:8 row_mask:0xf bank_mask:0xf
v_add_f32_dpp v16, v16, v16 row_ror:4 row_mask:0xf bank_mask:0xf
v_add_f32_dpp v17, v17, v17 row_ror:4 row_mask:0xf bank_mask:0xf
v_add_f32_dpp v18, v18, v18 row_ror:4 row_mask:0xf bank_mask:0xf
v_add_f32_dpp v19, v19, v19 row_ror:4 row_mask:0xf bank_mask:0xf
v_add_f32_dpp v16, v16, v16 row_ror:2 row_mask:0xf bank_mask:0xf
v_add_f32_dpp v17, v17, v17 row_ror:2 row_mask:0xf bank_mask:0xf
v_add_f32_dpp v18, v18, v18 row_ror:2 row_mask:0xf bank_mask:0xf
v_add_f32_dpp v19, v19, v19 row_ror:2 row_mask:0xf bank_mask:0xf
v_add_f32_dpp v16, v16, v16 row_ror:1 row_mask:0xf bank_mask:0xf
v_add_f32_dpp v17, v17, v17 row_ror:1 row_mask:0xf bank_mask:0xf
v_add_f32_dpp v18, v18, v18 row_ror:1 row_mask:0xf bank_mask:0xf
v_add_f32_dpp v19, v19, v19 row_ror:1 row_mask:0xf bank_mask:0xf
v_max3_f32 v20, v16, v17, v18
v_max3_f32 v20, v20, v19, v6
v_mov_b32 v21, v20
s_nop 1
v_permlane16_swap_b32 v20, v21
v_max_f32 v20, v20, v21
v_mov_b32 v21, v20
s_nop 1
v_permlane32_swap_b32 v20, v21
v_max_f32 v20, v20, v21
v_sub_f32 v21, v6, v20
v_mul_f32 v21, s44, v21
v_exp_f32 v21, v21
v_mul_f32 v22, s44, v20
v_mov_b32 v6, v20
v_fma_f32 v16, v16, s44, -v22
v_fma_f32 v17, v17, s44, -v22
v_fma_f32 v18, v18, s44, -v22
v_fma_f32 v19, v19, s44, -v22
v_exp_f32 v16, v16
v_exp_f32 v17, v17
v_exp_f32 v18, v18
v_exp_f32 v19, v19
v_mul_f32 v7, v7, v21
v_mul_f32 v8, v8, v21
v_mul_f32 v9, v9, v21
v_mul_f32 v10, v10, v21
v_mul_f32 v11, v11, v21
v_add_f32 v7, v7, v16
v_add_f32 v7, v7, v17
v_add_f32 v7, v7, v18
v_add_f32 v7, v7, v19
v_cvt_pk_bf16_f32 v16, v16, v16
v_cvt_pk_bf16_f32 v17, v17, v17
v_cvt_pk_bf16_f32 v18, v18, v18
v_cvt_pk_bf16_f32 v19, v19, v19
s_waitcnt lgkmcnt(0)
v_and_b32 v20, v12, v16
v_and_b32 v21, v13, v16
v_and_b32 v22, v14, v16
v_and_b32 v23, v15, v16
s_nop 1
v_mfma_f32_16x16x32_bf16 v[8:11], v[20:23], v[24:27], v[8:11]
s_nop 7
ds_read_b128 v[24:27], v1 offset:2048
s_waitcnt lgkmcnt(0)
v_and_b32 v20, v12, v17
v_and_b32 v21, v13, v17
v_and_b32 v22, v14, v17
v_and_b32 v23, v15, v17
s_nop 1
v_mfma_f32_16x16x32_bf16 v[8:11], v[20:23], v[28:31], v[8:11]
s_nop 7
ds_read_b128 v[28:31], v1 offset:3072
s_waitcnt lgkmcnt(0)
v_and_b32 v20, v12, v18
v_and_b32 v21, v13, v18
v_and_b32 v22, v14, v18
v_and_b32 v23, v15, v18
s_nop 1
v_mfma_f32_16x16x32_bf16 v[8:11], v[20:23], v[24:27], v[8:11]
s_waitcnt lgkmcnt(0)
v_and_b32 v20, v12, v19
v_and_b32 v21, v13, v19
v_and_b32 v22, v14, v19
v_and_b32 v23, v15, v19
s_nop 1
v_mfma_f32_16x16x32_bf16 v[8:11], v[20:23], v[28:31], v[8:11]
s_nop 7
s_waitcnt vmcnt(4)
s_mov_b32 s46, 8192
buffer_load_dwordx4 v[64:67], v0, s[36:39], s46 offen nt
s_waitcnt vmcnt(4)
s_mov_b32 s46, 9216
buffer_load_dwordx4 v[68:71], v0, s[36:39], s46 offen nt
s_waitcnt vmcnt(4)
s_mov_b32 s46, 10240
buffer_load_dwordx4 v[72:75], v0, s[36:39], s46 offen nt
s_waitcnt vmcnt(4)
s_mov_b32 s46, 11264
buffer_load_dwordx4 v[76:79], v0, s[36:39], s46 offen nt
s_waitcnt vmcnt(4)
s_mov_b32 s46, 8192
s_add_u32 s49, s48, 8192
s_mov_b32 m0, s49
s_nop 0
buffer_load_dwordx4 v0, s[40:43], s46 offen nt lds
s_waitcnt vmcnt(4)
s_mov_b32 s46, 9216
s_add_u32 s49, s48, 9216
s_mov_b32 m0, s49
s_nop 0
buffer_load_dwordx4 v0, s[40:43], s46 offen nt lds
s_waitcnt vmcnt(4)
s_mov_b32 s46, 10240
buffer_load_dwordx4 v[108:111], v0, s[40:43], s46 offen nt
s_waitcnt vmcnt(4)
s_mov_b32 s46, 11264
buffer_load_dwordx4 v[112:115], v0, s[40:43], s46 offen nt
v_dot2_f32_bf16 v16, v48, v2, 0
v_dot2_f32_bf16 v17, v52, v2, 0
v_dot2_f32_bf16 v18, v56, v2, 0
v_dot2_f32_bf16 v19, v60, v2, 0
v_dot2_f32_bf16 v16, v49, v3, v16
v_dot2_f32_bf16 v17, v53, v3, v17
v_dot2_f32_bf16 v18, v57, v3, v18
v_dot2_f32_bf16 v19, v61, v3, v19
v_dot2_f32_bf16 v16, v50, v4, v16
v_dot2_f32_bf16 v17, v54, v4, v17
v_dot2_f32_bf16 v18, v58, v4, v18
v_dot2_f32_bf16 v19, v62, v4, v19
v_dot2_f32_bf16 v16, v51, v5, v16
v_dot2_f32_bf16 v17, v55, v5, v17
v_dot2_f32_bf16 v18, v59, v5, v18
v_dot2_f32_bf16 v19, v63, v5, v19
ds_read_b128 v[24:27], v1 offset:4096
ds_read_b128 v[28:31], v1 offset:5120
v_add_f32_dpp v16, v16, v16 row_ror:8 row_mask:0xf bank_mask:0xf
v_add_f32_dpp v17, v17, v17 row_ror:8 row_mask:0xf bank_mask:0xf
v_add_f32_dpp v18, v18, v18 row_ror:8 row_mask:0xf bank_mask:0xf
v_add_f32_dpp v19, v19, v19 row_ror:8 row_mask:0xf bank_mask:0xf
v_add_f32_dpp v16, v16, v16 row_ror:4 row_mask:0xf bank_mask:0xf
v_add_f32_dpp v17, v17, v17 row_ror:4 row_mask:0xf bank_mask:0xf
v_add_f32_dpp v18, v18, v18 row_ror:4 row_mask:0xf bank_mask:0xf
v_add_f32_dpp v19, v19, v19 row_ror:4 row_mask:0xf bank_mask:0xf
v_add_f32_dpp v16, v16, v16 row_ror:2 row_mask:0xf bank_mask:0xf
v_add_f32_dpp v17, v17, v17 row_ror:2 row_mask:0xf bank_mask:0xf
v_add_f32_dpp v18, v18, v18 row_ror:2 row_mask:0xf bank_mask:0xf
v_add_f32_dpp v19, v19, v19 row_ror:2 row_mask:0xf bank_mask:0xf
v_add_f32_dpp v16, v16, v16 row_ror:1 row_mask:0xf bank_mask:0xf
v_add_f32_dpp v17, v17, v17 row_ror:1 row_mask:0xf bank_mask:0xf
v_add_f32_dpp v18, v18, v18 row_ror:1 row_mask:0xf bank_mask:0xf
v_add_f32_dpp v19, v19, v19 row_ror:1 row_mask:0xf bank_mask:0xf
v_max3_f32 v20, v16, v17, v18
v_max3_f32 v20, v20, v19, v6
v_mov_b32 v21, v20
s_nop 1
v_permlane16_swap_b32 v20, v21
v_max_f32 v20, v20, v21
v_mov_b32 v21, v20
s_nop 1
v_permlane32_swap_b32 v20, v21
v_max_f32 v20, v20, v21
v_sub_f32 v21, v6, v20
v_mul_f32 v21, s44, v21
v_exp_f32 v21, v21
v_mul_f32 v22, s44, v20
v_mov_b32 v6, v20
v_fma_f32 v16, v16, s44, -v22
v_fma_f32 v17, v17, s44, -v22
v_fma_f32 v18, v18, s44, -v22
v_fma_f32 v19, v19, s44, -v22
v_exp_f32 v16, v16
v_exp_f32 v17, v17
v_exp_f32 v18, v18
v_exp_f32 v19, v19
v_mul_f32 v7, v7, v21
v_mul_f32 v8, v8, v21
v_mul_f32 v9, v9, v21
v_mul_f32 v10, v10, v21
v_mul_f32 v11, v11, v21
v_add_f32 v7, v7, v16
v_add_f32 v7, v7, v17
v_add_f32 v7, v7, v18
v_add_f32 v7, v7, v19
v_cvt_pk_bf16_f32 v16, v16, v16
v_cvt_pk_bf16_f32 v17, v17, v17
v_cvt_pk_bf16_f32 v18, v18, v18
v_cvt_pk_bf16_f32 v19, v19, v19
s_waitcnt lgkmcnt(0)
v_and_b32 v20, v12, v16
v_and_b32 v21, v13, v16
v_and_b32 v22, v14, v16
v_and_b32 v23, v15, v16
s_nop 1
v_mfma_f32_16x16x32_bf16 v[8:11], v[20:23], v[24:27], v[8:11]
s_nop 7
ds_read_b128 v[24:27], v1 offset:6144
s_waitcnt lgkmcnt(0)
v_and_b32 v20, v12, v17
v_and_b32 v21, v13, v17
v_and_b32 v22, v14, v17
v_and_b32 v23, v15, v17
s_nop 1
v_mfma_f32_16x16x32_bf16 v[8:11], v[20:23], v[28:31], v[8:11]
s_nop 7
ds_read_b128 v[28:31], v1 offset:7168
s_waitcnt lgkmcnt(0)
v_and_b32 v20, v12, v18
v_and_b32 v21, v13, v18
v_and_b32 v22, v14, v18
v_and_b32 v23, v15, v18
s_nop 1
v_mfma_f32_16x16x32_bf16 v[8:11], v[20:23], v[24:27], v[8:11]
s_waitcnt lgkmcnt(0)
v_and_b32 v20, v12, v19
v_and_b32 v21, v13, v19
v_and_b32 v22, v14, v19
v_and_b32 v23, v15, v19
s_nop 1
v_mfma_f32_16x16x32_bf16 v[8:11], v[20:23], v[28:31], v[8:11]
s_nop 7
s_waitcnt vmcnt(4)
s_mov_b32 s46, 12288
buffer_load_dwordx4 v[80:83], v0, s[36:39], s46 offen nt
s_waitcnt vmcnt(4)
s_mov_b32 s46, 13312
buffer_load_dwordx4 v[84:87], v0, s[36:39], s46 offen nt
s_waitcnt vmcnt(4)
s_mov_b32 s46, 14336
buffer_load_dwordx4 v[88:91], v0, s[36:39], s46 offen nt
s_waitcnt vmcnt(4)
s_mov_b32 s46, 15360
buffer_load_dwordx4 v[92:95], v0, s[36:39], s46 offen nt
s_waitcnt vmcnt(4)
s_mov_b32 s46, 12288
buffer_load_dwordx4 v[116:119], v0, s[40:43], s46 offen nt
s_waitcnt vmcnt(4)
s_mov_b32 s46, 13312
buffer_load_dwordx4 v[120:123], v0, s[40:43], s46 offen nt
s_waitcnt vmcnt(4)
s_mov_b32 s46, 14336
buffer_load_dwordx4 v[124:127], v0, s[40:43], s46 offen nt
s_waitcnt vmcnt(4)
s_mov_b32 s46, 15360
buffer_load_dwordx4 v[128:131], v0, s[40:43], s46 offen nt
v_dot2_f32_bf16 v16, v64, v2, 0
v_dot2_f32_bf16 v17, v68, v2, 0
v_dot2_f32_bf16 v18, v72, v2, 0
v_dot2_f32_bf16 v19, v76, v2, 0
v_dot2_f32_bf16 v16, v65, v3, v16
v_dot2_f32_bf16 v17, v69, v3, v17
v_dot2_f32_bf16 v18, v73, v3, v18
v_dot2_f32_bf16 v19, v77, v3, v19
v_dot2_f32_bf16 v16, v66, v4, v16
v_dot2_f32_bf16 v17, v70, v4, v17
v_dot2_f32_bf16 v18, v74, v4, v18
v_dot2_f32_bf16 v19, v78, v4, v19
v_dot2_f32_bf16 v16, v67, v5, v16
v_dot2_f32_bf16 v17, v71, v5, v17
v_dot2_f32_bf16 v18, v75, v5, v18
v_dot2_f32_bf16 v19, v79, v5, v19
ds_read_b128 v[24:27], v1 offset:8192
ds_read_b128 v[28:31], v1 offset:9216
v_add_f32_dpp v16, v16, v16 row_ror:8 row_mask:0xf bank_mask:0xf
v_add_f32_dpp v17, v17, v17 row_ror:8 row_mask:0xf bank_mask:0xf
v_add_f32_dpp v18, v18, v18 row_ror:8 row_mask:0xf bank_mask:0xf
v_add_f32_dpp v19, v19, v19 row_ror:8 row_mask:0xf bank_mask:0xf
v_add_f32_dpp v16, v16, v16 row_ror:4 row_mask:0xf bank_mask:0xf
v_add_f32_dpp v17, v17, v17 row_ror:4 row_mask:0xf bank_mask:0xf
v_add_f32_dpp v18, v18, v18 row_ror:4 row_mask:0xf bank_mask:0xf
v_add_f32_dpp v19, v19, v19 row_ror:4 row_mask:0xf bank_mask:0xf
v_add_f32_dpp v16, v16, v16 row_ror:2 row_mask:0xf bank_mask:0xf
v_add_f32_dpp v17, v17, v17 row_ror:2 row_mask:0xf bank_mask:0xf
v_add_f32_dpp v18, v18, v18 row_ror:2 row_mask:0xf bank_mask:0xf
v_add_f32_dpp v19, v19, v19 row_ror:2 row_mask:0xf bank_mask:0xf
v_add_f32_dpp v16, v16, v16 row_ror:1 row_mask:0xf bank_mask:0xf
v_add_f32_dpp v17, v17, v17 row_ror:1 row_mask:0xf bank_mask:0xf
v_add_f32_dpp v18, v18, v18 row_ror:1 row_mask:0xf bank_mask:0xf
v_add_f32_dpp v19, v19, v19 row_ror:1 row_mask:0xf bank_mask:0xf
v_max3_f32 v20, v16, v17, v18
v_max3_f32 v20, v20, v19, v6
v_mov_b32 v21, v20
s_nop 1
v_permlane16_swap_b32 v20, v21
v_max_f32 v20, v20, v21
v_mov_b32 v21, v20
s_nop 1
v_permlane32_swap_b32 v20, v21
v_max_f32 v20, v20, v21
v_sub_f32 v21, v6, v20
v_mul_f32 v21, s44, v21
v_exp_f32 v21, v21
v_mul_f32 v22, s44, v20
v_mov_b32 v6, v20
v_fma_f32 v16, v16, s44, -v22
v_fma_f32 v17, v17, s44, -v22
v_fma_f32 v18, v18, s44, -v22
v_fma_f32 v19, v19, s44, -v22
v_exp_f32 v16, v16
v_exp_f32 v17, v17
v_exp_f32 v18, v18
v_exp_f32 v19, v19
v_mul_f32 v7, v7, v21
v_mul_f32 v8, v8, v21
v_mul_f32 v9, v9, v21
v_mul_f32 v10, v10, v21
v_mul_f32 v11, v11, v21
v_add_f32 v7, v7, v16
v_add_f32 v7, v7, v17
v_add_f32 v7, v7, v18
v_add_f32 v7, v7, v19
v_cvt_pk_bf16_f32 v16, v16, v16
v_cvt_pk_bf16_f32 v17, v17, v17
v_cvt_pk_bf16_f32 v18, v18, v18
v_cvt_pk_bf16_f32 v19, v19, v19
s_waitcnt lgkmcnt(0)
v_and_b32 v20, v12, v16
v_and_b32 v21, v13, v16
v_and_b32 v22, v14, v16
v_and_b32 v23, v15, v16
s_nop 1
v_mfma_f32_16x16x32_bf16 v[8:11], v[20:23], v[24:27], v[8:11]
s_waitcnt lgkmcnt(0)
v_and_b32 v20, v12, v17
v_and_b32 v21, v13, v17
v_and_b32 v22, v14, v17
v_and_b32 v23, v15, v17
s_nop 1
v_mfma_f32_16x16x32_bf16 v[8:11], v[20:23], v[28:31], v[8:11]
v_and_b32 v20, v12, v18
v_and_b32 v21, v13, v18
v_and_b32 v22, v14, v18
v_and_b32 v23, v15, v18
s_nop 1
v_mfma_f32_16x16x32_bf16 v[8:11], v[20:23], v[108:111], v[8:11]
v_and_b32 v20, v12, v19
v_and_b32 v21, v13, v19
v_and_b32 v22, v14, v19
v_and_b32 v23, v15, v19
s_nop 1
v_mfma_f32_16x16x32_bf16 v[8:11], v[20:23], v[112:115], v[8:11]
s_nop 7
s_waitcnt vmcnt(4)
s_mov_b32 s46, 16384
buffer_load_dwordx4 v[96:99], v0, s[36:39], s46 offen nt
s_waitcnt vmcnt(4)
s_mov_b32 s46, 17408
buffer_load_dwordx4 v[100:103], v0, s[36:39], s46 offen nt
s_waitcnt vmcnt(4)
s_mov_b32 s46, 18432
buffer_load_dwordx4 v[104:107], v0, s[36:39], s46 offen nt
s_waitcnt vmcnt(4)
s_mov_b32 s46, 16384
buffer_load_dwordx4 v[132:135], v0, s[40:43], s46 offen nt
s_waitcnt vmcnt(4)
s_mov_b32 s46, 17408
buffer_load_dwordx4 v[136:139], v0, s[40:43], s46 offen nt
s_waitcnt vmcnt(4)
s_mov_b32 s46, 18432
buffer_load_dwordx4 v[140:143], v0, s[40:43], s46 offen nt
v_dot2_f32_bf16 v16, v80, v2, 0
v_dot2_f32_bf16 v17, v84, v2, 0
v_dot2_f32_bf16 v18, v88, v2, 0
v_dot2_f32_bf16 v19, v92, v2, 0
v_dot2_f32_bf16 v16, v81, v3, v16
v_dot2_f32_bf16 v17, v85, v3, v17
v_dot2_f32_bf16 v18, v89, v3, v18
v_dot2_f32_bf16 v19, v93, v3, v19
v_dot2_f32_bf16 v16, v82, v4, v16
v_dot2_f32_bf16 v17, v86, v4, v17
v_dot2_f32_bf16 v18, v90, v4, v18
v_dot2_f32_bf16 v19, v94, v4, v19
v_dot2_f32_bf16 v16, v83, v5, v16
v_dot2_f32_bf16 v17, v87, v5, v17
v_dot2_f32_bf16 v18, v91, v5, v18
v_dot2_f32_bf16 v19, v95, v5, v19
v_add_f32_dpp v16, v16, v16 row_ror:8 row_mask:0xf bank_mask:0xf
v_add_f32_dpp v17, v17, v17 row_ror:8 row_mask:0xf bank_mask:0xf
v_add_f32_dpp v18, v18, v18 row_ror:8 row_mask:0xf bank_mask:0xf
v_add_f32_dpp v19, v19, v19 row_ror:8 row_mask:0xf bank_mask:0xf
v_add_f32_dpp v16, v16, v16 row_ror:4 row_mask:0xf bank_mask:0xf
v_add_f32_dpp v17, v17, v17 row_ror:4 row_mask:0xf bank_mask:0xf
v_add_f32_dpp v18, v18, v18 row_ror:4 row_mask:0xf bank_mask:0xf
v_add_f32_dpp v19, v19, v19 row_ror:4 row_mask:0xf bank_mask:0xf
v_add_f32_dpp v16, v16, v16 row_ror:2 row_mask:0xf bank_mask:0xf
v_add_f32_dpp v17, v17, v17 row_ror:2 row_mask:0xf bank_mask:0xf
v_add_f32_dpp v18, v18, v18 row_ror:2 row_mask:0xf bank_mask:0xf
v_add_f32_dpp v19, v19, v19 row_ror:2 row_mask:0xf bank_mask:0xf
v_add_f32_dpp v16, v16, v16 row_ror:1 row_mask:0xf bank_mask:0xf
v_add_f32_dpp v17, v17, v17 row_ror:1 row_mask:0xf bank_mask:0xf
v_add_f32_dpp v18, v18, v18 row_ror:1 row_mask:0xf bank_mask:0xf
v_add_f32_dpp v19, v19, v19 row_ror:1 row_mask:0xf bank_mask:0xf
v_max3_f32 v20, v16, v17, v18
v_max3_f32 v20, v20, v19, v6
v_mov_b32 v21, v20
s_nop 1
v_permlane16_swap_b32 v20, v21
v_max_f32 v20, v20, v21
v_mov_b32 v21, v20
s_nop 1
v_permlane32_swap_b32 v20, v21
v_max_f32 v20, v20, v21
v_sub_f32 v21, v6, v20
v_mul_f32 v21, s44, v21
v_exp_f32 v21, v21
v_mul_f32 v22, s44, v20
v_mov_b32 v6, v20
v_fma_f32 v16, v16, s44, -v22
v_fma_f32 v17, v17, s44, -v22
v_fma_f32 v18, v18, s44, -v22
v_fma_f32 v19, v19, s44, -v22
v_exp_f32 v16, v16
v_exp_f32 v17, v17
v_exp_f32 v18, v18
v_exp_f32 v19, v19
v_mul_f32 v7, v7, v21
v_mul_f32 v8, v8, v21
v_mul_f32 v9, v9, v21
v_mul_f32 v10, v10, v21
v_mul_f32 v11, v11, v21
v_add_f32 v7, v7, v16
v_add_f32 v7, v7, v17
v_add_f32 v7, v7, v18
v_add_f32 v7, v7, v19
v_cvt_pk_bf16_f32 v16, v16, v16
v_cvt_pk_bf16_f32 v17, v17, v17
v_cvt_pk_bf16_f32 v18, v18, v18
v_cvt_pk_bf16_f32 v19, v19, v19
v_and_b32 v20, v12, v16
v_and_b32 v21, v13, v16
v_and_b32 v22, v14, v16
v_and_b32 v23, v15, v16
s_nop 1
v_mfma_f32_16x16x32_bf16 v[8:11], v[20:23], v[116:119], v[8:11]
v_and_b32 v20, v12, v17
v_and_b32 v21, v13, v17
v_and_b32 v22, v14, v17
v_and_b32 v23, v15, v17
s_nop 1
v_mfma_f32_16x16x32_bf16 v[8:11], v[20:23], v[120:123], v[8:11]
v_and_b32 v20, v12, v18
v_and_b32 v21, v13, v18
v_and_b32 v22, v14, v18
v_and_b32 v23, v15, v18
s_nop 1
v_mfma_f32_16x16x32_bf16 v[8:11], v[20:23], v[124:127], v[8:11]
v_and_b32 v20, v12, v19
v_and_b32 v21, v13, v19
v_and_b32 v22, v14, v19
v_and_b32 v23, v15, v19
s_nop 1
v_mfma_f32_16x16x32_bf16 v[8:11], v[20:23], v[128:131], v[8:11]
s_waitcnt vmcnt(3)
v_dot2_f32_bf16 v16, v96, v2, 0
v_dot2_f32_bf16 v17, v100, v2, 0
v_dot2_f32_bf16 v18, v104, v2, 0
v_dot2_f32_bf16 v16, v97, v3, v16
v_dot2_f32_bf16 v17, v101, v3, v17
v_dot2_f32_bf16 v18, v105, v3, v18
v_dot2_f32_bf16 v16, v98, v4, v16
v_dot2_f32_bf16 v17, v102, v4, v17
v_dot2_f32_bf16 v18, v106, v4, v18
v_dot2_f32_bf16 v16, v99, v5, v16
v_dot2_f32_bf16 v17, v103, v5, v17
v_dot2_f32_bf16 v18, v107, v5, v18
s_add_u32 s3, s53, 8
s_mul_i32 s3, s3, 57344
s_lshl_b32 s4, s2, 8
s_add_u32 s3, s3, s4
s_add_u32 s3, s3, 4194304
v_subrev_u32 v20, s48, v1
v_and_b32 v20, 0xf0, v20
v_add_u32 v20, s3, v20
global_load_dwordx4 v[2:5], v20, s[28:29] sc1
s_waitcnt vmcnt(1)
v_add_f32_dpp v16, v16, v16 row_ror:8 row_mask:0xf bank_mask:0xf
v_add_f32_dpp v17, v17, v17 row_ror:8 row_mask:0xf bank_mask:0xf
v_add_f32_dpp v18, v18, v18 row_ror:8 row_mask:0xf bank_mask:0xf
v_add_f32_dpp v16, v16, v16 row_ror:4 row_mask:0xf bank_mask:0xf
v_add_f32_dpp v17, v17, v17 row_ror:4 row_mask:0xf bank_mask:0xf
v_add_f32_dpp v18, v18, v18 row_ror:4 row_mask:0xf bank_mask:0xf
v_add_f32_dpp v16, v16, v16 row_ror:2 row_mask:0xf bank_mask:0xf
v_add_f32_dpp v17, v17, v17 row_ror:2 row_mask:0xf bank_mask:0xf
v_add_f32_dpp v18, v18, v18 row_ror:2 row_mask:0xf bank_mask:0xf
v_add_f32_dpp v16, v16, v16 row_ror:1 row_mask:0xf bank_mask:0xf
v_add_f32_dpp v17, v17, v17 row_ror:1 row_mask:0xf bank_mask:0xf
v_add_f32_dpp v18, v18, v18 row_ror:1 row_mask:0xf bank_mask:0xf
v_max3_f32 v20, v16, v17, v18
v_max_f32 v20, v20, v6
v_mov_b32 v21, v20
s_nop 1
v_permlane16_swap_b32 v20, v21
v_max_f32 v20, v20, v21
v_mov_b32 v21, v20
s_nop 1
v_permlane32_swap_b32 v20, v21
v_max_f32 v20, v20, v21
v_sub_f32 v21, v6, v20
v_mul_f32 v21, s44, v21
v_exp_f32 v21, v21
v_mul_f32 v22, s44, v20
v_mov_b32 v6, v20
v_fma_f32 v16, v16, s44, -v22
v_fma_f32 v17, v17, s44, -v22
v_fma_f32 v18, v18, s44, -v22
v_exp_f32 v16, v16
v_exp_f32 v17, v17
v_exp_f32 v18, v18
v_mul_f32 v7, v7, v21
v_mul_f32 v8, v8, v21
v_mul_f32 v9, v9, v21
v_mul_f32 v10, v10, v21
v_mul_f32 v11, v11, v21
v_add_f32 v7, v7, v16
v_add_f32 v7, v7, v17
v_add_f32 v7, v7, v18
v_cvt_pk_bf16_f32 v16, v16, v16
v_cvt_pk_bf16_f32 v17, v17, v17
v_cvt_pk_bf16_f32 v18, v18, v18
v_and_b32 v20, v12, v16
v_and_b32 v21, v13, v16
v_and_b32 v22, v14, v16
v_and_b32 v23, v15, v16
s_nop 1
v_mfma_f32_16x16x32_bf16 v[8:11], v[20:23], v[132:135], v[8:11]
v_and_b32 v20, v12, v17
v_and_b32 v21, v13, v17
v_and_b32 v22, v14, v17
v_and_b32 v23, v15, v17
s_nop 1
v_mfma_f32_16x16x32_bf16 v[8:11], v[20:23], v[136:139], v[8:11]
v_and_b32 v20, v12, v18
v_and_b32 v21, v13, v18
v_and_b32 v22, v14, v18
v_and_b32 v23, v15, v18
s_nop 1
v_mfma_f32_16x16x32_bf16 v[8:11], v[20:23], v[140:143], v[8:11]
v_mul_f32 v6, s44, v6
v_mov_b32 v16, v7
s_nop 1
v_permlane16_swap_b32 v7, v16
v_add_f32 v7, v7, v16
v_mov_b32 v16, v7
s_nop 1
v_permlane32_swap_b32 v7, v16
v_add_f32 v7, v7, v16
v_subrev_u32 v16, s48, v1
v_and_b32 v17, 0xf0, v16
v_lshlrev_b32 v17, 1, v17
v_lshrrev_b32 v18, 8, v16
v_lshl_add_u32 v17, v18, 4, v17
s_mul_i32 s3, s30, 528
s_add_u32 s3, s3, 143360
v_add_u32 v17, s3, v17
s_mov_b32 exec_hi, 0
ds_write_b128 v17, v[8:11]
s_mov_b64 exec, 1
ds_write_b64 v17, v[6:7] offset:512
s_waitcnt lgkmcnt(0)
v_mov_b32 v18, 160256
v_mov_b32 v19, 1
ds_add_rtn_u32 v20, v18, v19
s_waitcnt lgkmcnt(0)
s_mov_b64 exec, -1
v_readfirstlane_b32 s3, v20
s_nop 0
s_and_b32 s3, s3, 7
s_cmp_lg_u32 s3, 7
s_cbranch_scc1 .L35
v_mov_b32 v10, 143872
ds_read_b64 v[16:17], v10 offset:0
ds_read_b64 v[18:19], v10 offset:528
ds_read_b64 v[20:21], v10 offset:1056
ds_read_b64 v[22:23], v10 offset:1584
ds_read_b64 v[24:25], v10 offset:2112
ds_read_b64 v[26:27], v10 offset:2640
ds_read_b64 v[28:29], v10 offset:3168
ds_read_b64 v[30:31], v10 offset:3696
v_subrev_u32 v11, s48, v1
v_lshrrev_b32 v11, 1, v11
v_add_u32 v10, 143360, v11
s_waitcnt lgkmcnt(0)
v_max3_f32 v6, v16, v18, v20
v_max3_f32 v6, v6, v22, v24
v_max3_f32 v6, v6, v26, v28
v_max_f32 v6, v6, v30
v_mov_b32 v7, 0
v_mov_b32 v8, 0
v_mov_b32 v9, 0
v_sub_f32 v16, v16, v6
v_exp_f32 v16, v16
v_sub_f32 v18, v18, v6
v_exp_f32 v18, v18
v_sub_f32 v20, v20, v6
v_exp_f32 v20, v20
v_sub_f32 v22, v22, v6
v_exp_f32 v22, v22
v_sub_f32 v24, v24, v6
v_exp_f32 v24, v24
v_sub_f32 v26, v26, v6
v_exp_f32 v26, v26
v_sub_f32 v28, v28, v6
v_exp_f32 v28, v28
v_sub_f32 v30, v30, v6
v_exp_f32 v30, v30
v_fmac_f32 v7, v16, v17
v_fmac_f32 v7, v18, v19
v_fmac_f32 v7, v20, v21
v_fmac_f32 v7, v22, v23
v_fmac_f32 v7, v24, v25
v_fmac_f32 v7, v26, v27
v_fmac_f32 v7, v28, v29
v_fmac_f32 v7, v30, v31
v_mov_b32 v17, v18
v_mov_b32 v18, v20
v_mov_b32 v19, v22
v_mov_b32 v20, v24
v_mov_b32 v21, v26
v_mov_b32 v22, v28
v_mov_b32 v23, v30
ds_read_b64 v[24:25], v10 offset:0
ds_read_b64 v[26:27], v10 offset:528
ds_read_b64 v[28:29], v10 offset:1056
ds_read_b64 v[30:31], v10 offset:1584
s_waitcnt lgkmcnt(0)
v_fmac_f32 v8, v16, v24
v_fmac_f32 v9, v16, v25
v_fmac_f32 v8, v17, v26
v_fmac_f32 v9, v17, v27
v_fmac_f32 v8, v18, v28
v_fmac_f32 v9, v18, v29
v_fmac_f32 v8, v19, v30
v_fmac_f32 v9, v19, v31
ds_read_b64 v[24:25], v10 offset:2112
ds_read_b64 v[26:27], v10 offset:2640
ds_read_b64 v[28:29], v10 offset:3168
ds_read_b64 v[30:31], v10 offset:3696
s_waitcnt lgkmcnt(0)
v_fmac_f32 v8, v20, v24
v_fmac_f32 v9, v20, v25
v_fmac_f32 v8, v21, v26
v_fmac_f32 v9, v21, v27
v_fmac_f32 v8, v22, v28
v_fmac_f32 v9, v22, v29
v_fmac_f32 v8, v23, v30
v_fmac_f32 v9, v23, v31
v_min_u32 v6, 0xfffffffe, v6
v_min_u32 v7, 0xfffffffe, v7
v_min_u32 v8, 0xfffffffe, v8
v_min_u32 v9, 0xfffffffe, v9
s_add_u32 s3, s52, 0
s_mul_i32 s3, s3, 224
s_add_u32 s3, s3, s2
s_mul_i32 s3, s3, 528
v_add_u32 v11, s3, v11
global_store_dwordx2 v11, v[8:9], s[28:29] offset:0 sc1
s_mov_b64 exec, 1
global_store_dwordx2 v11, v[6:7], s[28:29] offset:512 sc1
s_mov_b64 exec, -1
.L35:
s_nop 4
s_add_u32 s36, s36, 0x2000000
s_addc_u32 s37, s37, 0
s_add_u32 s40, s40, 0x2000000
s_addc_u32 s41, s41, 0
.L28:
s_nop 4
s_add_u32 s51, s51, 1
s_cmp_ge_u32 s51, 6
s_cselect_b32 s54, 1, 0
s_add_u32 s52, s51, 2
s_add_u32 s53, s51, 1
s_waitcnt vmcnt(0)
s_branch .L38
.L36:
s_nop 4
s_add_u32 s3, s51, 8
s_mul_i32 s3, s3, 57344
s_lshl_b32 s4, s2, 8
s_add_u32 s3, s3, s4
s_add_u32 s3, s3, 4194304
v_subrev_u32 v20, s48, v1
v_and_b32 v20, 0xf0, v20
v_add_u32 v20, s3, v20
global_load_dwordx4 v[2:5], v20, s[28:29] sc1
s_waitcnt vmcnt(0)
.L38:
s_nop 4
v_max3_u32 v17, v2, v3, v4
v_max_u32 v17, v17, v5
v_cmp_eq_u32 vcc, -1, v17
s_nop 0
s_cmp_eq_u64 vcc, 0
s_cbranch_scc1 .L37
s_sleep 2
s_add_u32 s47, s47, 1
s_cmp_lt_u32 s47, 262144
s_cbranch_scc1 .L36
s_endpgm
.L37:
s_nop 4
v_mov_b32 v6, 0xff800000
v_mov_b32 v7, 0
v_mov_b32 v8, 0
v_mov_b32 v9, 0
v_mov_b32 v10, 0
v_mov_b32 v11, 0
v_dot2_f32_bf16 v16, v144, v2, 0
v_dot2_f32_bf16 v17, v148, v2, 0
v_dot2_f32_bf16 v18, v152, v2, 0
v_dot2_f32_bf16 v19, v156, v2, 0
v_dot2_f32_bf16 v16, v145, v3, v16
v_dot2_f32_bf16 v17, v149, v3, v17
v_dot2_f32_bf16 v18, v153, v3, v18
v_dot2_f32_bf16 v19, v157, v3, v19
v_dot2_f32_bf16 v16, v146, v4, v16
v_dot2_f32_bf16 v17, v150, v4, v17
v_dot2_f32_bf16 v18, v154, v4, v18
v_dot2_f32_bf16 v19, v158, v4, v19
v_dot2_f32_bf16 v16, v147, v5, v16
v_dot2_f32_bf16 v17, v151, v5, v17
v_dot2_f32_bf16 v18, v155, v5, v18
v_dot2_f32_bf16 v19, v159, v5, v19
ds_read_b128 v[24:27], v1 offset:10240
ds_read_b128 v[28:31], v1 offset:11264
v_add_f32_dpp v16, v16, v16 row_ror:8 row_mask:0xf bank_mask:0xf
v_add_f32_dpp v17, v17, v17 row_ror:8 row_mask:0xf bank_mask:0xf
v_add_f32_dpp v18, v18, v18 row_ror:8 row_mask:0xf bank_mask:0xf
v_add_f32_dpp v19, v19, v19 row_ror:8 row_mask:0xf bank_mask:0xf
v_add_f32_dpp v16, v16, v16 row_ror:4 row_mask:0xf bank_mask:0xf
v_add_f32_dpp v17, v17, v17 row_ror:4 row_mask:0xf bank_mask:0xf
v_add_f32_dpp v18, v18, v18 row_ror:4 row_mask:0xf bank_mask:0xf
v_add_f32_dpp v19, v19, v19 row_ror:4 row_mask:0xf bank_mask:0xf
v_add_f32_dpp v16, v16, v16 row_ror:2 row_mask:0xf bank_mask:0xf
v_add_f32_dpp v17, v17, v17 row_ror:2 row_mask:0xf bank_mask:0xf
v_add_f32_dpp v18, v18, v18 row_ror:2 row_mask:0xf bank_mask:0xf
v_add_f32_dpp v19, v19, v19 row_ror:2 row_mask:0xf bank_mask:0xf
v_add_f32_dpp v16, v16, v16 row_ror:1 row_mask:0xf bank_mask:0xf
v_add_f32_dpp v17, v17, v17 row_ror:1 row_mask:0xf bank_mask:0xf
v_add_f32_dpp v18, v18, v18 row_ror:1 row_mask:0xf bank_mask:0xf
v_add_f32_dpp v19, v19, v19 row_ror:1 row_mask:0xf bank_mask:0xf
v_max3_f32 v20, v16, v17, v18
v_max3_f32 v20, v20, v19, v6
v_mov_b32 v21, v20
s_nop 1
v_permlane16_swap_b32 v20, v21
v_max_f32 v20, v20, v21
v_mov_b32 v21, v20
s_nop 1
v_permlane32_swap_b32 v20, v21
v_max_f32 v20, v20, v21
v_sub_f32 v21, v6, v20
v_mul_f32 v21, s44, v21
v_exp_f32 v21, v21
v_mul_f32 v22, s44, v20
v_mov_b32 v6, v20
v_fma_f32 v16, v16, s44, -v22
v_fma_f32 v17, v17, s44, -v22
v_fma_f32 v18, v18, s44, -v22
v_fma_f32 v19, v19, s44, -v22
v_exp_f32 v16, v16
v_exp_f32 v17, v17
v_exp_f32 v18, v18
v_exp_f32 v19, v19
v_mul_f32 v7, v7, v21
v_mul_f32 v8, v8, v21
v_mul_f32 v9, v9, v21
v_mul_f32 v10, v10, v21
v_mul_f32 v11, v11, v21
v_add_f32 v7, v7, v16
v_add_f32 v7, v7, v17
v_add_f32 v7, v7, v18
v_add_f32 v7, v7, v19
v_cvt_pk_bf16_f32 v16, v16, v16
v_cvt_pk_bf16_f32 v17, v17, v17
v_cvt_pk_bf16_f32 v18, v18, v18
v_cvt_pk_bf16_f32 v19, v19, v19
s_waitcnt lgkmcnt(0)
v_and_b32 v20, v12, v16
v_and_b32 v21, v13, v16
v_and_b32 v22, v14, v16
v_and_b32 v23, v15, v16
s_nop 1
v_mfma_f32_16x16x32_bf16 v[8:11], v[20:23], v[24:27], v[8:11]
s_nop 7
ds_read_b128 v[24:27], v1 offset:12288
s_waitcnt lgkmcnt(0)
v_and_b32 v20, v12, v17
v_and_b32 v21, v13, v17
v_and_b32 v22, v14, v17
v_and_b32 v23, v15, v17
s_nop 1
v_mfma_f32_16x16x32_bf16 v[8:11], v[20:23], v[28:31], v[8:11]
s_nop 7
ds_read_b128 v[28:31], v1 offset:13312
s_waitcnt lgkmcnt(0)
v_and_b32 v20, v12, v18
v_and_b32 v21, v13, v18
v_and_b32 v22, v14, v18
v_and_b32 v23, v15, v18
s_nop 1
v_mfma_f32_16x16x32_bf16 v[8:11], v[20:23], v[24:27], v[8:11]
s_waitcnt lgkmcnt(0)
v_and_b32 v20, v12, v19
v_and_b32 v21, v13, v19
v_and_b32 v22, v14, v19
v_and_b32 v23, v15, v19
s_nop 1
v_mfma_f32_16x16x32_bf16 v[8:11], v[20:23], v[28:31], v[8:11]
s_cmp_lg_u32 s54, 0
s_cbranch_scc1 .L39
s_nop 7
s_mov_b32 s46, 0
buffer_load_dwordx4 v[144:147], v0, s[36:39], s46 offen nt
s_mov_b32 s46, 1024
buffer_load_dwordx4 v[148:151], v0, s[36:39], s46 offen nt
s_mov_b32 s46, 2048
buffer_load_dwordx4 v[152:155], v0, s[36:39], s46 offen nt
s_mov_b32 s46, 3072
buffer_load_dwordx4 v[156:159], v0, s[36:39], s46 offen nt
s_mov_b32 s46, 0
s_add_u32 s49, s48, 10240
s_mov_b32 m0, s49
s_nop 0
buffer_load_dwordx4 v0, s[40:43], s46 offen nt lds
s_waitcnt vmcnt(4)
s_mov_b32 s46, 1024
s_add_u32 s49, s48, 11264
s_mov_b32 m0, s49
s_nop 0
buffer_load_dwordx4 v0, s[40:43], s46 offen nt lds
s_waitcnt vmcnt(4)
s_mov_b32 s46, 2048
s_add_u32 s49, s48, 12288
s_mov_b32 m0, s49
s_nop 0
buffer_load_dwordx4 v0, s[40:43], s46 offen nt lds
s_waitcnt vmcnt(4)
s_mov_b32 s46, 3072
s_add_u32 s49, s48, 13312
s_mov_b32 m0, s49
s_nop 0
buffer_load_dwordx4 v0, s[40:43], s46 offen nt lds
.L39:
s_nop 4
v_dot2_f32_bf16 v16, v160, v2, 0
v_dot2_f32_bf16 v17, v164, v2, 0
v_dot2_f32_bf16 v18, v168, v2, 0
v_dot2_f32_bf16 v19, v172, v2, 0
v_dot2_f32_bf16 v16, v161, v3, v16
v_dot2_f32_bf16 v17, v165, v3, v17
v_dot2_f32_bf16 v18, v169, v3, v18
v_dot2_f32_bf16 v19, v173, v3, v19
v_dot2_f32_bf16 v16, v162, v4, v16
v_dot2_f32_bf16 v17, v166, v4, v17
v_dot2_f32_bf16 v18, v170, v4, v18
v_dot2_f32_bf16 v19, v174, v4, v19
v_dot2_f32_bf16 v16, v163, v5, v16
v_dot2_f32_bf16 v17, v167, v5, v17
v_dot2_f32_bf16 v18, v171, v5, v18
v_dot2_f32_bf16 v19, v175, v5, v19
ds_read_b128 v[24:27], v1 offset:14336
ds_read_b128 v[28:31], v1 offset:15360
v_add_f32_dpp v16, v16, v16 row_ror:8 row_mask:0xf bank_mask:0xf
v_add_f32_dpp v17, v17, v17 row_ror:8 row_mask:0xf bank_mask:0xf
v_add_f32_dpp v18, v18, v18 row_ror:8 row_mask:0xf bank_mask:0xf
v_add_f32_dpp v19, v19, v19 row_ror:8 row_mask:0xf bank_mask:0xf
v_add_f32_dpp v16, v16, v16 row_ror:4 row_mask:0xf bank_mask:0xf
v_add_f32_dpp v17, v17, v17 row_ror:4 row_mask:0xf bank_mask:0xf
v_add_f32_dpp v18, v18, v18 row_ror:4 row_mask:0xf bank_mask:0xf
v_add_f32_dpp v19, v19, v19 row_ror:4 row_mask:0xf bank_mask:0xf
v_add_f32_dpp v16, v16, v16 row_ror:2 row_mask:0xf bank_mask:0xf
v_add_f32_dpp v17, v17, v17 row_ror:2 row_mask:0xf bank_mask:0xf
v_add_f32_dpp v18, v18, v18 row_ror:2 row_mask:0xf bank_mask:0xf
v_add_f32_dpp v19, v19, v19 row_ror:2 row_mask:0xf bank_mask:0xf
v_add_f32_dpp v16, v16, v16 row_ror:1 row_mask:0xf bank_mask:0xf
v_add_f32_dpp v17, v17, v17 row_ror:1 row_mask:0xf bank_mask:0xf
v_add_f32_dpp v18, v18, v18 row_ror:1 row_mask:0xf bank_mask:0xf
v_add_f32_dpp v19, v19, v19 row_ror:1 row_mask:0xf bank_mask:0xf
v_max3_f32 v20, v16, v17, v18
v_max3_f32 v20, v20, v19, v6
v_mov_b32 v21, v20
s_nop 1
v_permlane16_swap_b32 v20, v21
v_max_f32 v20, v20, v21
v_mov_b32 v21, v20
s_nop 1
v_permlane32_swap_b32 v20, v21
v_max_f32 v20, v20, v21
v_sub_f32 v21, v6, v20
v_mul_f32 v21, s44, v21
v_exp_f32 v21, v21
v_mul_f32 v22, s44, v20
v_mov_b32 v6, v20
v_fma_f32 v16, v16, s44, -v22
v_fma_f32 v17, v17, s44, -v22
v_fma_f32 v18, v18, s44, -v22
v_fma_f32 v19, v19, s44, -v22
v_exp_f32 v16, v16
v_exp_f32 v17, v17
v_exp_f32 v18, v18
v_exp_f32 v19, v19
v_mul_f32 v7, v7, v21
v_mul_f32 v8, v8, v21
v_mul_f32 v9, v9, v21
v_mul_f32 v10, v10, v21
v_mul_f32 v11, v11, v21
v_add_f32 v7, v7, v16
v_add_f32 v7, v7, v17
v_add_f32 v7, v7, v18
v_add_f32 v7, v7, v19
v_cvt_pk_bf16_f32 v16, v16, v16
v_cvt_pk_bf16_f32 v17, v17, v17
v_cvt_pk_bf16_f32 v18, v18, v18
v_cvt_pk_bf16_f32 v19, v19, v19
s_waitcnt lgkmcnt(0)
v_and_b32 v20, v12, v16
v_and_b32 v21, v13, v16
v_and_b32 v22, v14, v16
v_and_b32 v23, v15, v16
s_nop 1
v_mfma_f32_16x16x32_bf16 v[8:11], v[20:23], v[24:27], v[8:11]
s_nop 7
ds_read_b128 v[24:27], v1 offset:16384
s_waitcnt lgkmcnt(0)
v_and_b32 v20, v12, v17
v_and_b32 v21, v13, v17
v_and_b32 v22, v14, v17
v_and_b32 v23, v15, v17
s_nop 1
v_mfma_f32_16x16x32_bf16 v[8:11], v[20:23], v[28:31], v[8:11]
s_nop 7
ds_read_b128 v[28:31], v1 offset:17408
s_waitcnt lgkmcnt(0)
v_and_b32 v20, v12, v18
v_and_b32 v21, v13, v18
v_and_b32 v22, v14, v18
v_and_b32 v23, v15, v18
s_nop 1
v_mfma_f32_16x16x32_bf16 v[8:11], v[20:23], v[24:27], v[8:11]
s_waitcnt lgkmcnt(0)
v_and_b32 v20, v12, v19
v_and_b32 v21, v13, v19
v_and_b32 v22, v14, v19
v_and_b32 v23, v15, v19
s_nop 1
v_mfma_f32_16x16x32_bf16 v[8:11], v[20:23], v[28:31], v[8:11]
v_dot2_f32_bf16 v16, v176, v2, 0
v_dot2_f32_bf16 v17, v180, v2, 0
v_dot2_f32_bf16 v18, v184, v2, 0
v_dot2_f32_bf16 v19, v188, v2, 0
v_dot2_f32_bf16 v16, v177, v3, v16
v_dot2_f32_bf16 v17, v181, v3, v17
v_dot2_f32_bf16 v18, v185, v3, v18
v_dot2_f32_bf16 v19, v189, v3, v19
v_dot2_f32_bf16 v16, v178, v4, v16
v_dot2_f32_bf16 v17, v182, v4, v17
v_dot2_f32_bf16 v18, v186, v4, v18
v_dot2_f32_bf16 v19, v190, v4, v19
v_dot2_f32_bf16 v16, v179, v5, v16
v_dot2_f32_bf16 v17, v183, v5, v17
v_dot2_f32_bf16 v18, v187, v5, v18
v_dot2_f32_bf16 v19, v191, v5, v19
ds_read_b128 v[24:27], v1 offset:18432
ds_read_b128 v[28:31], v1 offset:19456
v_add_f32_dpp v16, v16, v16 row_ror:8 row_mask:0xf bank_mask:0xf
v_add_f32_dpp v17, v17, v17 row_ror:8 row_mask:0xf bank_mask:0xf
v_add_f32_dpp v18, v18, v18 row_ror:8 row_mask:0xf bank_mask:0xf
v_add_f32_dpp v19, v19, v19 row_ror:8 row_mask:0xf bank_mask:0xf
v_add_f32_dpp v16, v16, v16 row_ror:4 row_mask:0xf bank_mask:0xf
v_add_f32_dpp v17, v17, v17 row_ror:4 row_mask:0xf bank_mask:0xf
v_add_f32_dpp v18, v18, v18 row_ror:4 row_mask:0xf bank_mask:0xf
v_add_f32_dpp v19, v19, v19 row_ror:4 row_mask:0xf bank_mask:0xf
v_add_f32_dpp v16, v16, v16 row_ror:2 row_mask:0xf bank_mask:0xf
v_add_f32_dpp v17, v17, v17 row_ror:2 row_mask:0xf bank_mask:0xf
v_add_f32_dpp v18, v18, v18 row_ror:2 row_mask:0xf bank_mask:0xf
v_add_f32_dpp v19, v19, v19 row_ror:2 row_mask:0xf bank_mask:0xf
v_add_f32_dpp v16, v16, v16 row_ror:1 row_mask:0xf bank_mask:0xf
v_add_f32_dpp v17, v17, v17 row_ror:1 row_mask:0xf bank_mask:0xf
v_add_f32_dpp v18, v18, v18 row_ror:1 row_mask:0xf bank_mask:0xf
v_add_f32_dpp v19, v19, v19 row_ror:1 row_mask:0xf bank_mask:0xf
v_max3_f32 v20, v16, v17, v18
v_max3_f32 v20, v20, v19, v6
v_mov_b32 v21, v20
s_nop 1
v_permlane16_swap_b32 v20, v21
v_max_f32 v20, v20, v21
v_mov_b32 v21, v20
s_nop 1
v_permlane32_swap_b32 v20, v21
v_max_f32 v20, v20, v21
v_sub_f32 v21, v6, v20
v_mul_f32 v21, s44, v21
v_exp_f32 v21, v21
v_mul_f32 v22, s44, v20
v_mov_b32 v6, v20
v_fma_f32 v16, v16, s44, -v22
v_fma_f32 v17, v17, s44, -v22
v_fma_f32 v18, v18, s44, -v22
v_fma_f32 v19, v19, s44, -v22
v_exp_f32 v16, v16
v_exp_f32 v17, v17
v_exp_f32 v18, v18
v_exp_f32 v19, v19
v_mul_f32 v7, v7, v21
v_mul_f32 v8, v8, v21
v_mul_f32 v9, v9, v21
v_mul_f32 v10, v10, v21
v_mul_f32 v11, v11, v21
v_add_f32 v7, v7, v16
v_add_f32 v7, v7, v17
v_add_f32 v7, v7, v18
v_add_f32 v7, v7, v19
v_cvt_pk_bf16_f32 v16, v16, v16
v_cvt_pk_bf16_f32 v17, v17, v17
v_cvt_pk_bf16_f32 v18, v18, v18
v_cvt_pk_bf16_f32 v19, v19, v19
s_waitcnt lgkmcnt(0)
v_and_b32 v20, v12, v16
v_and_b32 v21, v13, v16
v_and_b32 v22, v14, v16
v_and_b32 v23, v15, v16
s_nop 1
v_mfma_f32_16x16x32_bf16 v[8:11], v[20:23], v[24:27], v[8:11]
s_waitcnt lgkmcnt(0)
v_and_b32 v20, v12, v17
v_and_b32 v21, v13, v17
v_and_b32 v22, v14, v17
v_and_b32 v23, v15, v17
s_nop 1
v_mfma_f32_16x16x32_bf16 v[8:11], v[20:23], v[28:31], v[8:11]
v_and_b32 v20, v12, v18
v_and_b32 v21, v13, v18
v_and_b32 v22, v14, v18
v_and_b32 v23, v15, v18
s_nop 1
v_mfma_f32_16x16x32_bf16 v[8:11], v[20:23], v[220:223], v[8:11]
v_and_b32 v20, v12, v19
v_and_b32 v21, v13, v19
v_and_b32 v22, v14, v19
v_and_b32 v23, v15, v19
s_nop 1
v_mfma_f32_16x16x32_bf16 v[8:11], v[20:23], v[224:227], v[8:11]
v_dot2_f32_bf16 v16, v192, v2, 0
v_dot2_f32_bf16 v17, v196, v2, 0
v_dot2_f32_bf16 v18, v200, v2, 0
v_dot2_f32_bf16 v19, v204, v2, 0
v_dot2_f32_bf16 v16, v193, v3, v16
v_dot2_f32_bf16 v17, v197, v3, v17
v_dot2_f32_bf16 v18, v201, v3, v18
v_dot2_f32_bf16 v19, v205, v3, v19
v_dot2_f32_bf16 v16, v194, v4, v16
v_dot2_f32_bf16 v17, v198, v4, v17
v_dot2_f32_bf16 v18, v202, v4, v18
v_dot2_f32_bf16 v19, v206, v4, v19
v_dot2_f32_bf16 v16, v195, v5, v16
v_dot2_f32_bf16 v17, v199, v5, v17
v_dot2_f32_bf16 v18, v203, v5, v18
v_dot2_f32_bf16 v19, v207, v5, v19
v_add_f32_dpp v16, v16, v16 row_ror:8 row_mask:0xf bank_mask:0xf
v_add_f32_dpp v17, v17, v17 row_ror:8 row_mask:0xf bank_mask:0xf
v_add_f32_dpp v18, v18, v18 row_ror:8 row_mask:0xf bank_mask:0xf
v_add_f32_dpp v19, v19, v19 row_ror:8 row_mask:0xf bank_mask:0xf
v_add_f32_dpp v16, v16, v16 row_ror:4 row_mask:0xf bank_mask:0xf
v_add_f32_dpp v17, v17, v17 row_ror:4 row_mask:0xf bank_mask:0xf
v_add_f32_dpp v18, v18, v18 row_ror:4 row_mask:0xf bank_mask:0xf
v_add_f32_dpp v19, v19, v19 row_ror:4 row_mask:0xf bank_mask:0xf
v_add_f32_dpp v16, v16, v16 row_ror:2 row_mask:0xf bank_mask:0xf
v_add_f32_dpp v17, v17, v17 row_ror:2 row_mask:0xf bank_mask:0xf
v_add_f32_dpp v18, v18, v18 row_ror:2 row_mask:0xf bank_mask:0xf
v_add_f32_dpp v19, v19, v19 row_ror:2 row_mask:0xf bank_mask:0xf
v_add_f32_dpp v16, v16, v16 row_ror:1 row_mask:0xf bank_mask:0xf
v_add_f32_dpp v17, v17, v17 row_ror:1 row_mask:0xf bank_mask:0xf
v_add_f32_dpp v18, v18, v18 row_ror:1 row_mask:0xf bank_mask:0xf
v_add_f32_dpp v19, v19, v19 row_ror:1 row_mask:0xf bank_mask:0xf
v_max3_f32 v20, v16, v17, v18
v_max3_f32 v20, v20, v19, v6
v_mov_b32 v21, v20
s_nop 1
v_permlane16_swap_b32 v20, v21
v_max_f32 v20, v20, v21
v_mov_b32 v21, v20
s_nop 1
v_permlane32_swap_b32 v20, v21
v_max_f32 v20, v20, v21
v_sub_f32 v21, v6, v20
v_mul_f32 v21, s44, v21
v_exp_f32 v21, v21
v_mul_f32 v22, s44, v20
v_mov_b32 v6, v20
v_fma_f32 v16, v16, s44, -v22
v_fma_f32 v17, v17, s44, -v22
v_fma_f32 v18, v18, s44, -v22
v_fma_f32 v19, v19, s44, -v22
v_exp_f32 v16, v16
v_exp_f32 v17, v17
v_exp_f32 v18, v18
v_exp_f32 v19, v19
v_mul_f32 v7, v7, v21
v_mul_f32 v8, v8, v21
v_mul_f32 v9, v9, v21
v_mul_f32 v10, v10, v21
v_mul_f32 v11, v11, v21
v_add_f32 v7, v7, v16
v_add_f32 v7, v7, v17
v_add_f32 v7, v7, v18
v_add_f32 v7, v7, v19
v_cvt_pk_bf16_f32 v16, v16, v16
v_cvt_pk_bf16_f32 v17, v17, v17
v_cvt_pk_bf16_f32 v18, v18, v18
v_cvt_pk_bf16_f32 v19, v19, v19
v_and_b32 v20, v12, v16
v_and_b32 v21, v13, v16
v_and_b32 v22, v14, v16
v_and_b32 v23, v15, v16
s_nop 1
v_mfma_f32_16x16x32_bf16 v[8:11], v[20:23], v[228:231], v[8:11]
v_and_b32 v20, v12, v17
v_and_b32 v21, v13, v17
v_and_b32 v22, v14, v17
v_and_b32 v23, v15, v17
s_nop 1
v_mfma_f32_16x16x32_bf16 v[8:11], v[20:23], v[232:235], v[8:11]
v_and_b32 v20, v12, v18
v_and_b32 v21, v13, v18
v_and_b32 v22, v14, v18
v_and_b32 v23, v15, v18
s_nop 1
v_mfma_f32_16x16x32_bf16 v[8:11], v[20:23], v[236:239], v[8:11]
v_and_b32 v20, v12, v19
v_and_b32 v21, v13, v19
v_and_b32 v22, v14, v19
v_and_b32 v23, v15, v19
s_nop 1
v_mfma_f32_16x16x32_bf16 v[8:11], v[20:23], v[240:243], v[8:11]
v_dot2_f32_bf16 v16, v208, v2, 0
v_dot2_f32_bf16 v17, v212, v2, 0
v_dot2_f32_bf16 v18, v216, v2, 0
v_dot2_f32_bf16 v16, v209, v3, v16
v_dot2_f32_bf16 v17, v213, v3, v17
v_dot2_f32_bf16 v18, v217, v3, v18
v_dot2_f32_bf16 v16, v210, v4, v16
v_dot2_f32_bf16 v17, v214, v4, v17
v_dot2_f32_bf16 v18, v218, v4, v18
v_dot2_f32_bf16 v16, v211, v5, v16
v_dot2_f32_bf16 v17, v215, v5, v17
v_dot2_f32_bf16 v18, v219, v5, v18
s_cmp_lg_u32 s54, 0
s_cbranch_scc1 .L40
s_add_u32 s3, s52, 0
s_mul_i32 s3, s3, 57344
s_lshl_b32 s4, s2, 8
s_add_u32 s3, s3, s4
s_add_u32 s3, s3, 4194304
v_subrev_u32 v20, s48, v1
v_and_b32 v20, 0xf0, v20
v_add_u32 v20, s3, v20
s_branch .L41
.L40:
s_nop 4
s_min_u32 s53, s53, 7
s_add_u32 s3, s53, 8
s_mul_i32 s3, s3, 57344
s_lshl_b32 s4, s2, 8
s_add_u32 s3, s3, s4
s_add_u32 s3, s3, 4194304
v_subrev_u32 v20, s48, v1
v_and_b32 v20, 0xf0, v20
v_add_u32 v20, s3, v20
.L41:
s_nop 4
global_load_dwordx4 v[2:5], v20, s[28:29] sc1
v_add_f32_dpp v16, v16, v16 row_ror:8 row_mask:0xf bank_mask:0xf
v_add_f32_dpp v17, v17, v17 row_ror:8 row_mask:0xf bank_mask:0xf
v_add_f32_dpp v18, v18, v18 row_ror:8 row_mask:0xf bank_mask:0xf
v_add_f32_dpp v16, v16, v16 row_ror:4 row_mask:0xf bank_mask:0xf
v_add_f32_dpp v17, v17, v17 row_ror:4 row_mask:0xf bank_mask:0xf
v_add_f32_dpp v18, v18, v18 row_ror:4 row_mask:0xf bank_mask:0xf
v_add_f32_dpp v16, v16, v16 row_ror:2 row_mask:0xf bank_mask:0xf
v_add_f32_dpp v17, v17, v17 row_ror:2 row_mask:0xf bank_mask:0xf
v_add_f32_dpp v18, v18, v18 row_ror:2 row_mask:0xf bank_mask:0xf
v_add_f32_dpp v16, v16, v16 row_ror:1 row_mask:0xf bank_mask:0xf
v_add_f32_dpp v17, v17, v17 row_ror:1 row_mask:0xf bank_mask:0xf
v_add_f32_dpp v18, v18, v18 row_ror:1 row_mask:0xf bank_mask:0xf
v_max3_f32 v20, v16, v17, v18
v_max_f32 v20, v20, v6
v_mov_b32 v21, v20
s_nop 1
v_permlane16_swap_b32 v20, v21
v_max_f32 v20, v20, v21
v_mov_b32 v21, v20
s_nop 1
v_permlane32_swap_b32 v20, v21
v_max_f32 v20, v20, v21
v_sub_f32 v21, v6, v20
v_mul_f32 v21, s44, v21
v_exp_f32 v21, v21
v_mul_f32 v22, s44, v20
v_mov_b32 v6, v20
v_fma_f32 v16, v16, s44, -v22
v_fma_f32 v17, v17, s44, -v22
v_fma_f32 v18, v18, s44, -v22
v_exp_f32 v16, v16
v_exp_f32 v17, v17
v_exp_f32 v18, v18
v_mul_f32 v7, v7, v21
v_mul_f32 v8, v8, v21
v_mul_f32 v9, v9, v21
v_mul_f32 v10, v10, v21
v_mul_f32 v11, v11, v21
v_add_f32 v7, v7, v16
v_add_f32 v7, v7, v17
v_add_f32 v7, v7, v18
v_cvt_pk_bf16_f32 v16, v16, v16
v_cvt_pk_bf16_f32 v17, v17, v17
v_cvt_pk_bf16_f32 v18, v18, v18
v_and_b32 v20, v12, v16
v_and_b32 v21, v13, v16
v_and_b32 v22, v14, v16
v_and_b32 v23, v15, v16
s_nop 1
v_mfma_f32_16x16x32_bf16 v[8:11], v[20:23], v[244:247], v[8:11]
v_and_b32 v20, v12, v17
v_and_b32 v21, v13, v17
v_and_b32 v22, v14, v17
v_and_b32 v23, v15, v17
s_nop 1
v_mfma_f32_16x16x32_bf16 v[8:11], v[20:23], v[248:251], v[8:11]
v_and_b32 v20, v12, v18
v_and_b32 v21, v13, v18
v_and_b32 v22, v14, v18
v_and_b32 v23, v15, v18
s_nop 1
v_mfma_f32_16x16x32_bf16 v[8:11], v[20:23], v[252:255], v[8:11]
s_cmp_lg_u32 s54, 0
s_cbranch_scc1 .L42
s_nop 7
s_waitcnt vmcnt(4)
s_mov_b32 s46, 4096
buffer_load_dwordx4 v[160:163], v0, s[36:39], s46 offen nt
s_waitcnt vmcnt(4)
s_mov_b32 s46, 5120
buffer_load_dwordx4 v[164:167], v0, s[36:39], s46 offen nt
s_waitcnt vmcnt(4)
s_mov_b32 s46, 6144
buffer_load_dwordx4 v[168:171], v0, s[36:39], s46 offen nt
s_waitcnt vmcnt(4)
s_mov_b32 s46, 7168
buffer_load_dwordx4 v[172:175], v0, s[36:39], s46 offen nt
s_waitcnt vmcnt(4)
s_mov_b32 s46, 4096
s_add_u32 s49, s48, 14336
s_mov_b32 m0, s49
s_nop 0
buffer_load_dwordx4 v0, s[40:43], s46 offen nt lds
s_waitcnt vmcnt(4)
s_mov_b32 s46, 5120
s_add_u32 s49, s48, 15360
s_mov_b32 m0, s49
s_nop 0
buffer_load_dwordx4 v0, s[40:43], s46 offen nt lds
s_waitcnt vmcnt(4)
s_mov_b32 s46, 6144
s_add_u32 s49, s48, 16384
s_mov_b32 m0, s49
s_nop 0
buffer_load_dwordx4 v0, s[40:43], s46 offen nt lds
s_waitcnt vmcnt(4)
s_mov_b32 s46, 7168
s_add_u32 s49, s48, 17408
s_mov_b32 m0, s49
s_nop 0
buffer_load_dwordx4 v0, s[40:43], s46 offen nt lds
.L42:
s_nop 4
v_mul_f32 v6, s44, v6
v_mov_b32 v16, v7
s_nop 1
v_permlane16_swap_b32 v7, v16
v_add_f32 v7, v7, v16
v_mov_b32 v16, v7
s_nop 1
v_permlane32_swap_b32 v7, v16
v_add_f32 v7, v7, v16
v_subrev_u32 v16, s48, v1
v_and_b32 v17, 0xf0, v16
v_lshlrev_b32 v17, 1, v17
v_lshrrev_b32 v18, 8, v16
v_lshl_add_u32 v17, v18, 4, v17
s_mul_i32 s3, s30, 528
s_add_u32 s3, s3, 156032
v_add_u32 v17, s3, v17
s_mov_b32 exec_hi, 0
ds_write_b128 v17, v[8:11]
s_mov_b64 exec, 1
ds_write_b64 v17, v[6:7] offset:512
s_waitcnt lgkmcnt(0)
v_mov_b32 v18, 160268
v_mov_b32 v19, 1
ds_add_rtn_u32 v20, v18, v19
s_waitcnt lgkmcnt(0)
s_mov_b64 exec, -1
v_readfirstlane_b32 s3, v20
s_nop 0
s_and_b32 s3, s3, 7
s_cmp_lg_u32 s3, 7
s_cbranch_scc1 .L43
v_mov_b32 v10, 156544
ds_read_b64 v[16:17], v10 offset:0
ds_read_b64 v[18:19], v10 offset:528
ds_read_b64 v[20:21], v10 offset:1056
ds_read_b64 v[22:23], v10 offset:1584
ds_read_b64 v[24:25], v10 offset:2112
ds_read_b64 v[26:27], v10 offset:2640
ds_read_b64 v[28:29], v10 offset:3168
ds_read_b64 v[30:31], v10 offset:3696
v_subrev_u32 v11, s48, v1
v_lshrrev_b32 v11, 1, v11
v_add_u32 v10, 156032, v11
s_waitcnt lgkmcnt(0)
v_max3_f32 v6, v16, v18, v20
v_max3_f32 v6, v6, v22, v24
v_max3_f32 v6, v6, v26, v28
v_max_f32 v6, v6, v30
v_mov_b32 v7, 0
v_mov_b32 v8, 0
v_mov_b32 v9, 0
v_sub_f32 v16, v16, v6
v_exp_f32 v16, v16
v_sub_f32 v18, v18, v6
v_exp_f32 v18, v18
v_sub_f32 v20, v20, v6
v_exp_f32 v20, v20
v_sub_f32 v22, v22, v6
v_exp_f32 v22, v22
v_sub_f32 v24, v24, v6
v_exp_f32 v24, v24
v_sub_f32 v26, v26, v6
v_exp_f32 v26, v26
v_sub_f32 v28, v28, v6
v_exp_f32 v28, v28
v_sub_f32 v30, v30, v6
v_exp_f32 v30, v30
v_fmac_f32 v7, v16, v17
v_fmac_f32 v7, v18, v19
v_fmac_f32 v7, v20, v21
v_fmac_f32 v7, v22, v23
v_fmac_f32 v7, v24, v25
v_fmac_f32 v7, v26, v27
v_fmac_f32 v7, v28, v29
v_fmac_f32 v7, v30, v31
v_mov_b32 v17, v18
v_mov_b32 v18, v20
v_mov_b32 v19, v22
v_mov_b32 v20, v24
v_mov_b32 v21, v26
v_mov_b32 v22, v28
v_mov_b32 v23, v30
ds_read_b64 v[24:25], v10 offset:0
ds_read_b64 v[26:27], v10 offset:528
ds_read_b64 v[28:29], v10 offset:1056
ds_read_b64 v[30:31], v10 offset:1584
s_waitcnt lgkmcnt(0)
v_fmac_f32 v8, v16, v24
v_fmac_f32 v9, v16, v25
v_fmac_f32 v8, v17, v26
v_fmac_f32 v9, v17, v27
v_fmac_f32 v8, v18, v28
v_fmac_f32 v9, v18, v29
v_fmac_f32 v8, v19, v30
v_fmac_f32 v9, v19, v31
ds_read_b64 v[24:25], v10 offset:2112
ds_read_b64 v[26:27], v10 offset:2640
ds_read_b64 v[28:29], v10 offset:3168
ds_read_b64 v[30:31], v10 offset:3696
s_waitcnt lgkmcnt(0)
v_fmac_f32 v8, v20, v24
v_fmac_f32 v9, v20, v25
v_fmac_f32 v8, v21, v26
v_fmac_f32 v9, v21, v27
v_fmac_f32 v8, v22, v28
v_fmac_f32 v9, v22, v29
v_fmac_f32 v8, v23, v30
v_fmac_f32 v9, v23, v31
v_min_u32 v6, 0xfffffffe, v6
v_min_u32 v7, 0xfffffffe, v7
v_min_u32 v8, 0xfffffffe, v8
v_min_u32 v9, 0xfffffffe, v9
s_add_u32 s3, s51, 8
s_mul_i32 s3, s3, 224
s_add_u32 s3, s3, s2
s_mul_i32 s3, s3, 528
v_add_u32 v11, s3, v11
global_store_dwordx2 v11, v[8:9], s[28:29] offset:0 sc1
s_mov_b64 exec, 1
global_store_dwordx2 v11, v[6:7], s[28:29] offset:512 sc1
s_mov_b64 exec, -1
.L43:
s_nop 4
s_cmp_lg_u32 s54, 0
s_cbranch_scc1 .L44
s_branch .L47
.L45:
s_nop 4
s_add_u32 s3, s52, 0
s_mul_i32 s3, s3, 57344
s_lshl_b32 s4, s2, 8
s_add_u32 s3, s3, s4
s_add_u32 s3, s3, 4194304
v_subrev_u32 v20, s48, v1
v_and_b32 v20, 0xf0, v20
v_add_u32 v20, s3, v20
global_load_dwordx4 v[2:5], v20, s[28:29] sc1
s_waitcnt vmcnt(0)
.L47:
s_nop 4
v_max3_u32 v17, v2, v3, v4
v_max_u32 v17, v17, v5
v_cmp_eq_u32 vcc, -1, v17
s_nop 0
s_cmp_eq_u64 vcc, 0
s_cbranch_scc1 .L46
s_sleep 2
s_add_u32 s47, s47, 1
s_cmp_lt_u32 s47, 262144
s_cbranch_scc1 .L45
s_endpgm
.L46:
s_nop 4
v_mov_b32 v6, 0xff800000
v_mov_b32 v7, 0
v_mov_b32 v8, 0
v_mov_b32 v9, 0
v_mov_b32 v10, 0
v_mov_b32 v11, 0
v_dot2_f32_bf16 v16, v144, v2, 0
v_dot2_f32_bf16 v17, v148, v2, 0
v_dot2_f32_bf16 v18, v152, v2, 0
v_dot2_f32_bf16 v19, v156, v2, 0
v_dot2_f32_bf16 v16, v145, v3, v16
v_dot2_f32_bf16 v17, v149, v3, v17
v_dot2_f32_bf16 v18, v153, v3, v18
v_dot2_f32_bf16 v19, v157, v3, v19
v_dot2_f32_bf16 v16, v146, v4, v16
v_dot2_f32_bf16 v17, v150, v4, v17
v_dot2_f32_bf16 v18, v154, v4, v18
v_dot2_f32_bf16 v19, v158, v4, v19
v_dot2_f32_bf16 v16, v147, v5, v16
v_dot2_f32_bf16 v17, v151, v5, v17
v_dot2_f32_bf16 v18, v155, v5, v18
v_dot2_f32_bf16 v19, v159, v5, v19
ds_read_b128 v[24:27], v1 offset:10240
ds_read_b128 v[28:31], v1 offset:11264
v_add_f32_dpp v16, v16, v16 row_ror:8 row_mask:0xf bank_mask:0xf
v_add_f32_dpp v17, v17, v17 row_ror:8 row_mask:0xf bank_mask:0xf
v_add_f32_dpp v18, v18, v18 row_ror:8 row_mask:0xf bank_mask:0xf
v_add_f32_dpp v19, v19, v19 row_ror:8 row_mask:0xf bank_mask:0xf
v_add_f32_dpp v16, v16, v16 row_ror:4 row_mask:0xf bank_mask:0xf
v_add_f32_dpp v17, v17, v17 row_ror:4 row_mask:0xf bank_mask:0xf
v_add_f32_dpp v18, v18, v18 row_ror:4 row_mask:0xf bank_mask:0xf
v_add_f32_dpp v19, v19, v19 row_ror:4 row_mask:0xf bank_mask:0xf
v_add_f32_dpp v16, v16, v16 row_ror:2 row_mask:0xf bank_mask:0xf
v_add_f32_dpp v17, v17, v17 row_ror:2 row_mask:0xf bank_mask:0xf
v_add_f32_dpp v18, v18, v18 row_ror:2 row_mask:0xf bank_mask:0xf
v_add_f32_dpp v19, v19, v19 row_ror:2 row_mask:0xf bank_mask:0xf
v_add_f32_dpp v16, v16, v16 row_ror:1 row_mask:0xf bank_mask:0xf
v_add_f32_dpp v17, v17, v17 row_ror:1 row_mask:0xf bank_mask:0xf
v_add_f32_dpp v18, v18, v18 row_ror:1 row_mask:0xf bank_mask:0xf
v_add_f32_dpp v19, v19, v19 row_ror:1 row_mask:0xf bank_mask:0xf
v_max3_f32 v20, v16, v17, v18
v_max3_f32 v20, v20, v19, v6
v_mov_b32 v21, v20
s_nop 1
v_permlane16_swap_b32 v20, v21
v_max_f32 v20, v20, v21
v_mov_b32 v21, v20
s_nop 1
v_permlane32_swap_b32 v20, v21
v_max_f32 v20, v20, v21
v_sub_f32 v21, v6, v20
v_mul_f32 v21, s44, v21
v_exp_f32 v21, v21
v_mul_f32 v22, s44, v20
v_mov_b32 v6, v20
v_fma_f32 v16, v16, s44, -v22
v_fma_f32 v17, v17, s44, -v22
v_fma_f32 v18, v18, s44, -v22
v_fma_f32 v19, v19, s44, -v22
v_exp_f32 v16, v16
v_exp_f32 v17, v17
v_exp_f32 v18, v18
v_exp_f32 v19, v19
v_mul_f32 v7, v7, v21
v_mul_f32 v8, v8, v21
v_mul_f32 v9, v9, v21
v_mul_f32 v10, v10, v21
v_mul_f32 v11, v11, v21
v_add_f32 v7, v7, v16
v_add_f32 v7, v7, v17
v_add_f32 v7, v7, v18
v_add_f32 v7, v7, v19
v_cvt_pk_bf16_f32 v16, v16, v16
v_cvt_pk_bf16_f32 v17, v17, v17
v_cvt_pk_bf16_f32 v18, v18, v18
v_cvt_pk_bf16_f32 v19, v19, v19
s_waitcnt lgkmcnt(0)
v_and_b32 v20, v12, v16
v_and_b32 v21, v13, v16
v_and_b32 v22, v14, v16
v_and_b32 v23, v15, v16
s_nop 1
v_mfma_f32_16x16x32_bf16 v[8:11], v[20:23], v[24:27], v[8:11]
s_nop 7
ds_read_b128 v[24:27], v1 offset:12288
s_waitcnt lgkmcnt(0)
v_and_b32 v20, v12, v17
v_and_b32 v21, v13, v17
v_and_b32 v22, v14, v17
v_and_b32 v23, v15, v17
s_nop 1
v_mfma_f32_16x16x32_bf16 v[8:11], v[20:23], v[28:31], v[8:11]
s_nop 7
ds_read_b128 v[28:31], v1 offset:13312
s_waitcnt lgkmcnt(0)
v_and_b32 v20, v12, v18
v_and_b32 v21, v13, v18
v_and_b32 v22, v14, v18
v_and_b32 v23, v15, v18
s_nop 1
v_mfma_f32_16x16x32_bf16 v[8:11], v[20:23], v[24:27], v[8:11]
s_waitcnt lgkmcnt(0)
v_and_b32 v20, v12, v19
v_and_b32 v21, v13, v19
v_and_b32 v22, v14, v19
v_and_b32 v23, v15, v19
s_nop 1
v_mfma_f32_16x16x32_bf16 v[8:11], v[20:23], v[28:31], v[8:11]
s_nop 7
s_waitcnt vmcnt(4)
s_mov_b32 s46, 8192
buffer_load_dwordx4 v[176:179], v0, s[36:39], s46 offen nt
s_waitcnt vmcnt(4)
s_mov_b32 s46, 9216
buffer_load_dwordx4 v[180:183], v0, s[36:39], s46 offen nt
s_waitcnt vmcnt(4)
s_mov_b32 s46, 10240
buffer_load_dwordx4 v[184:187], v0, s[36:39], s46 offen nt
s_waitcnt vmcnt(4)
s_mov_b32 s46, 11264
buffer_load_dwordx4 v[188:191], v0, s[36:39], s46 offen nt
s_waitcnt vmcnt(4)
s_mov_b32 s46, 8192
s_add_u32 s49, s48, 18432
s_mov_b32 m0, s49
s_nop 0
buffer_load_dwordx4 v0, s[40:43], s46 offen nt lds
s_waitcnt vmcnt(4)
s_mov_b32 s46, 9216
s_add_u32 s49, s48, 19456
s_mov_b32 m0, s49
s_nop 0
buffer_load_dwordx4 v0, s[40:43], s46 offen nt lds
s_waitcnt vmcnt(4)
s_mov_b32 s46, 10240
buffer_load_dwordx4 v[220:223], v0, s[40:43], s46 offen nt
s_waitcnt vmcnt(4)
s_mov_b32 s46, 11264
buffer_load_dwordx4 v[224:227], v0, s[40:43], s46 offen nt
v_dot2_f32_bf16 v16, v160, v2, 0
v_dot2_f32_bf16 v17, v164, v2, 0
v_dot2_f32_bf16 v18, v168, v2, 0
v_dot2_f32_bf16 v19, v172, v2, 0
v_dot2_f32_bf16 v16, v161, v3, v16
v_dot2_f32_bf16 v17, v165, v3, v17
v_dot2_f32_bf16 v18, v169, v3, v18
v_dot2_f32_bf16 v19, v173, v3, v19
v_dot2_f32_bf16 v16, v162, v4, v16
v_dot2_f32_bf16 v17, v166, v4, v17
v_dot2_f32_bf16 v18, v170, v4, v18
v_dot2_f32_bf16 v19, v174, v4, v19
v_dot2_f32_bf16 v16, v163, v5, v16
v_dot2_f32_bf16 v17, v167, v5, v17
v_dot2_f32_bf16 v18, v171, v5, v18
v_dot2_f32_bf16 v19, v175, v5, v19
ds_read_b128 v[24:27], v1 offset:14336
ds_read_b128 v[28:31], v1 offset:15360
v_add_f32_dpp v16, v16, v16 row_ror:8 row_mask:0xf bank_mask:0xf
v_add_f32_dpp v17, v17, v17 row_ror:8 row_mask:0xf bank_mask:0xf
v_add_f32_dpp v18, v18, v18 row_ror:8 row_mask:0xf bank_mask:0xf
v_add_f32_dpp v19, v19, v19 row_ror:8 row_mask:0xf bank_mask:0xf
v_add_f32_dpp v16, v16, v16 row_ror:4 row_mask:0xf bank_mask:0xf
v_add_f32_dpp v17, v17, v17 row_ror:4 row_mask:0xf bank_mask:0xf
v_add_f32_dpp v18, v18, v18 row_ror:4 row_mask:0xf bank_mask:0xf
v_add_f32_dpp v19, v19, v19 row_ror:4 row_mask:0xf bank_mask:0xf
v_add_f32_dpp v16, v16, v16 row_ror:2 row_mask:0xf bank_mask:0xf
v_add_f32_dpp v17, v17, v17 row_ror:2 row_mask:0xf bank_mask:0xf
v_add_f32_dpp v18, v18, v18 row_ror:2 row_mask:0xf bank_mask:0xf
v_add_f32_dpp v19, v19, v19 row_ror:2 row_mask:0xf bank_mask:0xf
v_add_f32_dpp v16, v16, v16 row_ror:1 row_mask:0xf bank_mask:0xf
v_add_f32_dpp v17, v17, v17 row_ror:1 row_mask:0xf bank_mask:0xf
v_add_f32_dpp v18, v18, v18 row_ror:1 row_mask:0xf bank_mask:0xf
v_add_f32_dpp v19, v19, v19 row_ror:1 row_mask:0xf bank_mask:0xf
v_max3_f32 v20, v16, v17, v18
v_max3_f32 v20, v20, v19, v6
v_mov_b32 v21, v20
s_nop 1
v_permlane16_swap_b32 v20, v21
v_max_f32 v20, v20, v21
v_mov_b32 v21, v20
s_nop 1
v_permlane32_swap_b32 v20, v21
v_max_f32 v20, v20, v21
v_sub_f32 v21, v6, v20
v_mul_f32 v21, s44, v21
v_exp_f32 v21, v21
v_mul_f32 v22, s44, v20
v_mov_b32 v6, v20
v_fma_f32 v16, v16, s44, -v22
v_fma_f32 v17, v17, s44, -v22
v_fma_f32 v18, v18, s44, -v22
v_fma_f32 v19, v19, s44, -v22
v_exp_f32 v16, v16
v_exp_f32 v17, v17
v_exp_f32 v18, v18
v_exp_f32 v19, v19
v_mul_f32 v7, v7, v21
v_mul_f32 v8, v8, v21
v_mul_f32 v9, v9, v21
v_mul_f32 v10, v10, v21
v_mul_f32 v11, v11, v21
v_add_f32 v7, v7, v16
v_add_f32 v7, v7, v17
v_add_f32 v7, v7, v18
v_add_f32 v7, v7, v19
v_cvt_pk_bf16_f32 v16, v16, v16
v_cvt_pk_bf16_f32 v17, v17, v17
v_cvt_pk_bf16_f32 v18, v18, v18
v_cvt_pk_bf16_f32 v19, v19, v19
s_waitcnt lgkmcnt(0)
v_and_b32 v20, v12, v16
v_and_b32 v21, v13, v16
v_and_b32 v22, v14, v16
v_and_b32 v23, v15, v16
s_nop 1
v_mfma_f32_16x16x32_bf16 v[8:11], v[20:23], v[24:27], v[8:11]
s_nop 7
ds_read_b128 v[24:27], v1 offset:16384
s_waitcnt lgkmcnt(0)
v_and_b32 v20, v12, v17
v_and_b32 v21, v13, v17
v_and_b32 v22, v14, v17
v_and_b32 v23, v15, v17
s_nop 1
v_mfma_f32_16x16x32_bf16 v[8:11], v[20:23], v[28:31], v[8:11]
s_nop 7
ds_read_b128 v[28:31], v1 offset:17408
s_waitcnt lgkmcnt(0)
v_and_b32 v20, v12, v18
v_and_b32 v21, v13, v18
v_and_b32 v22, v14, v18
v_and_b32 v23, v15, v18
s_nop 1
v_mfma_f32_16x16x32_bf16 v[8:11], v[20:23], v[24:27], v[8:11]
s_waitcnt lgkmcnt(0)
v_and_b32 v20, v12, v19
v_and_b32 v21, v13, v19
v_and_b32 v22, v14, v19
v_and_b32 v23, v15, v19
s_nop 1
v_mfma_f32_16x16x32_bf16 v[8:11], v[20:23], v[28:31], v[8:11]
s_nop 7
s_waitcnt vmcnt(4)
s_mov_b32 s46, 12288
buffer_load_dwordx4 v[192:195], v0, s[36:39], s46 offen nt
s_waitcnt vmcnt(4)
s_mov_b32 s46, 13312
buffer_load_dwordx4 v[196:199], v0, s[36:39], s46 offen nt
s_waitcnt vmcnt(4)
s_mov_b32 s46, 14336
buffer_load_dwordx4 v[200:203], v0, s[36:39], s46 offen nt
s_waitcnt vmcnt(4)
s_mov_b32 s46, 15360
buffer_load_dwordx4 v[204:207], v0, s[36:39], s46 offen nt
s_waitcnt vmcnt(4)
s_mov_b32 s46, 12288
buffer_load_dwordx4 v[228:231], v0, s[40:43], s46 offen nt
s_waitcnt vmcnt(4)
s_mov_b32 s46, 13312
buffer_load_dwordx4 v[232:235], v0, s[40:43], s46 offen nt
s_waitcnt vmcnt(4)
s_mov_b32 s46, 14336
buffer_load_dwordx4 v[236:239], v0, s[40:43], s46 offen nt
s_waitcnt vmcnt(4)
s_mov_b32 s46, 15360
buffer_load_dwordx4 v[240:243], v0, s[40:43], s46 offen nt
v_dot2_f32_bf16 v16, v176, v2, 0
v_dot2_f32_bf16 v17, v180, v2, 0
v_dot2_f32_bf16 v18, v184, v2, 0
v_dot2_f32_bf16 v19, v188, v2, 0
v_dot2_f32_bf16 v16, v177, v3, v16
v_dot2_f32_bf16 v17, v181, v3, v17
v_dot2_f32_bf16 v18, v185, v3, v18
v_dot2_f32_bf16 v19, v189, v3, v19
v_dot2_f32_bf16 v16, v178, v4, v16
v_dot2_f32_bf16 v17, v182, v4, v17
v_dot2_f32_bf16 v18, v186, v4, v18
v_dot2_f32_bf16 v19, v190, v4, v19
v_dot2_f32_bf16 v16, v179, v5, v16
v_dot2_f32_bf16 v17, v183, v5, v17
v_dot2_f32_bf16 v18, v187, v5, v18
v_dot2_f32_bf16 v19, v191, v5, v19
ds_read_b128 v[24:27], v1 offset:18432
ds_read_b128 v[28:31], v1 offset:19456
v_add_f32_dpp v16, v16, v16 row_ror:8 row_mask:0xf bank_mask:0xf
v_add_f32_dpp v17, v17, v17 row_ror:8 row_mask:0xf bank_mask:0xf
v_add_f32_dpp v18, v18, v18 row_ror:8 row_mask:0xf bank_mask:0xf
v_add_f32_dpp v19, v19, v19 row_ror:8 row_mask:0xf bank_mask:0xf
v_add_f32_dpp v16, v16, v16 row_ror:4 row_mask:0xf bank_mask:0xf
v_add_f32_dpp v17, v17, v17 row_ror:4 row_mask:0xf bank_mask:0xf
v_add_f32_dpp v18, v18, v18 row_ror:4 row_mask:0xf bank_mask:0xf
v_add_f32_dpp v19, v19, v19 row_ror:4 row_mask:0xf bank_mask:0xf
v_add_f32_dpp v16, v16, v16 row_ror:2 row_mask:0xf bank_mask:0xf
v_add_f32_dpp v17, v17, v17 row_ror:2 row_mask:0xf bank_mask:0xf
v_add_f32_dpp v18, v18, v18 row_ror:2 row_mask:0xf bank_mask:0xf
v_add_f32_dpp v19, v19, v19 row_ror:2 row_mask:0xf bank_mask:0xf
v_add_f32_dpp v16, v16, v16 row_ror:1 row_mask:0xf bank_mask:0xf
v_add_f32_dpp v17, v17, v17 row_ror:1 row_mask:0xf bank_mask:0xf
v_add_f32_dpp v18, v18, v18 row_ror:1 row_mask:0xf bank_mask:0xf
v_add_f32_dpp v19, v19, v19 row_ror:1 row_mask:0xf bank_mask:0xf
v_max3_f32 v20, v16, v17, v18
v_max3_f32 v20, v20, v19, v6
v_mov_b32 v21, v20
s_nop 1
v_permlane16_swap_b32 v20, v21
v_max_f32 v20, v20, v21
v_mov_b32 v21, v20
s_nop 1
v_permlane32_swap_b32 v20, v21
v_max_f32 v20, v20, v21
v_sub_f32 v21, v6, v20
v_mul_f32 v21, s44, v21
v_exp_f32 v21, v21
v_mul_f32 v22, s44, v20
v_mov_b32 v6, v20
v_fma_f32 v16, v16, s44, -v22
v_fma_f32 v17, v17, s44, -v22
v_fma_f32 v18, v18, s44, -v22
v_fma_f32 v19, v19, s44, -v22
v_exp_f32 v16, v16
v_exp_f32 v17, v17
v_exp_f32 v18, v18
v_exp_f32 v19, v19
v_mul_f32 v7, v7, v21
v_mul_f32 v8, v8, v21
v_mul_f32 v9, v9, v21
v_mul_f32 v10, v10, v21
v_mul_f32 v11, v11, v21
v_add_f32 v7, v7, v16
v_add_f32 v7, v7, v17
v_add_f32 v7, v7, v18
v_add_f32 v7, v7, v19
v_cvt_pk_bf16_f32 v16, v16, v16
v_cvt_pk_bf16_f32 v17, v17, v17
v_cvt_pk_bf16_f32 v18, v18, v18
v_cvt_pk_bf16_f32 v19, v19, v19
s_waitcnt lgkmcnt(0)
v_and_b32 v20, v12, v16
v_and_b32 v21, v13, v16
v_and_b32 v22, v14, v16
v_and_b32 v23, v15, v16
s_nop 1
v_mfma_f32_16x16x32_bf16 v[8:11], v[20:23], v[24:27], v[8:11]
s_waitcnt lgkmcnt(0)
v_and_b32 v20, v12, v17
v_and_b32 v21, v13, v17
v_and_b32 v22, v14, v17
v_and_b32 v23, v15, v17
s_nop 1
v_mfma_f32_16x16x32_bf16 v[8:11], v[20:23], v[28:31], v[8:11]
v_and_b32 v20, v12, v18
v_and_b32 v21, v13, v18
v_and_b32 v22, v14, v18
v_and_b32 v23, v15, v18
s_nop 1
v_mfma_f32_16x16x32_bf16 v[8:11], v[20:23], v[220:223], v[8:11]
v_and_b32 v20, v12, v19
v_and_b32 v21, v13, v19
v_and_b32 v22, v14, v19
v_and_b32 v23, v15, v19
s_nop 1
v_mfma_f32_16x16x32_bf16 v[8:11], v[20:23], v[224:227], v[8:11]
s_nop 7
s_waitcnt vmcnt(4)
s_mov_b32 s46, 16384
buffer_load_dwordx4 v[208:211], v0, s[36:39], s46 offen nt
s_waitcnt vmcnt(4)
s_mov_b32 s46, 17408
buffer_load_dwordx4 v[212:215], v0, s[36:39], s46 offen nt
s_waitcnt vmcnt(4)
s_mov_b32 s46, 18432
buffer_load_dwordx4 v[216:219], v0, s[36:39], s46 offen nt
s_waitcnt vmcnt(4)
s_mov_b32 s46, 16384
buffer_load_dwordx4 v[244:247], v0, s[40:43], s46 offen nt
s_waitcnt vmcnt(4)
s_mov_b32 s46, 17408
buffer_load_dwordx4 v[248:251], v0, s[40:43], s46 offen nt
s_waitcnt vmcnt(4)
s_mov_b32 s46, 18432
buffer_load_dwordx4 v[252:255], v0, s[40:43], s46 offen nt
v_dot2_f32_bf16 v16, v192, v2, 0
v_dot2_f32_bf16 v17, v196, v2, 0
v_dot2_f32_bf16 v18, v200, v2, 0
v_dot2_f32_bf16 v19, v204, v2, 0
v_dot2_f32_bf16 v16, v193, v3, v16
v_dot2_f32_bf16 v17, v197, v3, v17
v_dot2_f32_bf16 v18, v201, v3, v18
v_dot2_f32_bf16 v19, v205, v3, v19
v_dot2_f32_bf16 v16, v194, v4, v16
v_dot2_f32_bf16 v17, v198, v4, v17
v_dot2_f32_bf16 v18, v202, v4, v18
v_dot2_f32_bf16 v19, v206, v4, v19
v_dot2_f32_bf16 v16, v195, v5, v16
v_dot2_f32_bf16 v17, v199, v5, v17
v_dot2_f32_bf16 v18, v203, v5, v18
v_dot2_f32_bf16 v19, v207, v5, v19
v_add_f32_dpp v16, v16, v16 row_ror:8 row_mask:0xf bank_mask:0xf
v_add_f32_dpp v17, v17, v17 row_ror:8 row_mask:0xf bank_mask:0xf
v_add_f32_dpp v18, v18, v18 row_ror:8 row_mask:0xf bank_mask:0xf
v_add_f32_dpp v19, v19, v19 row_ror:8 row_mask:0xf bank_mask:0xf
v_add_f32_dpp v16, v16, v16 row_ror:4 row_mask:0xf bank_mask:0xf
v_add_f32_dpp v17, v17, v17 row_ror:4 row_mask:0xf bank_mask:0xf
v_add_f32_dpp v18, v18, v18 row_ror:4 row_mask:0xf bank_mask:0xf
v_add_f32_dpp v19, v19, v19 row_ror:4 row_mask:0xf bank_mask:0xf
v_add_f32_dpp v16, v16, v16 row_ror:2 row_mask:0xf bank_mask:0xf
v_add_f32_dpp v17, v17, v17 row_ror:2 row_mask:0xf bank_mask:0xf
v_add_f32_dpp v18, v18, v18 row_ror:2 row_mask:0xf bank_mask:0xf
v_add_f32_dpp v19, v19, v19 row_ror:2 row_mask:0xf bank_mask:0xf
v_add_f32_dpp v16, v16, v16 row_ror:1 row_mask:0xf bank_mask:0xf
v_add_f32_dpp v17, v17, v17 row_ror:1 row_mask:0xf bank_mask:0xf
v_add_f32_dpp v18, v18, v18 row_ror:1 row_mask:0xf bank_mask:0xf
v_add_f32_dpp v19, v19, v19 row_ror:1 row_mask:0xf bank_mask:0xf
v_max3_f32 v20, v16, v17, v18
v_max3_f32 v20, v20, v19, v6
v_mov_b32 v21, v20
s_nop 1
v_permlane16_swap_b32 v20, v21
v_max_f32 v20, v20, v21
v_mov_b32 v21, v20
s_nop 1
v_permlane32_swap_b32 v20, v21
v_max_f32 v20, v20, v21
v_sub_f32 v21, v6, v20
v_mul_f32 v21, s44, v21
v_exp_f32 v21, v21
v_mul_f32 v22, s44, v20
v_mov_b32 v6, v20
v_fma_f32 v16, v16, s44, -v22
v_fma_f32 v17, v17, s44, -v22
v_fma_f32 v18, v18, s44, -v22
v_fma_f32 v19, v19, s44, -v22
v_exp_f32 v16, v16
v_exp_f32 v17, v17
v_exp_f32 v18, v18
v_exp_f32 v19, v19
v_mul_f32 v7, v7, v21
v_mul_f32 v8, v8, v21
v_mul_f32 v9, v9, v21
v_mul_f32 v10, v10, v21
v_mul_f32 v11, v11, v21
v_add_f32 v7, v7, v16
v_add_f32 v7, v7, v17
v_add_f32 v7, v7, v18
v_add_f32 v7, v7, v19
v_cvt_pk_bf16_f32 v16, v16, v16
v_cvt_pk_bf16_f32 v17, v17, v17
v_cvt_pk_bf16_f32 v18, v18, v18
v_cvt_pk_bf16_f32 v19, v19, v19
v_and_b32 v20, v12, v16
v_and_b32 v21, v13, v16
v_and_b32 v22, v14, v16
v_and_b32 v23, v15, v16
s_nop 1
v_mfma_f32_16x16x32_bf16 v[8:11], v[20:23], v[228:231], v[8:11]
v_and_b32 v20, v12, v17
v_and_b32 v21, v13, v17
v_and_b32 v22, v14, v17
v_and_b32 v23, v15, v17
s_nop 1
v_mfma_f32_16x16x32_bf16 v[8:11], v[20:23], v[232:235], v[8:11]
v_and_b32 v20, v12, v18
v_and_b32 v21, v13, v18
v_and_b32 v22, v14, v18
v_and_b32 v23, v15, v18
s_nop 1
v_mfma_f32_16x16x32_bf16 v[8:11], v[20:23], v[236:239], v[8:11]
v_and_b32 v20, v12, v19
v_and_b32 v21, v13, v19
v_and_b32 v22, v14, v19
v_and_b32 v23, v15, v19
s_nop 1
v_mfma_f32_16x16x32_bf16 v[8:11], v[20:23], v[240:243], v[8:11]
s_waitcnt vmcnt(3)
v_dot2_f32_bf16 v16, v208, v2, 0
v_dot2_f32_bf16 v17, v212, v2, 0
v_dot2_f32_bf16 v18, v216, v2, 0
v_dot2_f32_bf16 v16, v209, v3, v16
v_dot2_f32_bf16 v17, v213, v3, v17
v_dot2_f32_bf16 v18, v217, v3, v18
v_dot2_f32_bf16 v16, v210, v4, v16
v_dot2_f32_bf16 v17, v214, v4, v17
v_dot2_f32_bf16 v18, v218, v4, v18
v_dot2_f32_bf16 v16, v211, v5, v16
v_dot2_f32_bf16 v17, v215, v5, v17
v_dot2_f32_bf16 v18, v219, v5, v18
s_add_u32 s3, s53, 8
s_mul_i32 s3, s3, 57344
s_lshl_b32 s4, s2, 8
s_add_u32 s3, s3, s4
s_add_u32 s3, s3, 4194304
v_subrev_u32 v20, s48, v1
v_and_b32 v20, 0xf0, v20
v_add_u32 v20, s3, v20
global_load_dwordx4 v[2:5], v20, s[28:29] sc1
s_waitcnt vmcnt(1)
v_add_f32_dpp v16, v16, v16 row_ror:8 row_mask:0xf bank_mask:0xf
v_add_f32_dpp v17, v17, v17 row_ror:8 row_mask:0xf bank_mask:0xf
v_add_f32_dpp v18, v18, v18 row_ror:8 row_mask:0xf bank_mask:0xf
v_add_f32_dpp v16, v16, v16 row_ror:4 row_mask:0xf bank_mask:0xf
v_add_f32_dpp v17, v17, v17 row_ror:4 row_mask:0xf bank_mask:0xf
v_add_f32_dpp v18, v18, v18 row_ror:4 row_mask:0xf bank_mask:0xf
v_add_f32_dpp v16, v16, v16 row_ror:2 row_mask:0xf bank_mask:0xf
v_add_f32_dpp v17, v17, v17 row_ror:2 row_mask:0xf bank_mask:0xf
v_add_f32_dpp v18, v18, v18 row_ror:2 row_mask:0xf bank_mask:0xf
v_add_f32_dpp v16, v16, v16 row_ror:1 row_mask:0xf bank_mask:0xf
v_add_f32_dpp v17, v17, v17 row_ror:1 row_mask:0xf bank_mask:0xf
v_add_f32_dpp v18, v18, v18 row_ror:1 row_mask:0xf bank_mask:0xf
v_max3_f32 v20, v16, v17, v18
v_max_f32 v20, v20, v6
v_mov_b32 v21, v20
s_nop 1
v_permlane16_swap_b32 v20, v21
v_max_f32 v20, v20, v21
v_mov_b32 v21, v20
s_nop 1
v_permlane32_swap_b32 v20, v21
v_max_f32 v20, v20, v21
v_sub_f32 v21, v6, v20
v_mul_f32 v21, s44, v21
v_exp_f32 v21, v21
v_mul_f32 v22, s44, v20
v_mov_b32 v6, v20
v_fma_f32 v16, v16, s44, -v22
v_fma_f32 v17, v17, s44, -v22
v_fma_f32 v18, v18, s44, -v22
v_exp_f32 v16, v16
v_exp_f32 v17, v17
v_exp_f32 v18, v18
v_mul_f32 v7, v7, v21
v_mul_f32 v8, v8, v21
v_mul_f32 v9, v9, v21
v_mul_f32 v10, v10, v21
v_mul_f32 v11, v11, v21
v_add_f32 v7, v7, v16
v_add_f32 v7, v7, v17
v_add_f32 v7, v7, v18
v_cvt_pk_bf16_f32 v16, v16, v16
v_cvt_pk_bf16_f32 v17, v17, v17
v_cvt_pk_bf16_f32 v18, v18, v18
v_and_b32 v20, v12, v16
v_and_b32 v21, v13, v16
v_and_b32 v22, v14, v16
v_and_b32 v23, v15, v16
s_nop 1
v_mfma_f32_16x16x32_bf16 v[8:11], v[20:23], v[244:247], v[8:11]
v_and_b32 v20, v12, v17
v_and_b32 v21, v13, v17
v_and_b32 v22, v14, v17
v_and_b32 v23, v15, v17
s_nop 1
v_mfma_f32_16x16x32_bf16 v[8:11], v[20:23], v[248:251], v[8:11]
v_and_b32 v20, v12, v18
v_and_b32 v21, v13, v18
v_and_b32 v22, v14, v18
v_and_b32 v23, v15, v18
s_nop 1
v_mfma_f32_16x16x32_bf16 v[8:11], v[20:23], v[252:255], v[8:11]
v_mul_f32 v6, s44, v6
v_mov_b32 v16, v7
s_nop 1
v_permlane16_swap_b32 v7, v16
v_add_f32 v7, v7, v16
v_mov_b32 v16, v7
s_nop 1
v_permlane32_swap_b32 v7, v16
v_add_f32 v7, v7, v16
v_subrev_u32 v16, s48, v1
v_and_b32 v17, 0xf0, v16
v_lshlrev_b32 v17, 1, v17
v_lshrrev_b32 v18, 8, v16
v_lshl_add_u32 v17, v18, 4, v17
s_mul_i32 s3, s30, 528
s_add_u32 s3, s3, 147584
v_add_u32 v17, s3, v17
s_mov_b32 exec_hi, 0
ds_write_b128 v17, v[8:11]
s_mov_b64 exec, 1
ds_write_b64 v17, v[6:7] offset:512
s_waitcnt lgkmcnt(0)
v_mov_b32 v18, 160260
v_mov_b32 v19, 1
ds_add_rtn_u32 v20, v18, v19
s_waitcnt lgkmcnt(0)
s_mov_b64 exec, -1
v_readfirstlane_b32 s3, v20
s_nop 0
s_and_b32 s3, s3, 7
s_cmp_lg_u32 s3, 7
s_cbranch_scc1 .L51
v_mov_b32 v10, 148096
ds_read_b64 v[16:17], v10 offset:0
ds_read_b64 v[18:19], v10 offset:528
ds_read_b64 v[20:21], v10 offset:1056
ds_read_b64 v[22:23], v10 offset:1584
ds_read_b64 v[24:25], v10 offset:2112
ds_read_b64 v[26:27], v10 offset:2640
ds_read_b64 v[28:29], v10 offset:3168
ds_read_b64 v[30:31], v10 offset:3696
v_subrev_u32 v11, s48, v1
v_lshrrev_b32 v11, 1, v11
v_add_u32 v10, 147584, v11
s_waitcnt lgkmcnt(0)
v_max3_f32 v6, v16, v18, v20
v_max3_f32 v6, v6, v22, v24
v_max3_f32 v6, v6, v26, v28
v_max_f32 v6, v6, v30
v_mov_b32 v7, 0
v_mov_b32 v8, 0
v_mov_b32 v9, 0
v_sub_f32 v16, v16, v6
v_exp_f32 v16, v16
v_sub_f32 v18, v18, v6
v_exp_f32 v18, v18
v_sub_f32 v20, v20, v6
v_exp_f32 v20, v20
v_sub_f32 v22, v22, v6
v_exp_f32 v22, v22
v_sub_f32 v24, v24, v6
v_exp_f32 v24, v24
v_sub_f32 v26, v26, v6
v_exp_f32 v26, v26
v_sub_f32 v28, v28, v6
v_exp_f32 v28, v28
v_sub_f32 v30, v30, v6
v_exp_f32 v30, v30
v_fmac_f32 v7, v16, v17
v_fmac_f32 v7, v18, v19
v_fmac_f32 v7, v20, v21
v_fmac_f32 v7, v22, v23
v_fmac_f32 v7, v24, v25
v_fmac_f32 v7, v26, v27
v_fmac_f32 v7, v28, v29
v_fmac_f32 v7, v30, v31
v_mov_b32 v17, v18
v_mov_b32 v18, v20
v_mov_b32 v19, v22
v_mov_b32 v20, v24
v_mov_b32 v21, v26
v_mov_b32 v22, v28
v_mov_b32 v23, v30
ds_read_b64 v[24:25], v10 offset:0
ds_read_b64 v[26:27], v10 offset:528
ds_read_b64 v[28:29], v10 offset:1056
ds_read_b64 v[30:31], v10 offset:1584
s_waitcnt lgkmcnt(0)
v_fmac_f32 v8, v16, v24
v_fmac_f32 v9, v16, v25
v_fmac_f32 v8, v17, v26
v_fmac_f32 v9, v17, v27
v_fmac_f32 v8, v18, v28
v_fmac_f32 v9, v18, v29
v_fmac_f32 v8, v19, v30
v_fmac_f32 v9, v19, v31
ds_read_b64 v[24:25], v10 offset:2112
ds_read_b64 v[26:27], v10 offset:2640
ds_read_b64 v[28:29], v10 offset:3168
ds_read_b64 v[30:31], v10 offset:3696
s_waitcnt lgkmcnt(0)
v_fmac_f32 v8, v20, v24
v_fmac_f32 v9, v20, v25
v_fmac_f32 v8, v21, v26
v_fmac_f32 v9, v21, v27
v_fmac_f32 v8, v22, v28
v_fmac_f32 v9, v22, v29
v_fmac_f32 v8, v23, v30
v_fmac_f32 v9, v23, v31
v_min_u32 v6, 0xfffffffe, v6
v_min_u32 v7, 0xfffffffe, v7
v_min_u32 v8, 0xfffffffe, v8
v_min_u32 v9, 0xfffffffe, v9
s_add_u32 s3, s52, 0
s_mul_i32 s3, s3, 224
s_add_u32 s3, s3, s2
s_mul_i32 s3, s3, 528
v_add_u32 v11, s3, v11
global_store_dwordx2 v11, v[8:9], s[28:29] offset:0 sc1
s_mov_b64 exec, 1
global_store_dwordx2 v11, v[6:7], s[28:29] offset:512 sc1
s_mov_b64 exec, -1
.L51:
s_nop 4
s_add_u32 s36, s36, 0x2000000
s_addc_u32 s37, s37, 0
s_add_u32 s40, s40, 0x2000000
s_addc_u32 s41, s41, 0
.L44:
s_nop 4
s_add_u32 s51, s51, 1
s_cmp_lt_u32 s51, 8
s_cbranch_scc1 L_loop_a
s_endpgm
L_w7:
s_nop 4
v_mov_b32 v20, 160256
v_mov_b32 v22, 0
v_mov_b32 v23, 0
ds_write_b64 v20, v[22:23]
ds_write_b64 v20, v[22:23] offset:8
v_mov_b32 v24, -1
v_mov_b32 v25, -1
v_mov_b32 v26, -1
v_mov_b32 v27, -1
v_lshrrev_b32 v20, 2, v16
s_mov_b32 s3, 57344
v_mul_lo_u32 v21, v20, s3
v_and_b32 v22, 3, v16
v_lshl_add_u32 v21, v22, 6, v21
s_lshl_b32 s3, s2, 8
s_add_u32 s3, s3, 4194304
v_add_u32 v21, s3, v21
global_store_dwordx4 v21, v[24:27], s[28:29] offset:0 sc1
global_store_dwordx4 v21, v[24:27], s[28:29] offset:16 sc1
global_store_dwordx4 v21, v[24:27], s[28:29] offset:32 sc1
global_store_dwordx4 v21, v[24:27], s[28:29] offset:48 sc1
s_mov_b32 s3, 118272
s_nop 0
v_mul_lo_u32 v21, v20, s3
s_mul_i32 s3, s2, 528
v_add_u32 v21, s3, v21
v_add_u32 v23, 0, v22
v_min_u32 v23, 32, v23
v_lshl_add_u32 v23, v23, 4, v21
global_store_dwordx4 v23, v[24:27], s[28:29] offset:0 sc1
s_nop 1
v_add_u32 v23, 4, v22
v_min_u32 v23, 32, v23
v_lshl_add_u32 v23, v23, 4, v21
global_store_dwordx4 v23, v[24:27], s[28:29] offset:0 sc1
s_nop 1
v_add_u32 v23, 8, v22
v_min_u32 v23, 32, v23
v_lshl_add_u32 v23, v23, 4, v21
global_store_dwordx4 v23, v[24:27], s[28:29] offset:0 sc1
s_nop 1
v_add_u32 v23, 12, v22
v_min_u32 v23, 32, v23
v_lshl_add_u32 v23, v23, 4, v21
global_store_dwordx4 v23, v[24:27], s[28:29] offset:0 sc1
s_nop 1
v_add_u32 v23, 16, v22
v_min_u32 v23, 32, v23
v_lshl_add_u32 v23, v23, 4, v21
global_store_dwordx4 v23, v[24:27], s[28:29] offset:0 sc1
s_nop 1
v_add_u32 v23, 20, v22
v_min_u32 v23, 32, v23
v_lshl_add_u32 v23, v23, 4, v21
global_store_dwordx4 v23, v[24:27], s[28:29] offset:0 sc1
s_nop 1
v_add_u32 v23, 24, v22
v_min_u32 v23, 32, v23
v_lshl_add_u32 v23, v23, 4, v21
global_store_dwordx4 v23, v[24:27], s[28:29] offset:0 sc1
s_nop 1
v_add_u32 v23, 28, v22
v_min_u32 v23, 32, v23
v_lshl_add_u32 v23, v23, 4, v21
global_store_dwordx4 v23, v[24:27], s[28:29] offset:0 sc1
s_nop 1
v_add_u32 v23, 32, v22
v_min_u32 v23, 32, v23
v_lshl_add_u32 v23, v23, 4, v21
global_store_dwordx4 v23, v[24:27], s[28:29] offset:0 sc1
s_waitcnt vmcnt(0)
v_mov_b32 v20, s2
v_mov_b32 v21, 1
s_mov_b64 exec, 1
global_store_byte v20, v21, s[26:27] sc1
s_mov_b64 exec, -1
s_waitcnt lgkmcnt(0)
s_barrier
s_mov_b32 s54, 0
s_nop 7
s_mov_b32 s46, 0
buffer_load_dwordx4 v[32:35], v0, s[36:39], s46 offen nt
s_mov_b32 s46, 1024
buffer_load_dwordx4 v[36:39], v0, s[36:39], s46 offen nt
s_mov_b32 s46, 2048
buffer_load_dwordx4 v[40:43], v0, s[36:39], s46 offen nt
s_mov_b32 s46, 3072
buffer_load_dwordx4 v[44:47], v0, s[36:39], s46 offen nt
s_mov_b32 s46, 0
buffer_load_dwordx4 v[88:91], v0, s[40:43], s46 offen nt
s_waitcnt vmcnt(4)
s_mov_b32 s46, 1024
buffer_load_dwordx4 v[92:95], v0, s[40:43], s46 offen nt
s_waitcnt vmcnt(4)
s_mov_b32 s46, 2048
buffer_load_dwordx4 v[96:99], v0, s[40:43], s46 offen nt
s_waitcnt vmcnt(4)
s_mov_b32 s46, 3072
buffer_load_dwordx4 v[100:103], v0, s[40:43], s46 offen nt
s_nop 7
s_waitcnt vmcnt(4)
s_mov_b32 s46, 4096
buffer_load_dwordx4 v[48:51], v0, s[36:39], s46 offen nt
s_waitcnt vmcnt(4)
s_mov_b32 s46, 5120
buffer_load_dwordx4 v[52:55], v0, s[36:39], s46 offen nt
s_waitcnt vmcnt(4)
s_mov_b32 s46, 6144
buffer_load_dwordx4 v[56:59], v0, s[36:39], s46 offen nt
s_waitcnt vmcnt(4)
s_mov_b32 s46, 7168
buffer_load_dwordx4 v[60:63], v0, s[36:39], s46 offen nt
s_waitcnt vmcnt(4)
s_mov_b32 s46, 4096
buffer_load_dwordx4 v[104:107], v0, s[40:43], s46 offen nt
s_waitcnt vmcnt(4)
s_mov_b32 s46, 5120
buffer_load_dwordx4 v[108:111], v0, s[40:43], s46 offen nt
s_waitcnt vmcnt(4)
s_mov_b32 s46, 6144
buffer_load_dwordx4 v[112:115], v0, s[40:43], s46 offen nt
s_waitcnt vmcnt(4)
s_mov_b32 s46, 7168
buffer_load_dwordx4 v[116:119], v0, s[40:43], s46 offen nt
s_nop 7
s_waitcnt vmcnt(4)
s_mov_b32 s46, 8192
buffer_load_dwordx4 v[64:67], v0, s[36:39], s46 offen nt
s_waitcnt vmcnt(4)
s_mov_b32 s46, 9216
buffer_load_dwordx4 v[68:71], v0, s[36:39], s46 offen nt
s_waitcnt vmcnt(4)
s_mov_b32 s46, 10240
buffer_load_dwordx4 v[72:75], v0, s[36:39], s46 offen nt
s_waitcnt vmcnt(4)
s_mov_b32 s46, 8192
buffer_load_dwordx4 v[120:123], v0, s[40:43], s46 offen nt
s_waitcnt vmcnt(4)
s_mov_b32 s46, 9216
buffer_load_dwordx4 v[124:127], v0, s[40:43], s46 offen nt
s_waitcnt vmcnt(4)
s_mov_b32 s46, 10240
buffer_load_dwordx4 v[128:131], v0, s[40:43], s46 offen nt
s_nop 7
s_waitcnt vmcnt(4)
s_mov_b32 s46, 11264
buffer_load_dwordx4 v[76:79], v0, s[36:39], s46 offen nt
s_waitcnt vmcnt(4)
s_mov_b32 s46, 12288
buffer_load_dwordx4 v[80:83], v0, s[36:39], s46 offen nt
s_waitcnt vmcnt(4)
s_mov_b32 s46, 13312
buffer_load_dwordx4 v[84:87], v0, s[36:39], s46 offen nt
s_waitcnt vmcnt(4)
s_mov_b32 s46, 11264
buffer_load_dwordx4 v[132:135], v0, s[40:43], s46 offen nt
s_waitcnt vmcnt(4)
s_mov_b32 s46, 12288
buffer_load_dwordx4 v[136:139], v0, s[40:43], s46 offen nt
s_waitcnt vmcnt(4)
s_mov_b32 s46, 13312
buffer_load_dwordx4 v[140:143], v0, s[40:43], s46 offen nt
s_mov_b32 s51, 0
s_mov_b32 s52, 1
.L56:
s_nop 4
s_add_u32 s3, s51, 0
s_mul_i32 s3, s3, 57344
s_lshl_b32 s4, s2, 8
s_add_u32 s3, s3, s4
s_add_u32 s3, s3, 4194304
v_subrev_u32 v20, s48, v1
v_and_b32 v20, 0xf0, v20
v_add_u32 v20, s3, v20
global_load_dwordx4 v[2:5], v20, s[28:29] sc1
s_waitcnt vmcnt(0)
.L58:
s_nop 4
v_max3_u32 v17, v2, v3, v4
v_max_u32 v17, v17, v5
v_cmp_eq_u32 vcc, -1, v17
s_nop 0
s_cmp_eq_u64 vcc, 0
s_cbranch_scc1 .L57
s_sleep 2
s_add_u32 s47, s47, 1
s_cmp_lt_u32 s47, 262144
s_cbranch_scc1 .L56
s_endpgm
.L57:
s_nop 4
v_mov_b32 v6, 0xff800000
v_mov_b32 v7, 0
v_mov_b32 v8, 0
v_mov_b32 v9, 0
v_mov_b32 v10, 0
v_mov_b32 v11, 0
v_dot2_f32_bf16 v16, v32, v2, 0
v_dot2_f32_bf16 v17, v36, v2, 0
v_dot2_f32_bf16 v18, v40, v2, 0
v_dot2_f32_bf16 v19, v44, v2, 0
v_dot2_f32_bf16 v16, v33, v3, v16
v_dot2_f32_bf16 v17, v37, v3, v17
v_dot2_f32_bf16 v18, v41, v3, v18
v_dot2_f32_bf16 v19, v45, v3, v19
v_dot2_f32_bf16 v16, v34, v4, v16
v_dot2_f32_bf16 v17, v38, v4, v17
v_dot2_f32_bf16 v18, v42, v4, v18
v_dot2_f32_bf16 v19, v46, v4, v19
v_dot2_f32_bf16 v16, v35, v5, v16
v_dot2_f32_bf16 v17, v39, v5, v17
v_dot2_f32_bf16 v18, v43, v5, v18
v_dot2_f32_bf16 v19, v47, v5, v19
v_add_f32_dpp v16, v16, v16 row_ror:8 row_mask:0xf bank_mask:0xf
v_add_f32_dpp v17, v17, v17 row_ror:8 row_mask:0xf bank_mask:0xf
v_add_f32_dpp v18, v18, v18 row_ror:8 row_mask:0xf bank_mask:0xf
v_add_f32_dpp v19, v19, v19 row_ror:8 row_mask:0xf bank_mask:0xf
v_add_f32_dpp v16, v16, v16 row_ror:4 row_mask:0xf bank_mask:0xf
v_add_f32_dpp v17, v17, v17 row_ror:4 row_mask:0xf bank_mask:0xf
v_add_f32_dpp v18, v18, v18 row_ror:4 row_mask:0xf bank_mask:0xf
v_add_f32_dpp v19, v19, v19 row_ror:4 row_mask:0xf bank_mask:0xf
v_add_f32_dpp v16, v16, v16 row_ror:2 row_mask:0xf bank_mask:0xf
v_add_f32_dpp v17, v17, v17 row_ror:2 row_mask:0xf bank_mask:0xf
v_add_f32_dpp v18, v18, v18 row_ror:2 row_mask:0xf bank_mask:0xf
v_add_f32_dpp v19, v19, v19 row_ror:2 row_mask:0xf bank_mask:0xf
v_add_f32_dpp v16, v16, v16 row_ror:1 row_mask:0xf bank_mask:0xf
v_add_f32_dpp v17, v17, v17 row_ror:1 row_mask:0xf bank_mask:0xf
v_add_f32_dpp v18, v18, v18 row_ror:1 row_mask:0xf bank_mask:0xf
v_add_f32_dpp v19, v19, v19 row_ror:1 row_mask:0xf bank_mask:0xf
v_max3_f32 v20, v16, v17, v18
v_max3_f32 v20, v20, v19, v6
v_mov_b32 v21, v20
s_nop 1
v_permlane16_swap_b32 v20, v21
v_max_f32 v20, v20, v21
v_mov_b32 v21, v20
s_nop 1
v_permlane32_swap_b32 v20, v21
v_max_f32 v20, v20, v21
v_sub_f32 v21, v6, v20
v_mul_f32 v21, s44, v21
v_exp_f32 v21, v21
v_mul_f32 v22, s44, v20
v_mov_b32 v6, v20
v_fma_f32 v16, v16, s44, -v22
v_fma_f32 v17, v17, s44, -v22
v_fma_f32 v18, v18, s44, -v22
v_fma_f32 v19, v19, s44, -v22
v_exp_f32 v16, v16
v_exp_f32 v17, v17
v_exp_f32 v18, v18
v_exp_f32 v19, v19
v_mul_f32 v7, v7, v21
v_mul_f32 v8, v8, v21
v_mul_f32 v9, v9, v21
v_mul_f32 v10, v10, v21
v_mul_f32 v11, v11, v21
v_add_f32 v7, v7, v16
v_add_f32 v7, v7, v17
v_add_f32 v7, v7, v18
v_add_f32 v7, v7, v19
v_cvt_pk_bf16_f32 v16, v16, v16
v_cvt_pk_bf16_f32 v17, v17, v17
v_cvt_pk_bf16_f32 v18, v18, v18
v_cvt_pk_bf16_f32 v19, v19, v19
v_and_b32 v20, v12, v16
v_and_b32 v21, v13, v16
v_and_b32 v22, v14, v16
v_and_b32 v23, v15, v16
s_nop 1
v_mfma_f32_16x16x32_bf16 v[8:11], v[20:23], v[88:91], v[8:11]
v_and_b32 v20, v12, v17
v_and_b32 v21, v13, v17
v_and_b32 v22, v14, v17
v_and_b32 v23, v15, v17
s_nop 1
v_mfma_f32_16x16x32_bf16 v[8:11], v[20:23], v[92:95], v[8:11]
v_and_b32 v20, v12, v18
v_and_b32 v21, v13, v18
v_and_b32 v22, v14, v18
v_and_b32 v23, v15, v18
s_nop 1
v_mfma_f32_16x16x32_bf16 v[8:11], v[20:23], v[96:99], v[8:11]
v_and_b32 v20, v12, v19
v_and_b32 v21, v13, v19
v_and_b32 v22, v14, v19
v_and_b32 v23, v15, v19
s_nop 1
v_mfma_f32_16x16x32_bf16 v[8:11], v[20:23], v[100:103], v[8:11]
v_dot2_f32_bf16 v16, v48, v2, 0
v_dot2_f32_bf16 v17, v52, v2, 0
v_dot2_f32_bf16 v18, v56, v2, 0
v_dot2_f32_bf16 v19, v60, v2, 0
v_dot2_f32_bf16 v16, v49, v3, v16
v_dot2_f32_bf16 v17, v53, v3, v17
v_dot2_f32_bf16 v18, v57, v3, v18
v_dot2_f32_bf16 v19, v61, v3, v19
v_dot2_f32_bf16 v16, v50, v4, v16
v_dot2_f32_bf16 v17, v54, v4, v17
v_dot2_f32_bf16 v18, v58, v4, v18
v_dot2_f32_bf16 v19, v62, v4, v19
v_dot2_f32_bf16 v16, v51, v5, v16
v_dot2_f32_bf16 v17, v55, v5, v17
v_dot2_f32_bf16 v18, v59, v5, v18
v_dot2_f32_bf16 v19, v63, v5, v19
v_add_f32_dpp v16, v16, v16 row_ror:8 row_mask:0xf bank_mask:0xf
v_add_f32_dpp v17, v17, v17 row_ror:8 row_mask:0xf bank_mask:0xf
v_add_f32_dpp v18, v18, v18 row_ror:8 row_mask:0xf bank_mask:0xf
v_add_f32_dpp v19, v19, v19 row_ror:8 row_mask:0xf bank_mask:0xf
v_add_f32_dpp v16, v16, v16 row_ror:4 row_mask:0xf bank_mask:0xf
v_add_f32_dpp v17, v17, v17 row_ror:4 row_mask:0xf bank_mask:0xf
v_add_f32_dpp v18, v18, v18 row_ror:4 row_mask:0xf bank_mask:0xf
v_add_f32_dpp v19, v19, v19 row_ror:4 row_mask:0xf bank_mask:0xf
v_add_f32_dpp v16, v16, v16 row_ror:2 row_mask:0xf bank_mask:0xf
v_add_f32_dpp v17, v17, v17 row_ror:2 row_mask:0xf bank_mask:0xf
v_add_f32_dpp v18, v18, v18 row_ror:2 row_mask:0xf bank_mask:0xf
v_add_f32_dpp v19, v19, v19 row_ror:2 row_mask:0xf bank_mask:0xf
v_add_f32_dpp v16, v16, v16 row_ror:1 row_mask:0xf bank_mask:0xf
v_add_f32_dpp v17, v17, v17 row_ror:1 row_mask:0xf bank_mask:0xf
v_add_f32_dpp v18, v18, v18 row_ror:1 row_mask:0xf bank_mask:0xf
v_add_f32_dpp v19, v19, v19 row_ror:1 row_mask:0xf bank_mask:0xf
v_max3_f32 v20, v16, v17, v18
v_max3_f32 v20, v20, v19, v6
v_mov_b32 v21, v20
s_nop 1
v_permlane16_swap_b32 v20, v21
v_max_f32 v20, v20, v21
v_mov_b32 v21, v20
s_nop 1
v_permlane32_swap_b32 v20, v21
v_max_f32 v20, v20, v21
v_sub_f32 v21, v6, v20
v_mul_f32 v21, s44, v21
v_exp_f32 v21, v21
v_mul_f32 v22, s44, v20
v_mov_b32 v6, v20
v_fma_f32 v16, v16, s44, -v22
v_fma_f32 v17, v17, s44, -v22
v_fma_f32 v18, v18, s44, -v22
v_fma_f32 v19, v19, s44, -v22
v_exp_f32 v16, v16
v_exp_f32 v17, v17
v_exp_f32 v18, v18
v_exp_f32 v19, v19
v_mul_f32 v7, v7, v21
v_mul_f32 v8, v8, v21
v_mul_f32 v9, v9, v21
v_mul_f32 v10, v10, v21
v_mul_f32 v11, v11, v21
v_add_f32 v7, v7, v16
v_add_f32 v7, v7, v17
v_add_f32 v7, v7, v18
v_add_f32 v7, v7, v19
v_cvt_pk_bf16_f32 v16, v16, v16
v_cvt_pk_bf16_f32 v17, v17, v17
v_cvt_pk_bf16_f32 v18, v18, v18
v_cvt_pk_bf16_f32 v19, v19, v19
v_and_b32 v20, v12, v16
v_and_b32 v21, v13, v16
v_and_b32 v22, v14, v16
v_and_b32 v23, v15, v16
s_nop 1
v_mfma_f32_16x16x32_bf16 v[8:11], v[20:23], v[104:107], v[8:11]
v_and_b32 v20, v12, v17
v_and_b32 v21, v13, v17
v_and_b32 v22, v14, v17
v_and_b32 v23, v15, v17
s_nop 1
v_mfma_f32_16x16x32_bf16 v[8:11], v[20:23], v[108:111], v[8:11]
v_and_b32 v20, v12, v18
v_and_b32 v21, v13, v18
v_and_b32 v22, v14, v18
v_and_b32 v23, v15, v18
s_nop 1
v_mfma_f32_16x16x32_bf16 v[8:11], v[20:23], v[112:115], v[8:11]
v_and_b32 v20, v12, v19
v_and_b32 v21, v13, v19
v_and_b32 v22, v14, v19
v_and_b32 v23, v15, v19
s_nop 1
v_mfma_f32_16x16x32_bf16 v[8:11], v[20:23], v[116:119], v[8:11]
v_dot2_f32_bf16 v16, v64, v2, 0
v_dot2_f32_bf16 v17, v68, v2, 0
v_dot2_f32_bf16 v18, v72, v2, 0
v_dot2_f32_bf16 v16, v65, v3, v16
v_dot2_f32_bf16 v17, v69, v3, v17
v_dot2_f32_bf16 v18, v73, v3, v18
v_dot2_f32_bf16 v16, v66, v4, v16
v_dot2_f32_bf16 v17, v70, v4, v17
v_dot2_f32_bf16 v18, v74, v4, v18
v_dot2_f32_bf16 v16, v67, v5, v16
v_dot2_f32_bf16 v17, v71, v5, v17
v_dot2_f32_bf16 v18, v75, v5, v18
s_nop 0
v_add_f32_dpp v16, v16, v16 row_ror:8 row_mask:0xf bank_mask:0xf
v_add_f32_dpp v17, v17, v17 row_ror:8 row_mask:0xf bank_mask:0xf
v_add_f32_dpp v18, v18, v18 row_ror:8 row_mask:0xf bank_mask:0xf
v_add_f32_dpp v16, v16, v16 row_ror:4 row_mask:0xf bank_mask:0xf
v_add_f32_dpp v17, v17, v17 row_ror:4 row_mask:0xf bank_mask:0xf
v_add_f32_dpp v18, v18, v18 row_ror:4 row_mask:0xf bank_mask:0xf
v_add_f32_dpp v16, v16, v16 row_ror:2 row_mask:0xf bank_mask:0xf
v_add_f32_dpp v17, v17, v17 row_ror:2 row_mask:0xf bank_mask:0xf
v_add_f32_dpp v18, v18, v18 row_ror:2 row_mask:0xf bank_mask:0xf
v_add_f32_dpp v16, v16, v16 row_ror:1 row_mask:0xf bank_mask:0xf
v_add_f32_dpp v17, v17, v17 row_ror:1 row_mask:0xf bank_mask:0xf
v_add_f32_dpp v18, v18, v18 row_ror:1 row_mask:0xf bank_mask:0xf
v_add_f32 v17, s45, v17
v_add_f32 v18, s45, v18
v_max3_f32 v20, v16, v17, v18
v_max_f32 v20, v20, v6
v_mov_b32 v21, v20
s_nop 1
v_permlane16_swap_b32 v20, v21
v_max_f32 v20, v20, v21
v_mov_b32 v21, v20
s_nop 1
v_permlane32_swap_b32 v20, v21
v_max_f32 v20, v20, v21
v_sub_f32 v21, v6, v20
v_mul_f32 v21, s44, v21
v_exp_f32 v21, v21
v_mul_f32 v22, s44, v20
v_mov_b32 v6, v20
v_fma_f32 v16, v16, s44, -v22
v_fma_f32 v17, v17, s44, -v22
v_fma_f32 v18, v18, s44, -v22
v_exp_f32 v16, v16
v_exp_f32 v17, v17
v_exp_f32 v18, v18
v_mul_f32 v7, v7, v21
v_mul_f32 v8, v8, v21
v_mul_f32 v9, v9, v21
v_mul_f32 v10, v10, v21
v_mul_f32 v11, v11, v21
v_add_f32 v7, v7, v16
v_add_f32 v7, v7, v17
v_add_f32 v7, v7, v18
v_cvt_pk_bf16_f32 v16, v16, v16
v_cvt_pk_bf16_f32 v17, v17, v17
v_cvt_pk_bf16_f32 v18, v18, v18
v_and_b32 v20, v12, v16
v_and_b32 v21, v13, v16
v_and_b32 v22, v14, v16
v_and_b32 v23, v15, v16
s_nop 1
v_mfma_f32_16x16x32_bf16 v[8:11], v[20:23], v[120:123], v[8:11]
v_and_b32 v20, v12, v17
v_and_b32 v21, v13, v17
v_and_b32 v22, v14, v17
v_and_b32 v23, v15, v17
s_nop 1
v_mfma_f32_16x16x32_bf16 v[8:11], v[20:23], v[124:127], v[8:11]
v_and_b32 v20, v12, v18
v_and_b32 v21, v13, v18
v_and_b32 v22, v14, v18
v_and_b32 v23, v15, v18
s_nop 1
v_mfma_f32_16x16x32_bf16 v[8:11], v[20:23], v[128:131], v[8:11]
v_dot2_f32_bf16 v16, v76, v2, 0
v_dot2_f32_bf16 v17, v80, v2, 0
v_dot2_f32_bf16 v18, v84, v2, 0
v_dot2_f32_bf16 v16, v77, v3, v16
v_dot2_f32_bf16 v17, v81, v3, v17
v_dot2_f32_bf16 v18, v85, v3, v18
v_dot2_f32_bf16 v16, v78, v4, v16
v_dot2_f32_bf16 v17, v82, v4, v17
v_dot2_f32_bf16 v18, v86, v4, v18
v_dot2_f32_bf16 v16, v79, v5, v16
v_dot2_f32_bf16 v17, v83, v5, v17
v_dot2_f32_bf16 v18, v87, v5, v18
s_add_u32 s3, s52, 0
s_mul_i32 s3, s3, 57344
s_lshl_b32 s4, s2, 8
s_add_u32 s3, s3, s4
s_add_u32 s3, s3, 4194304
v_subrev_u32 v20, s48, v1
v_and_b32 v20, 0xf0, v20
v_add_u32 v20, s3, v20
global_load_dwordx4 v[2:5], v20, s[28:29] sc1
v_add_f32_dpp v16, v16, v16 row_ror:8 row_mask:0xf bank_mask:0xf
v_add_f32_dpp v17, v17, v17 row_ror:8 row_mask:0xf bank_mask:0xf
v_add_f32_dpp v18, v18, v18 row_ror:8 row_mask:0xf bank_mask:0xf
v_add_f32_dpp v16, v16, v16 row_ror:4 row_mask:0xf bank_mask:0xf
v_add_f32_dpp v17, v17, v17 row_ror:4 row_mask:0xf bank_mask:0xf
v_add_f32_dpp v18, v18, v18 row_ror:4 row_mask:0xf bank_mask:0xf
v_add_f32_dpp v16, v16, v16 row_ror:2 row_mask:0xf bank_mask:0xf
v_add_f32_dpp v17, v17, v17 row_ror:2 row_mask:0xf bank_mask:0xf
v_add_f32_dpp v18, v18, v18 row_ror:2 row_mask:0xf bank_mask:0xf
v_add_f32_dpp v16, v16, v16 row_ror:1 row_mask:0xf bank_mask:0xf
v_add_f32_dpp v17, v17, v17 row_ror:1 row_mask:0xf bank_mask:0xf
v_add_f32_dpp v18, v18, v18 row_ror:1 row_mask:0xf bank_mask:0xf
v_add_f32 v16, s45, v16
v_add_f32 v17, s45, v17
v_add_f32 v18, s45, v18
v_max3_f32 v20, v16, v17, v18
v_max_f32 v20, v20, v6
v_mov_b32 v21, v20
s_nop 1
v_permlane16_swap_b32 v20, v21
v_max_f32 v20, v20, v21
v_mov_b32 v21, v20
s_nop 1
v_permlane32_swap_b32 v20, v21
v_max_f32 v20, v20, v21
v_sub_f32 v21, v6, v20
v_mul_f32 v21, s44, v21
v_exp_f32 v21, v21
v_mul_f32 v22, s44, v20
v_mov_b32 v6, v20
v_fma_f32 v16, v16, s44, -v22
v_fma_f32 v17, v17, s44, -v22
v_fma_f32 v18, v18, s44, -v22
v_exp_f32 v16, v16
v_exp_f32 v17, v17
v_exp_f32 v18, v18
v_mul_f32 v7, v7, v21
v_mul_f32 v8, v8, v21
v_mul_f32 v9, v9, v21
v_mul_f32 v10, v10, v21
v_mul_f32 v11, v11, v21
v_add_f32 v7, v7, v16
v_add_f32 v7, v7, v17
v_add_f32 v7, v7, v18
v_cvt_pk_bf16_f32 v16, v16, v16
v_cvt_pk_bf16_f32 v17, v17, v17
v_cvt_pk_bf16_f32 v18, v18, v18
v_and_b32 v20, v12, v16
v_and_b32 v21, v13, v16
v_and_b32 v22, v14, v16
v_and_b32 v23, v15, v16
s_nop 1
v_mfma_f32_16x16x32_bf16 v[8:11], v[20:23], v[132:135], v[8:11]
v_and_b32 v20, v12, v17
v_and_b32 v21, v13, v17
v_and_b32 v22, v14, v17
v_and_b32 v23, v15, v17
s_nop 1
v_mfma_f32_16x16x32_bf16 v[8:11], v[20:23], v[136:139], v[8:11]
v_and_b32 v20, v12, v18
v_and_b32 v21, v13, v18
v_and_b32 v22, v14, v18
v_and_b32 v23, v15, v18
s_nop 1
v_mfma_f32_16x16x32_bf16 v[8:11], v[20:23], v[140:143], v[8:11]
v_mul_f32 v6, s44, v6
v_mov_b32 v16, v7
s_nop 1
v_permlane16_swap_b32 v7, v16
v_add_f32 v7, v7, v16
v_mov_b32 v16, v7
s_nop 1
v_permlane32_swap_b32 v7, v16
v_add_f32 v7, v7, v16
v_subrev_u32 v16, s48, v1
v_and_b32 v17, 0xf0, v16
v_lshlrev_b32 v17, 1, v17
v_lshrrev_b32 v18, 8, v16
v_lshl_add_u32 v17, v18, 4, v17
s_mul_i32 s3, s30, 528
s_add_u32 s3, s3, 143360
v_add_u32 v17, s3, v17
s_mov_b32 exec_hi, 0
ds_write_b128 v17, v[8:11]
s_mov_b64 exec, 1
ds_write_b64 v17, v[6:7] offset:512
s_waitcnt lgkmcnt(0)
v_mov_b32 v18, 160256
v_mov_b32 v19, 1
ds_add_rtn_u32 v20, v18, v19
s_waitcnt lgkmcnt(0)
s_mov_b64 exec, -1
v_readfirstlane_b32 s3, v20
s_nop 0
s_and_b32 s3, s3, 7
s_cmp_lg_u32 s3, 7
s_cbranch_scc1 .L59
v_mov_b32 v10, 143872
ds_read_b64 v[16:17], v10 offset:0
ds_read_b64 v[18:19], v10 offset:528
ds_read_b64 v[20:21], v10 offset:1056
ds_read_b64 v[22:23], v10 offset:1584
ds_read_b64 v[24:25], v10 offset:2112
ds_read_b64 v[26:27], v10 offset:2640
ds_read_b64 v[28:29], v10 offset:3168
ds_read_b64 v[30:31], v10 offset:3696
v_subrev_u32 v11, s48, v1
v_lshrrev_b32 v11, 1, v11
v_add_u32 v10, 143360, v11
s_waitcnt lgkmcnt(0)
v_max3_f32 v6, v16, v18, v20
v_max3_f32 v6, v6, v22, v24
v_max3_f32 v6, v6, v26, v28
v_max_f32 v6, v6, v30
v_mov_b32 v7, 0
v_mov_b32 v8, 0
v_mov_b32 v9, 0
v_sub_f32 v16, v16, v6
v_exp_f32 v16, v16
v_sub_f32 v18, v18, v6
v_exp_f32 v18, v18
v_sub_f32 v20, v20, v6
v_exp_f32 v20, v20
v_sub_f32 v22, v22, v6
v_exp_f32 v22, v22
v_sub_f32 v24, v24, v6
v_exp_f32 v24, v24
v_sub_f32 v26, v26, v6
v_exp_f32 v26, v26
v_sub_f32 v28, v28, v6
v_exp_f32 v28, v28
v_sub_f32 v30, v30, v6
v_exp_f32 v30, v30
v_fmac_f32 v7, v16, v17
v_fmac_f32 v7, v18, v19
v_fmac_f32 v7, v20, v21
v_fmac_f32 v7, v22, v23
v_fmac_f32 v7, v24, v25
v_fmac_f32 v7, v26, v27
v_fmac_f32 v7, v28, v29
v_fmac_f32 v7, v30, v31
v_mov_b32 v17, v18
v_mov_b32 v18, v20
v_mov_b32 v19, v22
v_mov_b32 v20, v24
v_mov_b32 v21, v26
v_mov_b32 v22, v28
v_mov_b32 v23, v30
ds_read_b64 v[24:25], v10 offset:0
ds_read_b64 v[26:27], v10 offset:528
ds_read_b64 v[28:29], v10 offset:1056
ds_read_b64 v[30:31], v10 offset:1584
s_waitcnt lgkmcnt(0)
v_fmac_f32 v8, v16, v24
v_fmac_f32 v9, v16, v25
v_fmac_f32 v8, v17, v26
v_fmac_f32 v9, v17, v27
v_fmac_f32 v8, v18, v28
v_fmac_f32 v9, v18, v29
v_fmac_f32 v8, v19, v30
v_fmac_f32 v9, v19, v31
ds_read_b64 v[24:25], v10 offset:2112
ds_read_b64 v[26:27], v10 offset:2640
ds_read_b64 v[28:29], v10 offset:3168
ds_read_b64 v[30:31], v10 offset:3696
s_waitcnt lgkmcnt(0)
v_fmac_f32 v8, v20, v24
v_fmac_f32 v9, v20, v25
v_fmac_f32 v8, v21, v26
v_fmac_f32 v9, v21, v27
v_fmac_f32 v8, v22, v28
v_fmac_f32 v9, v22, v29
v_fmac_f32 v8, v23, v30
v_fmac_f32 v9, v23, v31
v_min_u32 v6, 0xfffffffe, v6
v_min_u32 v7, 0xfffffffe, v7
v_min_u32 v8, 0xfffffffe, v8
v_min_u32 v9, 0xfffffffe, v9
s_add_u32 s3, s51, 0
s_mul_i32 s3, s3, 224
s_add_u32 s3, s3, s2
s_mul_i32 s3, s3, 528
v_add_u32 v11, s3, v11
global_store_dwordx2 v11, v[8:9], s[28:29] offset:0 sc1
s_mov_b64 exec, 1
global_store_dwordx2 v11, v[6:7], s[28:29] offset:512 sc1
s_mov_b64 exec, -1
.L59:
s_nop 4
s_add_u32 s36, s36, 0x2000000
s_addc_u32 s37, s37, 0
s_add_u32 s40, s40, 0x2000000
s_addc_u32 s41, s41, 0
s_nop 7
s_mov_b32 s46, 0
buffer_load_dwordx4 v[144:147], v0, s[36:39], s46 offen nt
s_mov_b32 s46, 1024
buffer_load_dwordx4 v[148:151], v0, s[36:39], s46 offen nt
s_mov_b32 s46, 2048
buffer_load_dwordx4 v[152:155], v0, s[36:39], s46 offen nt
s_mov_b32 s46, 3072
buffer_load_dwordx4 v[156:159], v0, s[36:39], s46 offen nt
s_waitcnt vmcnt(4)
s_mov_b32 s46, 0
buffer_load_dwordx4 v[200:203], v0, s[40:43], s46 offen nt
s_waitcnt vmcnt(4)
s_mov_b32 s46, 1024
buffer_load_dwordx4 v[204:207], v0, s[40:43], s46 offen nt
s_waitcnt vmcnt(4)
s_mov_b32 s46, 2048
buffer_load_dwordx4 v[208:211], v0, s[40:43], s46 offen nt
s_waitcnt vmcnt(4)
s_mov_b32 s46, 3072
buffer_load_dwordx4 v[212:215], v0, s[40:43], s46 offen nt
s_nop 7
s_waitcnt vmcnt(4)
s_mov_b32 s46, 4096
buffer_load_dwordx4 v[160:163], v0, s[36:39], s46 offen nt
s_waitcnt vmcnt(4)
s_mov_b32 s46, 5120
buffer_load_dwordx4 v[164:167], v0, s[36:39], s46 offen nt
s_waitcnt vmcnt(4)
s_mov_b32 s46, 6144
buffer_load_dwordx4 v[168:171], v0, s[36:39], s46 offen nt
s_waitcnt vmcnt(4)
s_mov_b32 s46, 7168
buffer_load_dwordx4 v[172:175], v0, s[36:39], s46 offen nt
s_waitcnt vmcnt(4)
s_mov_b32 s46, 4096
buffer_load_dwordx4 v[216:219], v0, s[40:43], s46 offen nt
s_waitcnt vmcnt(4)
s_mov_b32 s46, 5120
buffer_load_dwordx4 v[220:223], v0, s[40:43], s46 offen nt
s_waitcnt vmcnt(4)
s_mov_b32 s46, 6144
buffer_load_dwordx4 v[224:227], v0, s[40:43], s46 offen nt
s_waitcnt vmcnt(4)
s_mov_b32 s46, 7168
buffer_load_dwordx4 v[228:231], v0, s[40:43], s46 offen nt
s_branch .L64
.L62:
s_nop 4
s_add_u32 s3, s52, 0
s_mul_i32 s3, s3, 57344
s_lshl_b32 s4, s2, 8
s_add_u32 s3, s3, s4
s_add_u32 s3, s3, 4194304
v_subrev_u32 v20, s48, v1
v_and_b32 v20, 0xf0, v20
v_add_u32 v20, s3, v20
global_load_dwordx4 v[2:5], v20, s[28:29] sc1
s_waitcnt vmcnt(0)
.L64:
s_nop 4
v_max3_u32 v17, v2, v3, v4
v_max_u32 v17, v17, v5
v_cmp_eq_u32 vcc, -1, v17
s_nop 0
s_cmp_eq_u64 vcc, 0
s_cbranch_scc1 .L63
s_sleep 2
s_add_u32 s47, s47, 1
s_cmp_lt_u32 s47, 262144
s_cbranch_scc1 .L62
s_endpgm
.L63:
s_nop 4
v_mov_b32 v6, 0xff800000
v_mov_b32 v7, 0
v_mov_b32 v8, 0
v_mov_b32 v9, 0
v_mov_b32 v10, 0
v_mov_b32 v11, 0
v_dot2_f32_bf16 v16, v144, v2, 0
v_dot2_f32_bf16 v17, v148, v2, 0
v_dot2_f32_bf16 v18, v152, v2, 0
v_dot2_f32_bf16 v19, v156, v2, 0
v_dot2_f32_bf16 v16, v145, v3, v16
v_dot2_f32_bf16 v17, v149, v3, v17
v_dot2_f32_bf16 v18, v153, v3, v18
v_dot2_f32_bf16 v19, v157, v3, v19
v_dot2_f32_bf16 v16, v146, v4, v16
v_dot2_f32_bf16 v17, v150, v4, v17
v_dot2_f32_bf16 v18, v154, v4, v18
v_dot2_f32_bf16 v19, v158, v4, v19
v_dot2_f32_bf16 v16, v147, v5, v16
v_dot2_f32_bf16 v17, v151, v5, v17
v_dot2_f32_bf16 v18, v155, v5, v18
v_dot2_f32_bf16 v19, v159, v5, v19
v_add_f32_dpp v16, v16, v16 row_ror:8 row_mask:0xf bank_mask:0xf
v_add_f32_dpp v17, v17, v17 row_ror:8 row_mask:0xf bank_mask:0xf
v_add_f32_dpp v18, v18, v18 row_ror:8 row_mask:0xf bank_mask:0xf
v_add_f32_dpp v19, v19, v19 row_ror:8 row_mask:0xf bank_mask:0xf
v_add_f32_dpp v16, v16, v16 row_ror:4 row_mask:0xf bank_mask:0xf
v_add_f32_dpp v17, v17, v17 row_ror:4 row_mask:0xf bank_mask:0xf
v_add_f32_dpp v18, v18, v18 row_ror:4 row_mask:0xf bank_mask:0xf
v_add_f32_dpp v19, v19, v19 row_ror:4 row_mask:0xf bank_mask:0xf
v_add_f32_dpp v16, v16, v16 row_ror:2 row_mask:0xf bank_mask:0xf
v_add_f32_dpp v17, v17, v17 row_ror:2 row_mask:0xf bank_mask:0xf
v_add_f32_dpp v18, v18, v18 row_ror:2 row_mask:0xf bank_mask:0xf
v_add_f32_dpp v19, v19, v19 row_ror:2 row_mask:0xf bank_mask:0xf
v_add_f32_dpp v16, v16, v16 row_ror:1 row_mask:0xf bank_mask:0xf
v_add_f32_dpp v17, v17, v17 row_ror:1 row_mask:0xf bank_mask:0xf
v_add_f32_dpp v18, v18, v18 row_ror:1 row_mask:0xf bank_mask:0xf
v_add_f32_dpp v19, v19, v19 row_ror:1 row_mask:0xf bank_mask:0xf
v_max3_f32 v20, v16, v17, v18
v_max3_f32 v20, v20, v19, v6
v_mov_b32 v21, v20
s_nop 1
v_permlane16_swap_b32 v20, v21
v_max_f32 v20, v20, v21
v_mov_b32 v21, v20
s_nop 1
v_permlane32_swap_b32 v20, v21
v_max_f32 v20, v20, v21
v_sub_f32 v21, v6, v20
v_mul_f32 v21, s44, v21
v_exp_f32 v21, v21
v_mul_f32 v22, s44, v20
v_mov_b32 v6, v20
v_fma_f32 v16, v16, s44, -v22
v_fma_f32 v17, v17, s44, -v22
v_fma_f32 v18, v18, s44, -v22
v_fma_f32 v19, v19, s44, -v22
v_exp_f32 v16, v16
v_exp_f32 v17, v17
v_exp_f32 v18, v18
v_exp_f32 v19, v19
v_mul_f32 v7, v7, v21
v_mul_f32 v8, v8, v21
v_mul_f32 v9, v9, v21
v_mul_f32 v10, v10, v21
v_mul_f32 v11, v11, v21
v_add_f32 v7, v7, v16
v_add_f32 v7, v7, v17
v_add_f32 v7, v7, v18
v_add_f32 v7, v7, v19
v_cvt_pk_bf16_f32 v16, v16, v16
v_cvt_pk_bf16_f32 v17, v17, v17
v_cvt_pk_bf16_f32 v18, v18, v18
v_cvt_pk_bf16_f32 v19, v19, v19
v_and_b32 v20, v12, v16
v_and_b32 v21, v13, v16
v_and_b32 v22, v14, v16
v_and_b32 v23, v15, v16
s_nop 1
v_mfma_f32_16x16x32_bf16 v[8:11], v[20:23], v[200:203], v[8:11]
v_and_b32 v20, v12, v17
v_and_b32 v21, v13, v17
v_and_b32 v22, v14, v17
v_and_b32 v23, v15, v17
s_nop 1
v_mfma_f32_16x16x32_bf16 v[8:11], v[20:23], v[204:207], v[8:11]
v_and_b32 v20, v12, v18
v_and_b32 v21, v13, v18
v_and_b32 v22, v14, v18
v_and_b32 v23, v15, v18
s_nop 1
v_mfma_f32_16x16x32_bf16 v[8:11], v[20:23], v[208:211], v[8:11]
v_and_b32 v20, v12, v19
v_and_b32 v21, v13, v19
v_and_b32 v22, v14, v19
v_and_b32 v23, v15, v19
s_nop 1
v_mfma_f32_16x16x32_bf16 v[8:11], v[20:23], v[212:215], v[8:11]
s_nop 7
s_waitcnt vmcnt(4)
s_mov_b32 s46, 8192
buffer_load_dwordx4 v[176:179], v0, s[36:39], s46 offen nt
s_waitcnt vmcnt(4)
s_mov_b32 s46, 9216
buffer_load_dwordx4 v[180:183], v0, s[36:39], s46 offen nt
s_waitcnt vmcnt(4)
s_mov_b32 s46, 10240
buffer_load_dwordx4 v[184:187], v0, s[36:39], s46 offen nt
s_waitcnt vmcnt(4)
s_mov_b32 s46, 8192
buffer_load_dwordx4 v[232:235], v0, s[40:43], s46 offen nt
s_waitcnt vmcnt(4)
s_mov_b32 s46, 9216
buffer_load_dwordx4 v[236:239], v0, s[40:43], s46 offen nt
s_waitcnt vmcnt(4)
s_mov_b32 s46, 10240
buffer_load_dwordx4 v[240:243], v0, s[40:43], s46 offen nt
v_dot2_f32_bf16 v16, v160, v2, 0
v_dot2_f32_bf16 v17, v164, v2, 0
v_dot2_f32_bf16 v18, v168, v2, 0
v_dot2_f32_bf16 v19, v172, v2, 0
v_dot2_f32_bf16 v16, v161, v3, v16
v_dot2_f32_bf16 v17, v165, v3, v17
v_dot2_f32_bf16 v18, v169, v3, v18
v_dot2_f32_bf16 v19, v173, v3, v19
v_dot2_f32_bf16 v16, v162, v4, v16
v_dot2_f32_bf16 v17, v166, v4, v17
v_dot2_f32_bf16 v18, v170, v4, v18
v_dot2_f32_bf16 v19, v174, v4, v19
v_dot2_f32_bf16 v16, v163, v5, v16
v_dot2_f32_bf16 v17, v167, v5, v17
v_dot2_f32_bf16 v18, v171, v5, v18
v_dot2_f32_bf16 v19, v175, v5, v19
v_add_f32_dpp v16, v16, v16 row_ror:8 row_mask:0xf bank_mask:0xf
v_add_f32_dpp v17, v17, v17 row_ror:8 row_mask:0xf bank_mask:0xf
v_add_f32_dpp v18, v18, v18 row_ror:8 row_mask:0xf bank_mask:0xf
v_add_f32_dpp v19, v19, v19 row_ror:8 row_mask:0xf bank_mask:0xf
v_add_f32_dpp v16, v16, v16 row_ror:4 row_mask:0xf bank_mask:0xf
v_add_f32_dpp v17, v17, v17 row_ror:4 row_mask:0xf bank_mask:0xf
v_add_f32_dpp v18, v18, v18 row_ror:4 row_mask:0xf bank_mask:0xf
v_add_f32_dpp v19, v19, v19 row_ror:4 row_mask:0xf bank_mask:0xf
v_add_f32_dpp v16, v16, v16 row_ror:2 row_mask:0xf bank_mask:0xf
v_add_f32_dpp v17, v17, v17 row_ror:2 row_mask:0xf bank_mask:0xf
v_add_f32_dpp v18, v18, v18 row_ror:2 row_mask:0xf bank_mask:0xf
v_add_f32_dpp v19, v19, v19 row_ror:2 row_mask:0xf bank_mask:0xf
v_add_f32_dpp v16, v16, v16 row_ror:1 row_mask:0xf bank_mask:0xf
v_add_f32_dpp v17, v17, v17 row_ror:1 row_mask:0xf bank_mask:0xf
v_add_f32_dpp v18, v18, v18 row_ror:1 row_mask:0xf bank_mask:0xf
v_add_f32_dpp v19, v19, v19 row_ror:1 row_mask:0xf bank_mask:0xf
v_max3_f32 v20, v16, v17, v18
v_max3_f32 v20, v20, v19, v6
v_mov_b32 v21, v20
s_nop 1
v_permlane16_swap_b32 v20, v21
v_max_f32 v20, v20, v21
v_mov_b32 v21, v20
s_nop 1
v_permlane32_swap_b32 v20, v21
v_max_f32 v20, v20, v21
v_sub_f32 v21, v6, v20
v_mul_f32 v21, s44, v21
v_exp_f32 v21, v21
v_mul_f32 v22, s44, v20
v_mov_b32 v6, v20
v_fma_f32 v16, v16, s44, -v22
v_fma_f32 v17, v17, s44, -v22
v_fma_f32 v18, v18, s44, -v22
v_fma_f32 v19, v19, s44, -v22
v_exp_f32 v16, v16
v_exp_f32 v17, v17
v_exp_f32 v18, v18
v_exp_f32 v19, v19
v_mul_f32 v7, v7, v21
v_mul_f32 v8, v8, v21
v_mul_f32 v9, v9, v21
v_mul_f32 v10, v10, v21
v_mul_f32 v11, v11, v21
v_add_f32 v7, v7, v16
v_add_f32 v7, v7, v17
v_add_f32 v7, v7, v18
v_add_f32 v7, v7, v19
v_cvt_pk_bf16_f32 v16, v16, v16
v_cvt_pk_bf16_f32 v17, v17, v17
v_cvt_pk_bf16_f32 v18, v18, v18
v_cvt_pk_bf16_f32 v19, v19, v19
v_and_b32 v20, v12, v16
v_and_b32 v21, v13, v16
v_and_b32 v22, v14, v16
v_and_b32 v23, v15, v16
s_nop 1
v_mfma_f32_16x16x32_bf16 v[8:11], v[20:23], v[216:219], v[8:11]
v_and_b32 v20, v12, v17
v_and_b32 v21, v13, v17
v_and_b32 v22, v14, v17
v_and_b32 v23, v15, v17
s_nop 1
v_mfma_f32_16x16x32_bf16 v[8:11], v[20:23], v[220:223], v[8:11]
v_and_b32 v20, v12, v18
v_and_b32 v21, v13, v18
v_and_b32 v22, v14, v18
v_and_b32 v23, v15, v18
s_nop 1
v_mfma_f32_16x16x32_bf16 v[8:11], v[20:23], v[224:227], v[8:11]
v_and_b32 v20, v12, v19
v_and_b32 v21, v13, v19
v_and_b32 v22, v14, v19
v_and_b32 v23, v15, v19
s_nop 1
v_mfma_f32_16x16x32_bf16 v[8:11], v[20:23], v[228:231], v[8:11]
s_nop 7
s_waitcnt vmcnt(4)
s_mov_b32 s46, 11264
buffer_load_dwordx4 v[188:191], v0, s[36:39], s46 offen nt
s_waitcnt vmcnt(4)
s_mov_b32 s46, 12288
buffer_load_dwordx4 v[192:195], v0, s[36:39], s46 offen nt
s_waitcnt vmcnt(4)
s_mov_b32 s46, 13312
buffer_load_dwordx4 v[196:199], v0, s[36:39], s46 offen nt
s_waitcnt vmcnt(4)
s_mov_b32 s46, 11264
buffer_load_dwordx4 v[244:247], v0, s[40:43], s46 offen nt
s_waitcnt vmcnt(4)
s_mov_b32 s46, 12288
buffer_load_dwordx4 v[248:251], v0, s[40:43], s46 offen nt
s_waitcnt vmcnt(4)
s_mov_b32 s46, 13312
buffer_load_dwordx4 v[252:255], v0, s[40:43], s46 offen nt
v_dot2_f32_bf16 v16, v176, v2, 0
v_dot2_f32_bf16 v17, v180, v2, 0
v_dot2_f32_bf16 v18, v184, v2, 0
v_dot2_f32_bf16 v16, v177, v3, v16
v_dot2_f32_bf16 v17, v181, v3, v17
v_dot2_f32_bf16 v18, v185, v3, v18
v_dot2_f32_bf16 v16, v178, v4, v16
v_dot2_f32_bf16 v17, v182, v4, v17
v_dot2_f32_bf16 v18, v186, v4, v18
v_dot2_f32_bf16 v16, v179, v5, v16
v_dot2_f32_bf16 v17, v183, v5, v17
v_dot2_f32_bf16 v18, v187, v5, v18
s_nop 0
v_add_f32_dpp v16, v16, v16 row_ror:8 row_mask:0xf bank_mask:0xf
v_add_f32_dpp v17, v17, v17 row_ror:8 row_mask:0xf bank_mask:0xf
v_add_f32_dpp v18, v18, v18 row_ror:8 row_mask:0xf bank_mask:0xf
v_add_f32_dpp v16, v16, v16 row_ror:4 row_mask:0xf bank_mask:0xf
v_add_f32_dpp v17, v17, v17 row_ror:4 row_mask:0xf bank_mask:0xf
v_add_f32_dpp v18, v18, v18 row_ror:4 row_mask:0xf bank_mask:0xf
v_add_f32_dpp v16, v16, v16 row_ror:2 row_mask:0xf bank_mask:0xf
v_add_f32_dpp v17, v17, v17 row_ror:2 row_mask:0xf bank_mask:0xf
v_add_f32_dpp v18, v18, v18 row_ror:2 row_mask:0xf bank_mask:0xf
v_add_f32_dpp v16, v16, v16 row_ror:1 row_mask:0xf bank_mask:0xf
v_add_f32_dpp v17, v17, v17 row_ror:1 row_mask:0xf bank_mask:0xf
v_add_f32_dpp v18, v18, v18 row_ror:1 row_mask:0xf bank_mask:0xf
v_add_f32 v17, s45, v17
v_add_f32 v18, s45, v18
v_max3_f32 v20, v16, v17, v18
v_max_f32 v20, v20, v6
v_mov_b32 v21, v20
s_nop 1
v_permlane16_swap_b32 v20, v21
v_max_f32 v20, v20, v21
v_mov_b32 v21, v20
s_nop 1
v_permlane32_swap_b32 v20, v21
v_max_f32 v20, v20, v21
v_sub_f32 v21, v6, v20
v_mul_f32 v21, s44, v21
v_exp_f32 v21, v21
v_mul_f32 v22, s44, v20
v_mov_b32 v6, v20
v_fma_f32 v16, v16, s44, -v22
v_fma_f32 v17, v17, s44, -v22
v_fma_f32 v18, v18, s44, -v22
v_exp_f32 v16, v16
v_exp_f32 v17, v17
v_exp_f32 v18, v18
v_mul_f32 v7, v7, v21
v_mul_f32 v8, v8, v21
v_mul_f32 v9, v9, v21
v_mul_f32 v10, v10, v21
v_mul_f32 v11, v11, v21
v_add_f32 v7, v7, v16
v_add_f32 v7, v7, v17
v_add_f32 v7, v7, v18
v_cvt_pk_bf16_f32 v16, v16, v16
v_cvt_pk_bf16_f32 v17, v17, v17
v_cvt_pk_bf16_f32 v18, v18, v18
v_and_b32 v20, v12, v16
v_and_b32 v21, v13, v16
v_and_b32 v22, v14, v16
v_and_b32 v23, v15, v16
s_nop 1
v_mfma_f32_16x16x32_bf16 v[8:11], v[20:23], v[232:235], v[8:11]
v_and_b32 v20, v12, v17
v_and_b32 v21, v13, v17
v_and_b32 v22, v14, v17
v_and_b32 v23, v15, v17
s_nop 1
v_mfma_f32_16x16x32_bf16 v[8:11], v[20:23], v[236:239], v[8:11]
v_and_b32 v20, v12, v18
v_and_b32 v21, v13, v18
v_and_b32 v22, v14, v18
v_and_b32 v23, v15, v18
s_nop 1
v_mfma_f32_16x16x32_bf16 v[8:11], v[20:23], v[240:243], v[8:11]
s_waitcnt vmcnt(3)
v_dot2_f32_bf16 v16, v188, v2, 0
v_dot2_f32_bf16 v17, v192, v2, 0
v_dot2_f32_bf16 v18, v196, v2, 0
v_dot2_f32_bf16 v16, v189, v3, v16
v_dot2_f32_bf16 v17, v193, v3, v17
v_dot2_f32_bf16 v18, v197, v3, v18
v_dot2_f32_bf16 v16, v190, v4, v16
v_dot2_f32_bf16 v17, v194, v4, v17
v_dot2_f32_bf16 v18, v198, v4, v18
v_dot2_f32_bf16 v16, v191, v5, v16
v_dot2_f32_bf16 v17, v195, v5, v17
v_dot2_f32_bf16 v18, v199, v5, v18
s_add_u32 s3, s51, 8
s_mul_i32 s3, s3, 57344
s_lshl_b32 s4, s2, 8
s_add_u32 s3, s3, s4
s_add_u32 s3, s3, 4194304
v_subrev_u32 v20, s48, v1
v_and_b32 v20, 0xf0, v20
v_add_u32 v20, s3, v20
global_load_dwordx4 v[2:5], v20, s[28:29] sc1
s_waitcnt vmcnt(1)
v_add_f32_dpp v16, v16, v16 row_ror:8 row_mask:0xf bank_mask:0xf
v_add_f32_dpp v17, v17, v17 row_ror:8 row_mask:0xf bank_mask:0xf
v_add_f32_dpp v18, v18, v18 row_ror:8 row_mask:0xf bank_mask:0xf
v_add_f32_dpp v16, v16, v16 row_ror:4 row_mask:0xf bank_mask:0xf
v_add_f32_dpp v17, v17, v17 row_ror:4 row_mask:0xf bank_mask:0xf
v_add_f32_dpp v18, v18, v18 row_ror:4 row_mask:0xf bank_mask:0xf
v_add_f32_dpp v16, v16, v16 row_ror:2 row_mask:0xf bank_mask:0xf
v_add_f32_dpp v17, v17, v17 row_ror:2 row_mask:0xf bank_mask:0xf
v_add_f32_dpp v18, v18, v18 row_ror:2 row_mask:0xf bank_mask:0xf
v_add_f32_dpp v16, v16, v16 row_ror:1 row_mask:0xf bank_mask:0xf
v_add_f32_dpp v17, v17, v17 row_ror:1 row_mask:0xf bank_mask:0xf
v_add_f32_dpp v18, v18, v18 row_ror:1 row_mask:0xf bank_mask:0xf
v_add_f32 v16, s45, v16
v_add_f32 v17, s45, v17
v_add_f32 v18, s45, v18
v_max3_f32 v20, v16, v17, v18
v_max_f32 v20, v20, v6
v_mov_b32 v21, v20
s_nop 1
v_permlane16_swap_b32 v20, v21
v_max_f32 v20, v20, v21
v_mov_b32 v21, v20
s_nop 1
v_permlane32_swap_b32 v20, v21
v_max_f32 v20, v20, v21
v_sub_f32 v21, v6, v20
v_mul_f32 v21, s44, v21
v_exp_f32 v21, v21
v_mul_f32 v22, s44, v20
v_mov_b32 v6, v20
v_fma_f32 v16, v16, s44, -v22
v_fma_f32 v17, v17, s44, -v22
v_fma_f32 v18, v18, s44, -v22
v_exp_f32 v16, v16
v_exp_f32 v17, v17
v_exp_f32 v18, v18
v_mul_f32 v7, v7, v21
v_mul_f32 v8, v8, v21
v_mul_f32 v9, v9, v21
v_mul_f32 v10, v10, v21
v_mul_f32 v11, v11, v21
v_add_f32 v7, v7, v16
v_add_f32 v7, v7, v17
v_add_f32 v7, v7, v18
v_cvt_pk_bf16_f32 v16, v16, v16
v_cvt_pk_bf16_f32 v17, v17, v17
v_cvt_pk_bf16_f32 v18, v18, v18
v_and_b32 v20, v12, v16
v_and_b32 v21, v13, v16
v_and_b32 v22, v14, v16
v_and_b32 v23, v15, v16
s_nop 1
v_mfma_f32_16x16x32_bf16 v[8:11], v[20:23], v[244:247], v[8:11]
v_and_b32 v20, v12, v17
v_and_b32 v21, v13, v17
v_and_b32 v22, v14, v17
v_and_b32 v23, v15, v17
s_nop 1
v_mfma_f32_16x16x32_bf16 v[8:11], v[20:23], v[248:251], v[8:11]
v_and_b32 v20, v12, v18
v_and_b32 v21, v13, v18
v_and_b32 v22, v14, v18
v_and_b32 v23, v15, v18
s_nop 1
v_mfma_f32_16x16x32_bf16 v[8:11], v[20:23], v[252:255], v[8:11]
v_mul_f32 v6, s44, v6
v_mov_b32 v16, v7
s_nop 1
v_permlane16_swap_b32 v7, v16
v_add_f32 v7, v7, v16
v_mov_b32 v16, v7
s_nop 1
v_permlane32_swap_b32 v7, v16
v_add_f32 v7, v7, v16
v_subrev_u32 v16, s48, v1
v_and_b32 v17, 0xf0, v16
v_lshlrev_b32 v17, 1, v17
v_lshrrev_b32 v18, 8, v16
v_lshl_add_u32 v17, v18, 4, v17
s_mul_i32 s3, s30, 528
s_add_u32 s3, s3, 147584
v_add_u32 v17, s3, v17
s_mov_b32 exec_hi, 0
ds_write_b128 v17, v[8:11]
s_mov_b64 exec, 1
ds_write_b64 v17, v[6:7] offset:512
s_waitcnt lgkmcnt(0)
v_mov_b32 v18, 160260
v_mov_b32 v19, 1
ds_add_rtn_u32 v20, v18, v19
s_waitcnt lgkmcnt(0)
s_mov_b64 exec, -1
v_readfirstlane_b32 s3, v20
s_nop 0
s_and_b32 s3, s3, 7
s_cmp_lg_u32 s3, 7
s_cbranch_scc1 .L67
v_mov_b32 v10, 148096
ds_read_b64 v[16:17], v10 offset:0
ds_read_b64 v[18:19], v10 offset:528
ds_read_b64 v[20:21], v10 offset:1056
ds_read_b64 v[22:23], v10 offset:1584
ds_read_b64 v[24:25], v10 offset:2112
ds_read_b64 v[26:27], v10 offset:2640
ds_read_b64 v[28:29], v10 offset:3168
ds_read_b64 v[30:31], v10 offset:3696
v_subrev_u32 v11, s48, v1
v_lshrrev_b32 v11, 1, v11
v_add_u32 v10, 147584, v11
s_waitcnt lgkmcnt(0)
v_max3_f32 v6, v16, v18, v20
v_max3_f32 v6, v6, v22, v24
v_max3_f32 v6, v6, v26, v28
v_max_f32 v6, v6, v30
v_mov_b32 v7, 0
v_mov_b32 v8, 0
v_mov_b32 v9, 0
v_sub_f32 v16, v16, v6
v_exp_f32 v16, v16
v_sub_f32 v18, v18, v6
v_exp_f32 v18, v18
v_sub_f32 v20, v20, v6
v_exp_f32 v20, v20
v_sub_f32 v22, v22, v6
v_exp_f32 v22, v22
v_sub_f32 v24, v24, v6
v_exp_f32 v24, v24
v_sub_f32 v26, v26, v6
v_exp_f32 v26, v26
v_sub_f32 v28, v28, v6
v_exp_f32 v28, v28
v_sub_f32 v30, v30, v6
v_exp_f32 v30, v30
v_fmac_f32 v7, v16, v17
v_fmac_f32 v7, v18, v19
v_fmac_f32 v7, v20, v21
v_fmac_f32 v7, v22, v23
v_fmac_f32 v7, v24, v25
v_fmac_f32 v7, v26, v27
v_fmac_f32 v7, v28, v29
v_fmac_f32 v7, v30, v31
v_mov_b32 v17, v18
v_mov_b32 v18, v20
v_mov_b32 v19, v22
v_mov_b32 v20, v24
v_mov_b32 v21, v26
v_mov_b32 v22, v28
v_mov_b32 v23, v30
ds_read_b64 v[24:25], v10 offset:0
ds_read_b64 v[26:27], v10 offset:528
ds_read_b64 v[28:29], v10 offset:1056
ds_read_b64 v[30:31], v10 offset:1584
s_waitcnt lgkmcnt(0)
v_fmac_f32 v8, v16, v24
v_fmac_f32 v9, v16, v25
v_fmac_f32 v8, v17, v26
v_fmac_f32 v9, v17, v27
v_fmac_f32 v8, v18, v28
v_fmac_f32 v9, v18, v29
v_fmac_f32 v8, v19, v30
v_fmac_f32 v9, v19, v31
ds_read_b64 v[24:25], v10 offset:2112
ds_read_b64 v[26:27], v10 offset:2640
ds_read_b64 v[28:29], v10 offset:3168
ds_read_b64 v[30:31], v10 offset:3696
s_waitcnt lgkmcnt(0)
v_fmac_f32 v8, v20, v24
v_fmac_f32 v9, v20, v25
v_fmac_f32 v8, v21, v26
v_fmac_f32 v9, v21, v27
v_fmac_f32 v8, v22, v28
v_fmac_f32 v9, v22, v29
v_fmac_f32 v8, v23, v30
v_fmac_f32 v9, v23, v31
v_min_u32 v6, 0xfffffffe, v6
v_min_u32 v7, 0xfffffffe, v7
v_min_u32 v8, 0xfffffffe, v8
v_min_u32 v9, 0xfffffffe, v9
s_add_u32 s3, s52, 0
s_mul_i32 s3, s3, 224
s_add_u32 s3, s3, s2
s_mul_i32 s3, s3, 528
v_add_u32 v11, s3, v11
global_store_dwordx2 v11, v[8:9], s[28:29] offset:0 sc1
s_mov_b64 exec, 1
global_store_dwordx2 v11, v[6:7], s[28:29] offset:512 sc1
s_mov_b64 exec, -1
.L67:
s_nop 4
s_add_u32 s36, s36, 0x2000000
s_addc_u32 s37, s37, 0
s_add_u32 s40, s40, 0x2000000
s_addc_u32 s41, s41, 0
L_loop_b:
s_nop 4
s_cmp_ge_u32 s51, 6
s_cselect_b32 s54, 1, 0
s_add_u32 s52, s51, 2
s_add_u32 s53, s51, 1
s_waitcnt vmcnt(0)
s_branch .L70
.L68:
s_nop 4
s_add_u32 s3, s51, 8
s_mul_i32 s3, s3, 57344
s_lshl_b32 s4, s2, 8
s_add_u32 s3, s3, s4
s_add_u32 s3, s3, 4194304
v_subrev_u32 v20, s48, v1
v_and_b32 v20, 0xf0, v20
v_add_u32 v20, s3, v20
global_load_dwordx4 v[2:5], v20, s[28:29] sc1
s_waitcnt vmcnt(0)
.L70:
s_nop 4
v_max3_u32 v17, v2, v3, v4
v_max_u32 v17, v17, v5
v_cmp_eq_u32 vcc, -1, v17
s_nop 0
s_cmp_eq_u64 vcc, 0
s_cbranch_scc1 .L69
s_sleep 2
s_add_u32 s47, s47, 1
s_cmp_lt_u32 s47, 262144
s_cbranch_scc1 .L68
s_endpgm
.L69:
s_nop 4
v_mov_b32 v6, 0xff800000
v_mov_b32 v7, 0
v_mov_b32 v8, 0
v_mov_b32 v9, 0
v_mov_b32 v10, 0
v_mov_b32 v11, 0
v_dot2_f32_bf16 v16, v32, v2, 0
v_dot2_f32_bf16 v17, v36, v2, 0
v_dot2_f32_bf16 v18, v40, v2, 0
v_dot2_f32_bf16 v19, v44, v2, 0
v_dot2_f32_bf16 v16, v33, v3, v16
v_dot2_f32_bf16 v17, v37, v3, v17
v_dot2_f32_bf16 v18, v41, v3, v18
v_dot2_f32_bf16 v19, v45, v3, v19
v_dot2_f32_bf16 v16, v34, v4, v16
v_dot2_f32_bf16 v17, v38, v4, v17
v_dot2_f32_bf16 v18, v42, v4, v18
v_dot2_f32_bf16 v19, v46, v4, v19
v_dot2_f32_bf16 v16, v35, v5, v16
v_dot2_f32_bf16 v17, v39, v5, v17
v_dot2_f32_bf16 v18, v43, v5, v18
v_dot2_f32_bf16 v19, v47, v5, v19
v_add_f32_dpp v16, v16, v16 row_ror:8 row_mask:0xf bank_mask:0xf
v_add_f32_dpp v17, v17, v17 row_ror:8 row_mask:0xf bank_mask:0xf
v_add_f32_dpp v18, v18, v18 row_ror:8 row_mask:0xf bank_mask:0xf
v_add_f32_dpp v19, v19, v19 row_ror:8 row_mask:0xf bank_mask:0xf
v_add_f32_dpp v16, v16, v16 row_ror:4 row_mask:0xf bank_mask:0xf
v_add_f32_dpp v17, v17, v17 row_ror:4 row_mask:0xf bank_mask:0xf
v_add_f32_dpp v18, v18, v18 row_ror:4 row_mask:0xf bank_mask:0xf
v_add_f32_dpp v19, v19, v19 row_ror:4 row_mask:0xf bank_mask:0xf
v_add_f32_dpp v16, v16, v16 row_ror:2 row_mask:0xf bank_mask:0xf
v_add_f32_dpp v17, v17, v17 row_ror:2 row_mask:0xf bank_mask:0xf
v_add_f32_dpp v18, v18, v18 row_ror:2 row_mask:0xf bank_mask:0xf
v_add_f32_dpp v19, v19, v19 row_ror:2 row_mask:0xf bank_mask:0xf
v_add_f32_dpp v16, v16, v16 row_ror:1 row_mask:0xf bank_mask:0xf
v_add_f32_dpp v17, v17, v17 row_ror:1 row_mask:0xf bank_mask:0xf
v_add_f32_dpp v18, v18, v18 row_ror:1 row_mask:0xf bank_mask:0xf
v_add_f32_dpp v19, v19, v19 row_ror:1 row_mask:0xf bank_mask:0xf
v_max3_f32 v20, v16, v17, v18
v_max3_f32 v20, v20, v19, v6
v_mov_b32 v21, v20
s_nop 1
v_permlane16_swap_b32 v20, v21
v_max_f32 v20, v20, v21
v_mov_b32 v21, v20
s_nop 1
v_permlane32_swap_b32 v20, v21
v_max_f32 v20, v20, v21
v_sub_f32 v21, v6, v20
v_mul_f32 v21, s44, v21
v_exp_f32 v21, v21
v_mul_f32 v22, s44, v20
v_mov_b32 v6, v20
v_fma_f32 v16, v16, s44, -v22
v_fma_f32 v17, v17, s44, -v22
v_fma_f32 v18, v18, s44, -v22
v_fma_f32 v19, v19, s44, -v22
v_exp_f32 v16, v16
v_exp_f32 v17, v17
v_exp_f32 v18, v18
v_exp_f32 v19, v19
v_mul_f32 v7, v7, v21
v_mul_f32 v8, v8, v21
v_mul_f32 v9, v9, v21
v_mul_f32 v10, v10, v21
v_mul_f32 v11, v11, v21
v_add_f32 v7, v7, v16
v_add_f32 v7, v7, v17
v_add_f32 v7, v7, v18
v_add_f32 v7, v7, v19
v_cvt_pk_bf16_f32 v16, v16, v16
v_cvt_pk_bf16_f32 v17, v17, v17
v_cvt_pk_bf16_f32 v18, v18, v18
v_cvt_pk_bf16_f32 v19, v19, v19
v_and_b32 v20, v12, v16
v_and_b32 v21, v13, v16
v_and_b32 v22, v14, v16
v_and_b32 v23, v15, v16
s_nop 1
v_mfma_f32_16x16x32_bf16 v[8:11], v[20:23], v[88:91], v[8:11]
v_and_b32 v20, v12, v17
v_and_b32 v21, v13, v17
v_and_b32 v22, v14, v17
v_and_b32 v23, v15, v17
s_nop 1
v_mfma_f32_16x16x32_bf16 v[8:11], v[20:23], v[92:95], v[8:11]
v_and_b32 v20, v12, v18
v_and_b32 v21, v13, v18
v_and_b32 v22, v14, v18
v_and_b32 v23, v15, v18
s_nop 1
v_mfma_f32_16x16x32_bf16 v[8:11], v[20:23], v[96:99], v[8:11]
v_and_b32 v20, v12, v19
v_and_b32 v21, v13, v19
v_and_b32 v22, v14, v19
v_and_b32 v23, v15, v19
s_nop 1
v_mfma_f32_16x16x32_bf16 v[8:11], v[20:23], v[100:103], v[8:11]
s_cmp_lg_u32 s54, 0
s_cbranch_scc1 .L71
s_nop 7
s_mov_b32 s46, 0
buffer_load_dwordx4 v[32:35], v0, s[36:39], s46 offen nt
s_mov_b32 s46, 1024
buffer_load_dwordx4 v[36:39], v0, s[36:39], s46 offen nt
s_mov_b32 s46, 2048
buffer_load_dwordx4 v[40:43], v0, s[36:39], s46 offen nt
s_mov_b32 s46, 3072
buffer_load_dwordx4 v[44:47], v0, s[36:39], s46 offen nt
s_mov_b32 s46, 0
buffer_load_dwordx4 v[88:91], v0, s[40:43], s46 offen nt
s_waitcnt vmcnt(4)
s_mov_b32 s46, 1024
buffer_load_dwordx4 v[92:95], v0, s[40:43], s46 offen nt
s_waitcnt vmcnt(4)
s_mov_b32 s46, 2048
buffer_load_dwordx4 v[96:99], v0, s[40:43], s46 offen nt
s_waitcnt vmcnt(4)
s_mov_b32 s46, 3072
buffer_load_dwordx4 v[100:103], v0, s[40:43], s46 offen nt
.L71:
s_nop 4
v_dot2_f32_bf16 v16, v48, v2, 0
v_dot2_f32_bf16 v17, v52, v2, 0
v_dot2_f32_bf16 v18, v56, v2, 0
v_dot2_f32_bf16 v19, v60, v2, 0
v_dot2_f32_bf16 v16, v49, v3, v16
v_dot2_f32_bf16 v17, v53, v3, v17
v_dot2_f32_bf16 v18, v57, v3, v18
v_dot2_f32_bf16 v19, v61, v3, v19
v_dot2_f32_bf16 v16, v50, v4, v16
v_dot2_f32_bf16 v17, v54, v4, v17
v_dot2_f32_bf16 v18, v58, v4, v18
v_dot2_f32_bf16 v19, v62, v4, v19
v_dot2_f32_bf16 v16, v51, v5, v16
v_dot2_f32_bf16 v17, v55, v5, v17
v_dot2_f32_bf16 v18, v59, v5, v18
v_dot2_f32_bf16 v19, v63, v5, v19
v_add_f32_dpp v16, v16, v16 row_ror:8 row_mask:0xf bank_mask:0xf
v_add_f32_dpp v17, v17, v17 row_ror:8 row_mask:0xf bank_mask:0xf
v_add_f32_dpp v18, v18, v18 row_ror:8 row_mask:0xf bank_mask:0xf
v_add_f32_dpp v19, v19, v19 row_ror:8 row_mask:0xf bank_mask:0xf
v_add_f32_dpp v16, v16, v16 row_ror:4 row_mask:0xf bank_mask:0xf
v_add_f32_dpp v17, v17, v17 row_ror:4 row_mask:0xf bank_mask:0xf
v_add_f32_dpp v18, v18, v18 row_ror:4 row_mask:0xf bank_mask:0xf
v_add_f32_dpp v19, v19, v19 row_ror:4 row_mask:0xf bank_mask:0xf
v_add_f32_dpp v16, v16, v16 row_ror:2 row_mask:0xf bank_mask:0xf
v_add_f32_dpp v17, v17, v17 row_ror:2 row_mask:0xf bank_mask:0xf
v_add_f32_dpp v18, v18, v18 row_ror:2 row_mask:0xf bank_mask:0xf
v_add_f32_dpp v19, v19, v19 row_ror:2 row_mask:0xf bank_mask:0xf
v_add_f32_dpp v16, v16, v16 row_ror:1 row_mask:0xf bank_mask:0xf
v_add_f32_dpp v17, v17, v17 row_ror:1 row_mask:0xf bank_mask:0xf
v_add_f32_dpp v18, v18, v18 row_ror:1 row_mask:0xf bank_mask:0xf
v_add_f32_dpp v19, v19, v19 row_ror:1 row_mask:0xf bank_mask:0xf
v_max3_f32 v20, v16, v17, v18
v_max3_f32 v20, v20, v19, v6
v_mov_b32 v21, v20
s_nop 1
v_permlane16_swap_b32 v20, v21
v_max_f32 v20, v20, v21
v_mov_b32 v21, v20
s_nop 1
v_permlane32_swap_b32 v20, v21
v_max_f32 v20, v20, v21
v_sub_f32 v21, v6, v20
v_mul_f32 v21, s44, v21
v_exp_f32 v21, v21
v_mul_f32 v22, s44, v20
v_mov_b32 v6, v20
v_fma_f32 v16, v16, s44, -v22
v_fma_f32 v17, v17, s44, -v22
v_fma_f32 v18, v18, s44, -v22
v_fma_f32 v19, v19, s44, -v22
v_exp_f32 v16, v16
v_exp_f32 v17, v17
v_exp_f32 v18, v18
v_exp_f32 v19, v19
v_mul_f32 v7, v7, v21
v_mul_f32 v8, v8, v21
v_mul_f32 v9, v9, v21
v_mul_f32 v10, v10, v21
v_mul_f32 v11, v11, v21
v_add_f32 v7, v7, v16
v_add_f32 v7, v7, v17
v_add_f32 v7, v7, v18
v_add_f32 v7, v7, v19
v_cvt_pk_bf16_f32 v16, v16, v16
v_cvt_pk_bf16_f32 v17, v17, v17
v_cvt_pk_bf16_f32 v18, v18, v18
v_cvt_pk_bf16_f32 v19, v19, v19
v_and_b32 v20, v12, v16
v_and_b32 v21, v13, v16
v_and_b32 v22, v14, v16
v_and_b32 v23, v15, v16
s_nop 1
v_mfma_f32_16x16x32_bf16 v[8:11], v[20:23], v[104:107], v[8:11]
v_and_b32 v20, v12, v17
v_and_b32 v21, v13, v17
v_and_b32 v22, v14, v17
v_and_b32 v23, v15, v17
s_nop 1
v_mfma_f32_16x16x32_bf16 v[8:11], v[20:23], v[108:111], v[8:11]
v_and_b32 v20, v12, v18
v_and_b32 v21, v13, v18
v_and_b32 v22, v14, v18
v_and_b32 v23, v15, v18
s_nop 1
v_mfma_f32_16x16x32_bf16 v[8:11], v[20:23], v[112:115], v[8:11]
v_and_b32 v20, v12, v19
v_and_b32 v21, v13, v19
v_and_b32 v22, v14, v19
v_and_b32 v23, v15, v19
s_nop 1
v_mfma_f32_16x16x32_bf16 v[8:11], v[20:23], v[116:119], v[8:11]
v_dot2_f32_bf16 v16, v64, v2, 0
v_dot2_f32_bf16 v17, v68, v2, 0
v_dot2_f32_bf16 v18, v72, v2, 0
v_dot2_f32_bf16 v16, v65, v3, v16
v_dot2_f32_bf16 v17, v69, v3, v17
v_dot2_f32_bf16 v18, v73, v3, v18
v_dot2_f32_bf16 v16, v66, v4, v16
v_dot2_f32_bf16 v17, v70, v4, v17
v_dot2_f32_bf16 v18, v74, v4, v18
v_dot2_f32_bf16 v16, v67, v5, v16
v_dot2_f32_bf16 v17, v71, v5, v17
v_dot2_f32_bf16 v18, v75, v5, v18
s_nop 0
v_add_f32_dpp v16, v16, v16 row_ror:8 row_mask:0xf bank_mask:0xf
v_add_f32_dpp v17, v17, v17 row_ror:8 row_mask:0xf bank_mask:0xf
v_add_f32_dpp v18, v18, v18 row_ror:8 row_mask:0xf bank_mask:0xf
v_add_f32_dpp v16, v16, v16 row_ror:4 row_mask:0xf bank_mask:0xf
v_add_f32_dpp v17, v17, v17 row_ror:4 row_mask:0xf bank_mask:0xf
v_add_f32_dpp v18, v18, v18 row_ror:4 row_mask:0xf bank_mask:0xf
v_add_f32_dpp v16, v16, v16 row_ror:2 row_mask:0xf bank_mask:0xf
v_add_f32_dpp v17, v17, v17 row_ror:2 row_mask:0xf bank_mask:0xf
v_add_f32_dpp v18, v18, v18 row_ror:2 row_mask:0xf bank_mask:0xf
v_add_f32_dpp v16, v16, v16 row_ror:1 row_mask:0xf bank_mask:0xf
v_add_f32_dpp v17, v17, v17 row_ror:1 row_mask:0xf bank_mask:0xf
v_add_f32_dpp v18, v18, v18 row_ror:1 row_mask:0xf bank_mask:0xf
v_add_f32 v17, s45, v17
v_add_f32 v18, s45, v18
v_max3_f32 v20, v16, v17, v18
v_max_f32 v20, v20, v6
v_mov_b32 v21, v20
s_nop 1
v_permlane16_swap_b32 v20, v21
v_max_f32 v20, v20, v21
v_mov_b32 v21, v20
s_nop 1
v_permlane32_swap_b32 v20, v21
v_max_f32 v20, v20, v21
v_sub_f32 v21, v6, v20
v_mul_f32 v21, s44, v21
v_exp_f32 v21, v21
v_mul_f32 v22, s44, v20
v_mov_b32 v6, v20
v_fma_f32 v16, v16, s44, -v22
v_fma_f32 v17, v17, s44, -v22
v_fma_f32 v18, v18, s44, -v22
v_exp_f32 v16, v16
v_exp_f32 v17, v17
v_exp_f32 v18, v18
v_mul_f32 v7, v7, v21
v_mul_f32 v8, v8, v21
v_mul_f32 v9, v9, v21
v_mul_f32 v10, v10, v21
v_mul_f32 v11, v11, v21
v_add_f32 v7, v7, v16
v_add_f32 v7, v7, v17
v_add_f32 v7, v7, v18
v_cvt_pk_bf16_f32 v16, v16, v16
v_cvt_pk_bf16_f32 v17, v17, v17
v_cvt_pk_bf16_f32 v18, v18, v18
v_and_b32 v20, v12, v16
v_and_b32 v21, v13, v16
v_and_b32 v22, v14, v16
v_and_b32 v23, v15, v16
s_nop 1
v_mfma_f32_16x16x32_bf16 v[8:11], v[20:23], v[120:123], v[8:11]
v_and_b32 v20, v12, v17
v_and_b32 v21, v13, v17
v_and_b32 v22, v14, v17
v_and_b32 v23, v15, v17
s_nop 1
v_mfma_f32_16x16x32_bf16 v[8:11], v[20:23], v[124:127], v[8:11]
v_and_b32 v20, v12, v18
v_and_b32 v21, v13, v18
v_and_b32 v22, v14, v18
v_and_b32 v23, v15, v18
s_nop 1
v_mfma_f32_16x16x32_bf16 v[8:11], v[20:23], v[128:131], v[8:11]
v_dot2_f32_bf16 v16, v76, v2, 0
v_dot2_f32_bf16 v17, v80, v2, 0
v_dot2_f32_bf16 v18, v84, v2, 0
v_dot2_f32_bf16 v16, v77, v3, v16
v_dot2_f32_bf16 v17, v81, v3, v17
v_dot2_f32_bf16 v18, v85, v3, v18
v_dot2_f32_bf16 v16, v78, v4, v16
v_dot2_f32_bf16 v17, v82, v4, v17
v_dot2_f32_bf16 v18, v86, v4, v18
v_dot2_f32_bf16 v16, v79, v5, v16
v_dot2_f32_bf16 v17, v83, v5, v17
v_dot2_f32_bf16 v18, v87, v5, v18
s_cmp_lg_u32 s54, 0
s_cbranch_scc1 .L72
s_add_u32 s3, s52, 0
s_mul_i32 s3, s3, 57344
s_lshl_b32 s4, s2, 8
s_add_u32 s3, s3, s4
s_add_u32 s3, s3, 4194304
v_subrev_u32 v20, s48, v1
v_and_b32 v20, 0xf0, v20
v_add_u32 v20, s3, v20
s_branch .L73
.L72:
s_nop 4
s_min_u32 s53, s53, 7
s_add_u32 s3, s53, 8
s_mul_i32 s3, s3, 57344
s_lshl_b32 s4, s2, 8
s_add_u32 s3, s3, s4
s_add_u32 s3, s3, 4194304
v_subrev_u32 v20, s48, v1
v_and_b32 v20, 0xf0, v20
v_add_u32 v20, s3, v20
.L73:
s_nop 4
global_load_dwordx4 v[2:5], v20, s[28:29] sc1
v_add_f32_dpp v16, v16, v16 row_ror:8 row_mask:0xf bank_mask:0xf
v_add_f32_dpp v17, v17, v17 row_ror:8 row_mask:0xf bank_mask:0xf
v_add_f32_dpp v18, v18, v18 row_ror:8 row_mask:0xf bank_mask:0xf
v_add_f32_dpp v16, v16, v16 row_ror:4 row_mask:0xf bank_mask:0xf
v_add_f32_dpp v17, v17, v17 row_ror:4 row_mask:0xf bank_mask:0xf
v_add_f32_dpp v18, v18, v18 row_ror:4 row_mask:0xf bank_mask:0xf
v_add_f32_dpp v16, v16, v16 row_ror:2 row_mask:0xf bank_mask:0xf
v_add_f32_dpp v17, v17, v17 row_ror:2 row_mask:0xf bank_mask:0xf
v_add_f32_dpp v18, v18, v18 row_ror:2 row_mask:0xf bank_mask:0xf
v_add_f32_dpp v16, v16, v16 row_ror:1 row_mask:0xf bank_mask:0xf
v_add_f32_dpp v17, v17, v17 row_ror:1 row_mask:0xf bank_mask:0xf
v_add_f32_dpp v18, v18, v18 row_ror:1 row_mask:0xf bank_mask:0xf
v_add_f32 v16, s45, v16
v_add_f32 v17, s45, v17
v_add_f32 v18, s45, v18
v_max3_f32 v20, v16, v17, v18
v_max_f32 v20, v20, v6
v_mov_b32 v21, v20
s_nop 1
v_permlane16_swap_b32 v20, v21
v_max_f32 v20, v20, v21
v_mov_b32 v21, v20
s_nop 1
v_permlane32_swap_b32 v20, v21
v_max_f32 v20, v20, v21
v_sub_f32 v21, v6, v20
v_mul_f32 v21, s44, v21
v_exp_f32 v21, v21
v_mul_f32 v22, s44, v20
v_mov_b32 v6, v20
v_fma_f32 v16, v16, s44, -v22
v_fma_f32 v17, v17, s44, -v22
v_fma_f32 v18, v18, s44, -v22
v_exp_f32 v16, v16
v_exp_f32 v17, v17
v_exp_f32 v18, v18
v_mul_f32 v7, v7, v21
v_mul_f32 v8, v8, v21
v_mul_f32 v9, v9, v21
v_mul_f32 v10, v10, v21
v_mul_f32 v11, v11, v21
v_add_f32 v7, v7, v16
v_add_f32 v7, v7, v17
v_add_f32 v7, v7, v18
v_cvt_pk_bf16_f32 v16, v16, v16
v_cvt_pk_bf16_f32 v17, v17, v17
v_cvt_pk_bf16_f32 v18, v18, v18
v_and_b32 v20, v12, v16
v_and_b32 v21, v13, v16
v_and_b32 v22, v14, v16
v_and_b32 v23, v15, v16
s_nop 1
v_mfma_f32_16x16x32_bf16 v[8:11], v[20:23], v[132:135], v[8:11]
v_and_b32 v20, v12, v17
v_and_b32 v21, v13, v17
v_and_b32 v22, v14, v17
v_and_b32 v23, v15, v17
s_nop 1
v_mfma_f32_16x16x32_bf16 v[8:11], v[20:23], v[136:139], v[8:11]
v_and_b32 v20, v12, v18
v_and_b32 v21, v13, v18
v_and_b32 v22, v14, v18
v_and_b32 v23, v15, v18
s_nop 1
v_mfma_f32_16x16x32_bf16 v[8:11], v[20:23], v[140:143], v[8:11]
s_cmp_lg_u32 s54, 0
s_cbranch_scc1 .L74
s_nop 7
s_waitcnt vmcnt(4)
s_mov_b32 s46, 4096
buffer_load_dwordx4 v[48:51], v0, s[36:39], s46 offen nt
s_waitcnt vmcnt(4)
s_mov_b32 s46, 5120
buffer_load_dwordx4 v[52:55], v0, s[36:39], s46 offen nt
s_waitcnt vmcnt(4)
s_mov_b32 s46, 6144
buffer_load_dwordx4 v[56:59], v0, s[36:39], s46 offen nt
s_waitcnt vmcnt(4)
s_mov_b32 s46, 7168
buffer_load_dwordx4 v[60:63], v0, s[36:39], s46 offen nt
s_waitcnt vmcnt(4)
s_mov_b32 s46, 4096
buffer_load_dwordx4 v[104:107], v0, s[40:43], s46 offen nt
s_waitcnt vmcnt(4)
s_mov_b32 s46, 5120
buffer_load_dwordx4 v[108:111], v0, s[40:43], s46 offen nt
s_waitcnt vmcnt(4)
s_mov_b32 s46, 6144
buffer_load_dwordx4 v[112:115], v0, s[40:43], s46 offen nt
s_waitcnt vmcnt(4)
s_mov_b32 s46, 7168
buffer_load_dwordx4 v[116:119], v0, s[40:43], s46 offen nt
.L74:
s_nop 4
v_mul_f32 v6, s44, v6
v_mov_b32 v16, v7
s_nop 1
v_permlane16_swap_b32 v7, v16
v_add_f32 v7, v7, v16
v_mov_b32 v16, v7
s_nop 1
v_permlane32_swap_b32 v7, v16
v_add_f32 v7, v7, v16
v_subrev_u32 v16, s48, v1
v_and_b32 v17, 0xf0, v16
v_lshlrev_b32 v17, 1, v17
v_lshrrev_b32 v18, 8, v16
v_lshl_add_u32 v17, v18, 4, v17
s_mul_i32 s3, s30, 528
s_add_u32 s3, s3, 151808
v_add_u32 v17, s3, v17
s_mov_b32 exec_hi, 0
ds_write_b128 v17, v[8:11]
s_mov_b64 exec, 1
ds_write_b64 v17, v[6:7] offset:512
s_waitcnt lgkmcnt(0)
v_mov_b32 v18, 160264
v_mov_b32 v19, 1
ds_add_rtn_u32 v20, v18, v19
s_waitcnt lgkmcnt(0)
s_mov_b64 exec, -1
v_readfirstlane_b32 s3, v20
s_nop 0
s_and_b32 s3, s3, 7
s_cmp_lg_u32 s3, 7
s_cbranch_scc1 .L75
v_mov_b32 v10, 152320
ds_read_b64 v[16:17], v10 offset:0
ds_read_b64 v[18:19], v10 offset:528
ds_read_b64 v[20:21], v10 offset:1056
ds_read_b64 v[22:23], v10 offset:1584
ds_read_b64 v[24:25], v10 offset:2112
ds_read_b64 v[26:27], v10 offset:2640
ds_read_b64 v[28:29], v10 offset:3168
ds_read_b64 v[30:31], v10 offset:3696
v_subrev_u32 v11, s48, v1
v_lshrrev_b32 v11, 1, v11
v_add_u32 v10, 151808, v11
s_waitcnt lgkmcnt(0)
v_max3_f32 v6, v16, v18, v20
v_max3_f32 v6, v6, v22, v24
v_max3_f32 v6, v6, v26, v28
v_max_f32 v6, v6, v30
v_mov_b32 v7, 0
v_mov_b32 v8, 0
v_mov_b32 v9, 0
v_sub_f32 v16, v16, v6
v_exp_f32 v16, v16
v_sub_f32 v18, v18, v6
v_exp_f32 v18, v18
v_sub_f32 v20, v20, v6
v_exp_f32 v20, v20
v_sub_f32 v22, v22, v6
v_exp_f32 v22, v22
v_sub_f32 v24, v24, v6
v_exp_f32 v24, v24
v_sub_f32 v26, v26, v6
v_exp_f32 v26, v26
v_sub_f32 v28, v28, v6
v_exp_f32 v28, v28
v_sub_f32 v30, v30, v6
v_exp_f32 v30, v30
v_fmac_f32 v7, v16, v17
v_fmac_f32 v7, v18, v19
v_fmac_f32 v7, v20, v21
v_fmac_f32 v7, v22, v23
v_fmac_f32 v7, v24, v25
v_fmac_f32 v7, v26, v27
v_fmac_f32 v7, v28, v29
v_fmac_f32 v7, v30, v31
v_mov_b32 v17, v18
v_mov_b32 v18, v20
v_mov_b32 v19, v22
v_mov_b32 v20, v24
v_mov_b32 v21, v26
v_mov_b32 v22, v28
v_mov_b32 v23, v30
ds_read_b64 v[24:25], v10 offset:0
ds_read_b64 v[26:27], v10 offset:528
ds_read_b64 v[28:29], v10 offset:1056
ds_read_b64 v[30:31], v10 offset:1584
s_waitcnt lgkmcnt(0)
v_fmac_f32 v8, v16, v24
v_fmac_f32 v9, v16, v25
v_fmac_f32 v8, v17, v26
v_fmac_f32 v9, v17, v27
v_fmac_f32 v8, v18, v28
v_fmac_f32 v9, v18, v29
v_fmac_f32 v8, v19, v30
v_fmac_f32 v9, v19, v31
ds_read_b64 v[24:25], v10 offset:2112
ds_read_b64 v[26:27], v10 offset:2640
ds_read_b64 v[28:29], v10 offset:3168
ds_read_b64 v[30:31], v10 offset:3696
s_waitcnt lgkmcnt(0)
v_fmac_f32 v8, v20, v24
v_fmac_f32 v9, v20, v25
v_fmac_f32 v8, v21, v26
v_fmac_f32 v9, v21, v27
v_fmac_f32 v8, v22, v28
v_fmac_f32 v9, v22, v29
v_fmac_f32 v8, v23, v30
v_fmac_f32 v9, v23, v31
v_min_u32 v6, 0xfffffffe, v6
v_min_u32 v7, 0xfffffffe, v7
v_min_u32 v8, 0xfffffffe, v8
v_min_u32 v9, 0xfffffffe, v9
s_add_u32 s3, s51, 8
s_mul_i32 s3, s3, 224
s_add_u32 s3, s3, s2
s_mul_i32 s3, s3, 528
v_add_u32 v11, s3, v11
global_store_dwordx2 v11, v[8:9], s[28:29] offset:0 sc1
s_mov_b64 exec, 1
global_store_dwordx2 v11, v[6:7], s[28:29] offset:512 sc1
s_mov_b64 exec, -1
.L75:
s_nop 4
s_cmp_lg_u32 s54, 0
s_cbranch_scc1 .L76
s_branch .L79
.L77:
s_nop 4
s_add_u32 s3, s52, 0
s_mul_i32 s3, s3, 57344
s_lshl_b32 s4, s2, 8
s_add_u32 s3, s3, s4
s_add_u32 s3, s3, 4194304
v_subrev_u32 v20, s48, v1
v_and_b32 v20, 0xf0, v20
v_add_u32 v20, s3, v20
global_load_dwordx4 v[2:5], v20, s[28:29] sc1
s_waitcnt vmcnt(0)
.L79:
s_nop 4
v_max3_u32 v17, v2, v3, v4
v_max_u32 v17, v17, v5
v_cmp_eq_u32 vcc, -1, v17
s_nop 0
s_cmp_eq_u64 vcc, 0
s_cbranch_scc1 .L78
s_sleep 2
s_add_u32 s47, s47, 1
s_cmp_lt_u32 s47, 262144
s_cbranch_scc1 .L77
s_endpgm
.L78:
s_nop 4
v_mov_b32 v6, 0xff800000
v_mov_b32 v7, 0
v_mov_b32 v8, 0
v_mov_b32 v9, 0
v_mov_b32 v10, 0
v_mov_b32 v11, 0
v_dot2_f32_bf16 v16, v32, v2, 0
v_dot2_f32_bf16 v17, v36, v2, 0
v_dot2_f32_bf16 v18, v40, v2, 0
v_dot2_f32_bf16 v19, v44, v2, 0
v_dot2_f32_bf16 v16, v33, v3, v16
v_dot2_f32_bf16 v17, v37, v3, v17
v_dot2_f32_bf16 v18, v41, v3, v18
v_dot2_f32_bf16 v19, v45, v3, v19
v_dot2_f32_bf16 v16, v34, v4, v16
v_dot2_f32_bf16 v17, v38, v4, v17
v_dot2_f32_bf16 v18, v42, v4, v18
v_dot2_f32_bf16 v19, v46, v4, v19
v_dot2_f32_bf16 v16, v35, v5, v16
v_dot2_f32_bf16 v17, v39, v5, v17
v_dot2_f32_bf16 v18, v43, v5, v18
v_dot2_f32_bf16 v19, v47, v5, v19
v_add_f32_dpp v16, v16, v16 row_ror:8 row_mask:0xf bank_mask:0xf
v_add_f32_dpp v17, v17, v17 row_ror:8 row_mask:0xf bank_mask:0xf
v_add_f32_dpp v18, v18, v18 row_ror:8 row_mask:0xf bank_mask:0xf
v_add_f32_dpp v19, v19, v19 row_ror:8 row_mask:0xf bank_mask:0xf
v_add_f32_dpp v16, v16, v16 row_ror:4 row_mask:0xf bank_mask:0xf
v_add_f32_dpp v17, v17, v17 row_ror:4 row_mask:0xf bank_mask:0xf
v_add_f32_dpp v18, v18, v18 row_ror:4 row_mask:0xf bank_mask:0xf
v_add_f32_dpp v19, v19, v19 row_ror:4 row_mask:0xf bank_mask:0xf
v_add_f32_dpp v16, v16, v16 row_ror:2 row_mask:0xf bank_mask:0xf
v_add_f32_dpp v17, v17, v17 row_ror:2 row_mask:0xf bank_mask:0xf
v_add_f32_dpp v18, v18, v18 row_ror:2 row_mask:0xf bank_mask:0xf
v_add_f32_dpp v19, v19, v19 row_ror:2 row_mask:0xf bank_mask:0xf
v_add_f32_dpp v16, v16, v16 row_ror:1 row_mask:0xf bank_mask:0xf
v_add_f32_dpp v17, v17, v17 row_ror:1 row_mask:0xf bank_mask:0xf
v_add_f32_dpp v18, v18, v18 row_ror:1 row_mask:0xf bank_mask:0xf
v_add_f32_dpp v19, v19, v19 row_ror:1 row_mask:0xf bank_mask:0xf
v_max3_f32 v20, v16, v17, v18
v_max3_f32 v20, v20, v19, v6
v_mov_b32 v21, v20
s_nop 1
v_permlane16_swap_b32 v20, v21
v_max_f32 v20, v20, v21
v_mov_b32 v21, v20
s_nop 1
v_permlane32_swap_b32 v20, v21
v_max_f32 v20, v20, v21
v_sub_f32 v21, v6, v20
v_mul_f32 v21, s44, v21
v_exp_f32 v21, v21
v_mul_f32 v22, s44, v20
v_mov_b32 v6, v20
v_fma_f32 v16, v16, s44, -v22
v_fma_f32 v17, v17, s44, -v22
v_fma_f32 v18, v18, s44, -v22
v_fma_f32 v19, v19, s44, -v22
v_exp_f32 v16, v16
v_exp_f32 v17, v17
v_exp_f32 v18, v18
v_exp_f32 v19, v19
v_mul_f32 v7, v7, v21
v_mul_f32 v8, v8, v21
v_mul_f32 v9, v9, v21
v_mul_f32 v10, v10, v21
v_mul_f32 v11, v11, v21
v_add_f32 v7, v7, v16
v_add_f32 v7, v7, v17
v_add_f32 v7, v7, v18
v_add_f32 v7, v7, v19
v_cvt_pk_bf16_f32 v16, v16, v16
v_cvt_pk_bf16_f32 v17, v17, v17
v_cvt_pk_bf16_f32 v18, v18, v18
v_cvt_pk_bf16_f32 v19, v19, v19
v_and_b32 v20, v12, v16
v_and_b32 v21, v13, v16
v_and_b32 v22, v14, v16
v_and_b32 v23, v15, v16
s_nop 1
v_mfma_f32_16x16x32_bf16 v[8:11], v[20:23], v[88:91], v[8:11]
v_and_b32 v20, v12, v17
v_and_b32 v21, v13, v17
v_and_b32 v22, v14, v17
v_and_b32 v23, v15, v17
s_nop 1
v_mfma_f32_16x16x32_bf16 v[8:11], v[20:23], v[92:95], v[8:11]
v_and_b32 v20, v12, v18
v_and_b32 v21, v13, v18
v_and_b32 v22, v14, v18
v_and_b32 v23, v15, v18
s_nop 1
v_mfma_f32_16x16x32_bf16 v[8:11], v[20:23], v[96:99], v[8:11]
v_and_b32 v20, v12, v19
v_and_b32 v21, v13, v19
v_and_b32 v22, v14, v19
v_and_b32 v23, v15, v19
s_nop 1
v_mfma_f32_16x16x32_bf16 v[8:11], v[20:23], v[100:103], v[8:11]
s_nop 7
s_waitcnt vmcnt(4)
s_mov_b32 s46, 8192
buffer_load_dwordx4 v[64:67], v0, s[36:39], s46 offen nt
s_waitcnt vmcnt(4)
s_mov_b32 s46, 9216
buffer_load_dwordx4 v[68:71], v0, s[36:39], s46 offen nt
s_waitcnt vmcnt(4)
s_mov_b32 s46, 10240
buffer_load_dwordx4 v[72:75], v0, s[36:39], s46 offen nt
s_waitcnt vmcnt(4)
s_mov_b32 s46, 8192
buffer_load_dwordx4 v[120:123], v0, s[40:43], s46 offen nt
s_waitcnt vmcnt(4)
s_mov_b32 s46, 9216
buffer_load_dwordx4 v[124:127], v0, s[40:43], s46 offen nt
s_waitcnt vmcnt(4)
s_mov_b32 s46, 10240
buffer_load_dwordx4 v[128:131], v0, s[40:43], s46 offen nt
v_dot2_f32_bf16 v16, v48, v2, 0
v_dot2_f32_bf16 v17, v52, v2, 0
v_dot2_f32_bf16 v18, v56, v2, 0
v_dot2_f32_bf16 v19, v60, v2, 0
v_dot2_f32_bf16 v16, v49, v3, v16
v_dot2_f32_bf16 v17, v53, v3, v17
v_dot2_f32_bf16 v18, v57, v3, v18
v_dot2_f32_bf16 v19, v61, v3, v19
v_dot2_f32_bf16 v16, v50, v4, v16
v_dot2_f32_bf16 v17, v54, v4, v17
v_dot2_f32_bf16 v18, v58, v4, v18
v_dot2_f32_bf16 v19, v62, v4, v19
v_dot2_f32_bf16 v16, v51, v5, v16
v_dot2_f32_bf16 v17, v55, v5, v17
v_dot2_f32_bf16 v18, v59, v5, v18
v_dot2_f32_bf16 v19, v63, v5, v19
v_add_f32_dpp v16, v16, v16 row_ror:8 row_mask:0xf bank_mask:0xf
v_add_f32_dpp v17, v17, v17 row_ror:8 row_mask:0xf bank_mask:0xf
v_add_f32_dpp v18, v18, v18 row_ror:8 row_mask:0xf bank_mask:0xf
v_add_f32_dpp v19, v19, v19 row_ror:8 row_mask:0xf bank_mask:0xf
v_add_f32_dpp v16, v16, v16 row_ror:4 row_mask:0xf bank_mask:0xf
v_add_f32_dpp v17, v17, v17 row_ror:4 row_mask:0xf bank_mask:0xf
v_add_f32_dpp v18, v18, v18 row_ror:4 row_mask:0xf bank_mask:0xf
v_add_f32_dpp v19, v19, v19 row_ror:4 row_mask:0xf bank_mask:0xf
v_add_f32_dpp v16, v16, v16 row_ror:2 row_mask:0xf bank_mask:0xf
v_add_f32_dpp v17, v17, v17 row_ror:2 row_mask:0xf bank_mask:0xf
v_add_f32_dpp v18, v18, v18 row_ror:2 row_mask:0xf bank_mask:0xf
v_add_f32_dpp v19, v19, v19 row_ror:2 row_mask:0xf bank_mask:0xf
v_add_f32_dpp v16, v16, v16 row_ror:1 row_mask:0xf bank_mask:0xf
v_add_f32_dpp v17, v17, v17 row_ror:1 row_mask:0xf bank_mask:0xf
v_add_f32_dpp v18, v18, v18 row_ror:1 row_mask:0xf bank_mask:0xf
v_add_f32_dpp v19, v19, v19 row_ror:1 row_mask:0xf bank_mask:0xf
v_max3_f32 v20, v16, v17, v18
v_max3_f32 v20, v20, v19, v6
v_mov_b32 v21, v20
s_nop 1
v_permlane16_swap_b32 v20, v21
v_max_f32 v20, v20, v21
v_mov_b32 v21, v20
s_nop 1
v_permlane32_swap_b32 v20, v21
v_max_f32 v20, v20, v21
v_sub_f32 v21, v6, v20
v_mul_f32 v21, s44, v21
v_exp_f32 v21, v21
v_mul_f32 v22, s44, v20
v_mov_b32 v6, v20
v_fma_f32 v16, v16, s44, -v22
v_fma_f32 v17, v17, s44, -v22
v_fma_f32 v18, v18, s44, -v22
v_fma_f32 v19, v19, s44, -v22
v_exp_f32 v16, v16
v_exp_f32 v17, v17
v_exp_f32 v18, v18
v_exp_f32 v19, v19
v_mul_f32 v7, v7, v21
v_mul_f32 v8, v8, v21
v_mul_f32 v9, v9, v21
v_mul_f32 v10, v10, v21
v_mul_f32 v11, v11, v21
v_add_f32 v7, v7, v16
v_add_f32 v7, v7, v17
v_add_f32 v7, v7, v18
v_add_f32 v7, v7, v19
v_cvt_pk_bf16_f32 v16, v16, v16
v_cvt_pk_bf16_f32 v17, v17, v17
v_cvt_pk_bf16_f32 v18, v18, v18
v_cvt_pk_bf16_f32 v19, v19, v19
v_and_b32 v20, v12, v16
v_and_b32 v21, v13, v16
v_and_b32 v22, v14, v16
v_and_b32 v23, v15, v16
s_nop 1
v_mfma_f32_16x16x32_bf16 v[8:11], v[20:23], v[104:107], v[8:11]
v_and_b32 v20, v12, v17
v_and_b32 v21, v13, v17
v_and_b32 v22, v14, v17
v_and_b32 v23, v15, v17
s_nop 1
v_mfma_f32_16x16x32_bf16 v[8:11], v[20:23], v[108:111], v[8:11]
v_and_b32 v20, v12, v18
v_and_b32 v21, v13, v18
v_and_b32 v22, v14, v18
v_and_b32 v23, v15, v18
s_nop 1
v_mfma_f32_16x16x32_bf16 v[8:11], v[20:23], v[112:115], v[8:11]
v_and_b32 v20, v12, v19
v_and_b32 v21, v13, v19
v_and_b32 v22, v14, v19
v_and_b32 v23, v15, v19
s_nop 1
v_mfma_f32_16x16x32_bf16 v[8:11], v[20:23], v[116:119], v[8:11]
s_nop 7
s_waitcnt vmcnt(4)
s_mov_b32 s46, 11264
buffer_load_dwordx4 v[76:79], v0, s[36:39], s46 offen nt
s_waitcnt vmcnt(4)
s_mov_b32 s46, 12288
buffer_load_dwordx4 v[80:83], v0, s[36:39], s46 offen nt
s_waitcnt vmcnt(4)
s_mov_b32 s46, 13312
buffer_load_dwordx4 v[84:87], v0, s[36:39], s46 offen nt
s_waitcnt vmcnt(4)
s_mov_b32 s46, 11264
buffer_load_dwordx4 v[132:135], v0, s[40:43], s46 offen nt
s_waitcnt vmcnt(4)
s_mov_b32 s46, 12288
buffer_load_dwordx4 v[136:139], v0, s[40:43], s46 offen nt
s_waitcnt vmcnt(4)
s_mov_b32 s46, 13312
buffer_load_dwordx4 v[140:143], v0, s[40:43], s46 offen nt
v_dot2_f32_bf16 v16, v64, v2, 0
v_dot2_f32_bf16 v17, v68, v2, 0
v_dot2_f32_bf16 v18, v72, v2, 0
v_dot2_f32_bf16 v16, v65, v3, v16
v_dot2_f32_bf16 v17, v69, v3, v17
v_dot2_f32_bf16 v18, v73, v3, v18
v_dot2_f32_bf16 v16, v66, v4, v16
v_dot2_f32_bf16 v17, v70, v4, v17
v_dot2_f32_bf16 v18, v74, v4, v18
v_dot2_f32_bf16 v16, v67, v5, v16
v_dot2_f32_bf16 v17, v71, v5, v17
v_dot2_f32_bf16 v18, v75, v5, v18
s_nop 0
v_add_f32_dpp v16, v16, v16 row_ror:8 row_mask:0xf bank_mask:0xf
v_add_f32_dpp v17, v17, v17 row_ror:8 row_mask:0xf bank_mask:0xf
v_add_f32_dpp v18, v18, v18 row_ror:8 row_mask:0xf bank_mask:0xf
v_add_f32_dpp v16, v16, v16 row_ror:4 row_mask:0xf bank_mask:0xf
v_add_f32_dpp v17, v17, v17 row_ror:4 row_mask:0xf bank_mask:0xf
v_add_f32_dpp v18, v18, v18 row_ror:4 row_mask:0xf bank_mask:0xf
v_add_f32_dpp v16, v16, v16 row_ror:2 row_mask:0xf bank_mask:0xf
v_add_f32_dpp v17, v17, v17 row_ror:2 row_mask:0xf bank_mask:0xf
v_add_f32_dpp v18, v18, v18 row_ror:2 row_mask:0xf bank_mask:0xf
v_add_f32_dpp v16, v16, v16 row_ror:1 row_mask:0xf bank_mask:0xf
v_add_f32_dpp v17, v17, v17 row_ror:1 row_mask:0xf bank_mask:0xf
v_add_f32_dpp v18, v18, v18 row_ror:1 row_mask:0xf bank_mask:0xf
v_add_f32 v17, s45, v17
v_add_f32 v18, s45, v18
v_max3_f32 v20, v16, v17, v18
v_max_f32 v20, v20, v6
v_mov_b32 v21, v20
s_nop 1
v_permlane16_swap_b32 v20, v21
v_max_f32 v20, v20, v21
v_mov_b32 v21, v20
s_nop 1
v_permlane32_swap_b32 v20, v21
v_max_f32 v20, v20, v21
v_sub_f32 v21, v6, v20
v_mul_f32 v21, s44, v21
v_exp_f32 v21, v21
v_mul_f32 v22, s44, v20
v_mov_b32 v6, v20
v_fma_f32 v16, v16, s44, -v22
v_fma_f32 v17, v17, s44, -v22
v_fma_f32 v18, v18, s44, -v22
v_exp_f32 v16, v16
v_exp_f32 v17, v17
v_exp_f32 v18, v18
v_mul_f32 v7, v7, v21
v_mul_f32 v8, v8, v21
v_mul_f32 v9, v9, v21
v_mul_f32 v10, v10, v21
v_mul_f32 v11, v11, v21
v_add_f32 v7, v7, v16
v_add_f32 v7, v7, v17
v_add_f32 v7, v7, v18
v_cvt_pk_bf16_f32 v16, v16, v16
v_cvt_pk_bf16_f32 v17, v17, v17
v_cvt_pk_bf16_f32 v18, v18, v18
v_and_b32 v20, v12, v16
v_and_b32 v21, v13, v16
v_and_b32 v22, v14, v16
v_and_b32 v23, v15, v16
s_nop 1
v_mfma_f32_16x16x32_bf16 v[8:11], v[20:23], v[120:123], v[8:11]
v_and_b32 v20, v12, v17
v_and_b32 v21, v13, v17
v_and_b32 v22, v14, v17
v_and_b32 v23, v15, v17
s_nop 1
v_mfma_f32_16x16x32_bf16 v[8:11], v[20:23], v[124:127], v[8:11]
v_and_b32 v20, v12, v18
v_and_b32 v21, v13, v18
v_and_b32 v22, v14, v18
v_and_b32 v23, v15, v18
s_nop 1
v_mfma_f32_16x16x32_bf16 v[8:11], v[20:23], v[128:131], v[8:11]
s_waitcnt vmcnt(3)
v_dot2_f32_bf16 v16, v76, v2, 0
v_dot2_f32_bf16 v17, v80, v2, 0
v_dot2_f32_bf16 v18, v84, v2, 0
v_dot2_f32_bf16 v16, v77, v3, v16
v_dot2_f32_bf16 v17, v81, v3, v17
v_dot2_f32_bf16 v18, v85, v3, v18
v_dot2_f32_bf16 v16, v78, v4, v16
v_dot2_f32_bf16 v17, v82, v4, v17
v_dot2_f32_bf16 v18, v86, v4, v18
v_dot2_f32_bf16 v16, v79, v5, v16
v_dot2_f32_bf16 v17, v83, v5, v17
v_dot2_f32_bf16 v18, v87, v5, v18
s_add_u32 s3, s53, 8
s_mul_i32 s3, s3, 57344
s_lshl_b32 s4, s2, 8
s_add_u32 s3, s3, s4
s_add_u32 s3, s3, 4194304
v_subrev_u32 v20, s48, v1
v_and_b32 v20, 0xf0, v20
v_add_u32 v20, s3, v20
global_load_dwordx4 v[2:5], v20, s[28:29] sc1
s_waitcnt vmcnt(1)
v_add_f32_dpp v16, v16, v16 row_ror:8 row_mask:0xf bank_mask:0xf
v_add_f32_dpp v17, v17, v17 row_ror:8 row_mask:0xf bank_mask:0xf
v_add_f32_dpp v18, v18, v18 row_ror:8 row_mask:0xf bank_mask:0xf
v_add_f32_dpp v16, v16, v16 row_ror:4 row_mask:0xf bank_mask:0xf
v_add_f32_dpp v17, v17, v17 row_ror:4 row_mask:0xf bank_mask:0xf
v_add_f32_dpp v18, v18, v18 row_ror:4 row_mask:0xf bank_mask:0xf
v_add_f32_dpp v16, v16, v16 row_ror:2 row_mask:0xf bank_mask:0xf
v_add_f32_dpp v17, v17, v17 row_ror:2 row_mask:0xf bank_mask:0xf
v_add_f32_dpp v18, v18, v18 row_ror:2 row_mask:0xf bank_mask:0xf
v_add_f32_dpp v16, v16, v16 row_ror:1 row_mask:0xf bank_mask:0xf
v_add_f32_dpp v17, v17, v17 row_ror:1 row_mask:0xf bank_mask:0xf
v_add_f32_dpp v18, v18, v18 row_ror:1 row_mask:0xf bank_mask:0xf
v_add_f32 v16, s45, v16
v_add_f32 v17, s45, v17
v_add_f32 v18, s45, v18
v_max3_f32 v20, v16, v17, v18
v_max_f32 v20, v20, v6
v_mov_b32 v21, v20
s_nop 1
v_permlane16_swap_b32 v20, v21
v_max_f32 v20, v20, v21
v_mov_b32 v21, v20
s_nop 1
v_permlane32_swap_b32 v20, v21
v_max_f32 v20, v20, v21
v_sub_f32 v21, v6, v20
v_mul_f32 v21, s44, v21
v_exp_f32 v21, v21
v_mul_f32 v22, s44, v20
v_mov_b32 v6, v20
v_fma_f32 v16, v16, s44, -v22
v_fma_f32 v17, v17, s44, -v22
v_fma_f32 v18, v18, s44, -v22
v_exp_f32 v16, v16
v_exp_f32 v17, v17
v_exp_f32 v18, v18
v_mul_f32 v7, v7, v21
v_mul_f32 v8, v8, v21
v_mul_f32 v9, v9, v21
v_mul_f32 v10, v10, v21
v_mul_f32 v11, v11, v21
v_add_f32 v7, v7, v16
v_add_f32 v7, v7, v17
v_add_f32 v7, v7, v18
v_cvt_pk_bf16_f32 v16, v16, v16
v_cvt_pk_bf16_f32 v17, v17, v17
v_cvt_pk_bf16_f32 v18, v18, v18
v_and_b32 v20, v12, v16
v_and_b32 v21, v13, v16
v_and_b32 v22, v14, v16
v_and_b32 v23, v15, v16
s_nop 1
v_mfma_f32_16x16x32_bf16 v[8:11], v[20:23], v[132:135], v[8:11]
v_and_b32 v20, v12, v17
v_and_b32 v21, v13, v17
v_and_b32 v22, v14, v17
v_and_b32 v23, v15, v17
s_nop 1
v_mfma_f32_16x16x32_bf16 v[8:11], v[20:23], v[136:139], v[8:11]
v_and_b32 v20, v12, v18
v_and_b32 v21, v13, v18
v_and_b32 v22, v14, v18
v_and_b32 v23, v15, v18
s_nop 1
v_mfma_f32_16x16x32_bf16 v[8:11], v[20:23], v[140:143], v[8:11]
v_mul_f32 v6, s44, v6
v_mov_b32 v16, v7
s_nop 1
v_permlane16_swap_b32 v7, v16
v_add_f32 v7, v7, v16
v_mov_b32 v16, v7
s_nop 1
v_permlane32_swap_b32 v7, v16
v_add_f32 v7, v7, v16
v_subrev_u32 v16, s48, v1
v_and_b32 v17, 0xf0, v16
v_lshlrev_b32 v17, 1, v17
v_lshrrev_b32 v18, 8, v16
v_lshl_add_u32 v17, v18, 4, v17
s_mul_i32 s3, s30, 528
s_add_u32 s3, s3, 143360
v_add_u32 v17, s3, v17
s_mov_b32 exec_hi, 0
ds_write_b128 v17, v[8:11]
s_mov_b64 exec, 1
ds_write_b64 v17, v[6:7] offset:512
s_waitcnt lgkmcnt(0)
v_mov_b32 v18, 160256
v_mov_b32 v19, 1
ds_add_rtn_u32 v20, v18, v19
s_waitcnt lgkmcnt(0)
s_mov_b64 exec, -1
v_readfirstlane_b32 s3, v20
s_nop 0
s_and_b32 s3, s3, 7
s_cmp_lg_u32 s3, 7
s_cbranch_scc1 .L82
v_mov_b32 v10, 143872
ds_read_b64 v[16:17], v10 offset:0
ds_read_b64 v[18:19], v10 offset:528
ds_read_b64 v[20:21], v10 offset:1056
ds_read_b64 v[22:23], v10 offset:1584
ds_read_b64 v[24:25], v10 offset:2112
ds_read_b64 v[26:27], v10 offset:2640
ds_read_b64 v[28:29], v10 offset:3168
ds_read_b64 v[30:31], v10 offset:3696
v_subrev_u32 v11, s48, v1
v_lshrrev_b32 v11, 1, v11
v_add_u32 v10, 143360, v11
s_waitcnt lgkmcnt(0)
v_max3_f32 v6, v16, v18, v20
v_max3_f32 v6, v6, v22, v24
v_max3_f32 v6, v6, v26, v28
v_max_f32 v6, v6, v30
v_mov_b32 v7, 0
v_mov_b32 v8, 0
v_mov_b32 v9, 0
v_sub_f32 v16, v16, v6
v_exp_f32 v16, v16
v_sub_f32 v18, v18, v6
v_exp_f32 v18, v18
v_sub_f32 v20, v20, v6
v_exp_f32 v20, v20
v_sub_f32 v22, v22, v6
v_exp_f32 v22, v22
v_sub_f32 v24, v24, v6
v_exp_f32 v24, v24
v_sub_f32 v26, v26, v6
v_exp_f32 v26, v26
v_sub_f32 v28, v28, v6
v_exp_f32 v28, v28
v_sub_f32 v30, v30, v6
v_exp_f32 v30, v30
v_fmac_f32 v7, v16, v17
v_fmac_f32 v7, v18, v19
v_fmac_f32 v7, v20, v21
v_fmac_f32 v7, v22, v23
v_fmac_f32 v7, v24, v25
v_fmac_f32 v7, v26, v27
v_fmac_f32 v7, v28, v29
v_fmac_f32 v7, v30, v31
v_mov_b32 v17, v18
v_mov_b32 v18, v20
v_mov_b32 v19, v22
v_mov_b32 v20, v24
v_mov_b32 v21, v26
v_mov_b32 v22, v28
v_mov_b32 v23, v30
ds_read_b64 v[24:25], v10 offset:0
ds_read_b64 v[26:27], v10 offset:528
ds_read_b64 v[28:29], v10 offset:1056
ds_read_b64 v[30:31], v10 offset:1584
s_waitcnt lgkmcnt(0)
v_fmac_f32 v8, v16, v24
v_fmac_f32 v9, v16, v25
v_fmac_f32 v8, v17, v26
v_fmac_f32 v9, v17, v27
v_fmac_f32 v8, v18, v28
v_fmac_f32 v9, v18, v29
v_fmac_f32 v8, v19, v30
v_fmac_f32 v9, v19, v31
ds_read_b64 v[24:25], v10 offset:2112
ds_read_b64 v[26:27], v10 offset:2640
ds_read_b64 v[28:29], v10 offset:3168
ds_read_b64 v[30:31], v10 offset:3696
s_waitcnt lgkmcnt(0)
v_fmac_f32 v8, v20, v24
v_fmac_f32 v9, v20, v25
v_fmac_f32 v8, v21, v26
v_fmac_f32 v9, v21, v27
v_fmac_f32 v8, v22, v28
v_fmac_f32 v9, v22, v29
v_fmac_f32 v8, v23, v30
v_fmac_f32 v9, v23, v31
v_min_u32 v6, 0xfffffffe, v6
v_min_u32 v7, 0xfffffffe, v7
v_min_u32 v8, 0xfffffffe, v8
v_min_u32 v9, 0xfffffffe, v9
s_add_u32 s3, s52, 0
s_mul_i32 s3, s3, 224
s_add_u32 s3, s3, s2
s_mul_i32 s3, s3, 528
v_add_u32 v11, s3, v11
global_store_dwordx2 v11, v[8:9], s[28:29] offset:0 sc1
s_mov_b64 exec, 1
global_store_dwordx2 v11, v[6:7], s[28:29] offset:512 sc1
s_mov_b64 exec, -1
.L82:
s_nop 4
s_add_u32 s36, s36, 0x2000000
s_addc_u32 s37, s37, 0
s_add_u32 s40, s40, 0x2000000
s_addc_u32 s41, s41, 0
.L76:
s_nop 4
s_add_u32 s51, s51, 1
s_cmp_ge_u32 s51, 6
s_cselect_b32 s54, 1, 0
s_add_u32 s52, s51, 2
s_add_u32 s53, s51, 1
s_waitcnt vmcnt(0)
s_branch .L85
.L83:
s_nop 4
s_add_u32 s3, s51, 8
s_mul_i32 s3, s3, 57344
s_lshl_b32 s4, s2, 8
s_add_u32 s3, s3, s4
s_add_u32 s3, s3, 4194304
v_subrev_u32 v20, s48, v1
v_and_b32 v20, 0xf0, v20
v_add_u32 v20, s3, v20
global_load_dwordx4 v[2:5], v20, s[28:29] sc1
s_waitcnt vmcnt(0)
.L85:
s_nop 4
v_max3_u32 v17, v2, v3, v4
v_max_u32 v17, v17, v5
v_cmp_eq_u32 vcc, -1, v17
s_nop 0
s_cmp_eq_u64 vcc, 0
s_cbranch_scc1 .L84
s_sleep 2
s_add_u32 s47, s47, 1
s_cmp_lt_u32 s47, 262144
s_cbranch_scc1 .L83
s_endpgm
.L84:
s_nop 4
v_mov_b32 v6, 0xff800000
v_mov_b32 v7, 0
v_mov_b32 v8, 0
v_mov_b32 v9, 0
v_mov_b32 v10, 0
v_mov_b32 v11, 0
v_dot2_f32_bf16 v16, v144, v2, 0
v_dot2_f32_bf16 v17, v148, v2, 0
v_dot2_f32_bf16 v18, v152, v2, 0
v_dot2_f32_bf16 v19, v156, v2, 0
v_dot2_f32_bf16 v16, v145, v3, v16
v_dot2_f32_bf16 v17, v149, v3, v17
v_dot2_f32_bf16 v18, v153, v3, v18
v_dot2_f32_bf16 v19, v157, v3, v19
v_dot2_f32_bf16 v16, v146, v4, v16
v_dot2_f32_bf16 v17, v150, v4, v17
v_dot2_f32_bf16 v18, v154, v4, v18
v_dot2_f32_bf16 v19, v158, v4, v19
v_dot2_f32_bf16 v16, v147, v5, v16
v_dot2_f32_bf16 v17, v151, v5, v17
v_dot2_f32_bf16 v18, v155, v5, v18
v_dot2_f32_bf16 v19, v159, v5, v19
v_add_f32_dpp v16, v16, v16 row_ror:8 row_mask:0xf bank_mask:0xf
v_add_f32_dpp v17, v17, v17 row_ror:8 row_mask:0xf bank_mask:0xf
v_add_f32_dpp v18, v18, v18 row_ror:8 row_mask:0xf bank_mask:0xf
v_add_f32_dpp v19, v19, v19 row_ror:8 row_mask:0xf bank_mask:0xf
v_add_f32_dpp v16, v16, v16 row_ror:4 row_mask:0xf bank_mask:0xf
v_add_f32_dpp v17, v17, v17 row_ror:4 row_mask:0xf bank_mask:0xf
v_add_f32_dpp v18, v18, v18 row_ror:4 row_mask:0xf bank_mask:0xf
v_add_f32_dpp v19, v19, v19 row_ror:4 row_mask:0xf bank_mask:0xf
v_add_f32_dpp v16, v16, v16 row_ror:2 row_mask:0xf bank_mask:0xf
v_add_f32_dpp v17, v17, v17 row_ror:2 row_mask:0xf bank_mask:0xf
v_add_f32_dpp v18, v18, v18 row_ror:2 row_mask:0xf bank_mask:0xf
v_add_f32_dpp v19, v19, v19 row_ror:2 row_mask:0xf bank_mask:0xf
v_add_f32_dpp v16, v16, v16 row_ror:1 row_mask:0xf bank_mask:0xf
v_add_f32_dpp v17, v17, v17 row_ror:1 row_mask:0xf bank_mask:0xf
v_add_f32_dpp v18, v18, v18 row_ror:1 row_mask:0xf bank_mask:0xf
v_add_f32_dpp v19, v19, v19 row_ror:1 row_mask:0xf bank_mask:0xf
v_max3_f32 v20, v16, v17, v18
v_max3_f32 v20, v20, v19, v6
v_mov_b32 v21, v20
s_nop 1
v_permlane16_swap_b32 v20, v21
v_max_f32 v20, v20, v21
v_mov_b32 v21, v20
s_nop 1
v_permlane32_swap_b32 v20, v21
v_max_f32 v20, v20, v21
v_sub_f32 v21, v6, v20
v_mul_f32 v21, s44, v21
v_exp_f32 v21, v21
v_mul_f32 v22, s44, v20
v_mov_b32 v6, v20
v_fma_f32 v16, v16, s44, -v22
v_fma_f32 v17, v17, s44, -v22
v_fma_f32 v18, v18, s44, -v22
v_fma_f32 v19, v19, s44, -v22
v_exp_f32 v16, v16
v_exp_f32 v17, v17
v_exp_f32 v18, v18
v_exp_f32 v19, v19
v_mul_f32 v7, v7, v21
v_mul_f32 v8, v8, v21
v_mul_f32 v9, v9, v21
v_mul_f32 v10, v10, v21
v_mul_f32 v11, v11, v21
v_add_f32 v7, v7, v16
v_add_f32 v7, v7, v17
v_add_f32 v7, v7, v18
v_add_f32 v7, v7, v19
v_cvt_pk_bf16_f32 v16, v16, v16
v_cvt_pk_bf16_f32 v17, v17, v17
v_cvt_pk_bf16_f32 v18, v18, v18
v_cvt_pk_bf16_f32 v19, v19, v19
v_and_b32 v20, v12, v16
v_and_b32 v21, v13, v16
v_and_b32 v22, v14, v16
v_and_b32 v23, v15, v16
s_nop 1
v_mfma_f32_16x16x32_bf16 v[8:11], v[20:23], v[200:203], v[8:11]
v_and_b32 v20, v12, v17
v_and_b32 v21, v13, v17
v_and_b32 v22, v14, v17
v_and_b32 v23, v15, v17
s_nop 1
v_mfma_f32_16x16x32_bf16 v[8:11], v[20:23], v[204:207], v[8:11]
v_and_b32 v20, v12, v18
v_and_b32 v21, v13, v18
v_and_b32 v22, v14, v18
v_and_b32 v23, v15, v18
s_nop 1
v_mfma_f32_16x16x32_bf16 v[8:11], v[20:23], v[208:211], v[8:11]
v_and_b32 v20, v12, v19
v_and_b32 v21, v13, v19
v_and_b32 v22, v14, v19
v_and_b32 v23, v15, v19
s_nop 1
v_mfma_f32_16x16x32_bf16 v[8:11], v[20:23], v[212:215], v[8:11]
s_cmp_lg_u32 s54, 0
s_cbranch_scc1 .L86
s_nop 7
s_mov_b32 s46, 0
buffer_load_dwordx4 v[144:147], v0, s[36:39], s46 offen nt
s_mov_b32 s46, 1024
buffer_load_dwordx4 v[148:151], v0, s[36:39], s46 offen nt
s_mov_b32 s46, 2048
buffer_load_dwordx4 v[152:155], v0, s[36:39], s46 offen nt
s_mov_b32 s46, 3072
buffer_load_dwordx4 v[156:159], v0, s[36:39], s46 offen nt
s_mov_b32 s46, 0
buffer_load_dwordx4 v[200:203], v0, s[40:43], s46 offen nt
s_waitcnt vmcnt(4)
s_mov_b32 s46, 1024
buffer_load_dwordx4 v[204:207], v0, s[40:43], s46 offen nt
s_waitcnt vmcnt(4)
s_mov_b32 s46, 2048
buffer_load_dwordx4 v[208:211], v0, s[40:43], s46 offen nt
s_waitcnt vmcnt(4)
s_mov_b32 s46, 3072
buffer_load_dwordx4 v[212:215], v0, s[40:43], s46 offen nt
.L86:
s_nop 4
v_dot2_f32_bf16 v16, v160, v2, 0
v_dot2_f32_bf16 v17, v164, v2, 0
v_dot2_f32_bf16 v18, v168, v2, 0
v_dot2_f32_bf16 v19, v172, v2, 0
v_dot2_f32_bf16 v16, v161, v3, v16
v_dot2_f32_bf16 v17, v165, v3, v17
v_dot2_f32_bf16 v18, v169, v3, v18
v_dot2_f32_bf16 v19, v173, v3, v19
v_dot2_f32_bf16 v16, v162, v4, v16
v_dot2_f32_bf16 v17, v166, v4, v17
v_dot2_f32_bf16 v18, v170, v4, v18
v_dot2_f32_bf16 v19, v174, v4, v19
v_dot2_f32_bf16 v16, v163, v5, v16
v_dot2_f32_bf16 v17, v167, v5, v17
v_dot2_f32_bf16 v18, v171, v5, v18
v_dot2_f32_bf16 v19, v175, v5, v19
v_add_f32_dpp v16, v16, v16 row_ror:8 row_mask:0xf bank_mask:0xf
v_add_f32_dpp v17, v17, v17 row_ror:8 row_mask:0xf bank_mask:0xf
v_add_f32_dpp v18, v18, v18 row_ror:8 row_mask:0xf bank_mask:0xf
v_add_f32_dpp v19, v19, v19 row_ror:8 row_mask:0xf bank_mask:0xf
v_add_f32_dpp v16, v16, v16 row_ror:4 row_mask:0xf bank_mask:0xf
v_add_f32_dpp v17, v17, v17 row_ror:4 row_mask:0xf bank_mask:0xf
v_add_f32_dpp v18, v18, v18 row_ror:4 row_mask:0xf bank_mask:0xf
v_add_f32_dpp v19, v19, v19 row_ror:4 row_mask:0xf bank_mask:0xf
v_add_f32_dpp v16, v16, v16 row_ror:2 row_mask:0xf bank_mask:0xf
v_add_f32_dpp v17, v17, v17 row_ror:2 row_mask:0xf bank_mask:0xf
v_add_f32_dpp v18, v18, v18 row_ror:2 row_mask:0xf bank_mask:0xf
v_add_f32_dpp v19, v19, v19 row_ror:2 row_mask:0xf bank_mask:0xf
v_add_f32_dpp v16, v16, v16 row_ror:1 row_mask:0xf bank_mask:0xf
v_add_f32_dpp v17, v17, v17 row_ror:1 row_mask:0xf bank_mask:0xf
v_add_f32_dpp v18, v18, v18 row_ror:1 row_mask:0xf bank_mask:0xf
v_add_f32_dpp v19, v19, v19 row_ror:1 row_mask:0xf bank_mask:0xf
v_max3_f32 v20, v16, v17, v18
v_max3_f32 v20, v20, v19, v6
v_mov_b32 v21, v20
s_nop 1
v_permlane16_swap_b32 v20, v21
v_max_f32 v20, v20, v21
v_mov_b32 v21, v20
s_nop 1
v_permlane32_swap_b32 v20, v21
v_max_f32 v20, v20, v21
v_sub_f32 v21, v6, v20
v_mul_f32 v21, s44, v21
v_exp_f32 v21, v21
v_mul_f32 v22, s44, v20
v_mov_b32 v6, v20
v_fma_f32 v16, v16, s44, -v22
v_fma_f32 v17, v17, s44, -v22
v_fma_f32 v18, v18, s44, -v22
v_fma_f32 v19, v19, s44, -v22
v_exp_f32 v16, v16
v_exp_f32 v17, v17
v_exp_f32 v18, v18
v_exp_f32 v19, v19
v_mul_f32 v7, v7, v21
v_mul_f32 v8, v8, v21
v_mul_f32 v9, v9, v21
v_mul_f32 v10, v10, v21
v_mul_f32 v11, v11, v21
v_add_f32 v7, v7, v16
v_add_f32 v7, v7, v17
v_add_f32 v7, v7, v18
v_add_f32 v7, v7, v19
v_cvt_pk_bf16_f32 v16, v16, v16
v_cvt_pk_bf16_f32 v17, v17, v17
v_cvt_pk_bf16_f32 v18, v18, v18
v_cvt_pk_bf16_f32 v19, v19, v19
v_and_b32 v20, v12, v16
v_and_b32 v21, v13, v16
v_and_b32 v22, v14, v16
v_and_b32 v23, v15, v16
s_nop 1
v_mfma_f32_16x16x32_bf16 v[8:11], v[20:23], v[216:219], v[8:11]
v_and_b32 v20, v12, v17
v_and_b32 v21, v13, v17
v_and_b32 v22, v14, v17
v_and_b32 v23, v15, v17
s_nop 1
v_mfma_f32_16x16x32_bf16 v[8:11], v[20:23], v[220:223], v[8:11]
v_and_b32 v20, v12, v18
v_and_b32 v21, v13, v18
v_and_b32 v22, v14, v18
v_and_b32 v23, v15, v18
s_nop 1
v_mfma_f32_16x16x32_bf16 v[8:11], v[20:23], v[224:227], v[8:11]
v_and_b32 v20, v12, v19
v_and_b32 v21, v13, v19
v_and_b32 v22, v14, v19
v_and_b32 v23, v15, v19
s_nop 1
v_mfma_f32_16x16x32_bf16 v[8:11], v[20:23], v[228:231], v[8:11]
v_dot2_f32_bf16 v16, v176, v2, 0
v_dot2_f32_bf16 v17, v180, v2, 0
v_dot2_f32_bf16 v18, v184, v2, 0
v_dot2_f32_bf16 v16, v177, v3, v16
v_dot2_f32_bf16 v17, v181, v3, v17
v_dot2_f32_bf16 v18, v185, v3, v18
v_dot2_f32_bf16 v16, v178, v4, v16
v_dot2_f32_bf16 v17, v182, v4, v17
v_dot2_f32_bf16 v18, v186, v4, v18
v_dot2_f32_bf16 v16, v179, v5, v16
v_dot2_f32_bf16 v17, v183, v5, v17
v_dot2_f32_bf16 v18, v187, v5, v18
s_nop 0
v_add_f32_dpp v16, v16, v16 row_ror:8 row_mask:0xf bank_mask:0xf
v_add_f32_dpp v17, v17, v17 row_ror:8 row_mask:0xf bank_mask:0xf
v_add_f32_dpp v18, v18, v18 row_ror:8 row_mask:0xf bank_mask:0xf
v_add_f32_dpp v16, v16, v16 row_ror:4 row_mask:0xf bank_mask:0xf
v_add_f32_dpp v17, v17, v17 row_ror:4 row_mask:0xf bank_mask:0xf
v_add_f32_dpp v18, v18, v18 row_ror:4 row_mask:0xf bank_mask:0xf
v_add_f32_dpp v16, v16, v16 row_ror:2 row_mask:0xf bank_mask:0xf
v_add_f32_dpp v17, v17, v17 row_ror:2 row_mask:0xf bank_mask:0xf
v_add_f32_dpp v18, v18, v18 row_ror:2 row_mask:0xf bank_mask:0xf
v_add_f32_dpp v16, v16, v16 row_ror:1 row_mask:0xf bank_mask:0xf
v_add_f32_dpp v17, v17, v17 row_ror:1 row_mask:0xf bank_mask:0xf
v_add_f32_dpp v18, v18, v18 row_ror:1 row_mask:0xf bank_mask:0xf
v_add_f32 v17, s45, v17
v_add_f32 v18, s45, v18
v_max3_f32 v20, v16, v17, v18
v_max_f32 v20, v20, v6
v_mov_b32 v21, v20
s_nop 1
v_permlane16_swap_b32 v20, v21
v_max_f32 v20, v20, v21
v_mov_b32 v21, v20
s_nop 1
v_permlane32_swap_b32 v20, v21
v_max_f32 v20, v20, v21
v_sub_f32 v21, v6, v20
v_mul_f32 v21, s44, v21
v_exp_f32 v21, v21
v_mul_f32 v22, s44, v20
v_mov_b32 v6, v20
v_fma_f32 v16, v16, s44, -v22
v_fma_f32 v17, v17, s44, -v22
v_fma_f32 v18, v18, s44, -v22
v_exp_f32 v16, v16
v_exp_f32 v17, v17
v_exp_f32 v18, v18
v_mul_f32 v7, v7, v21
v_mul_f32 v8, v8, v21
v_mul_f32 v9, v9, v21
v_mul_f32 v10, v10, v21
v_mul_f32 v11, v11, v21
v_add_f32 v7, v7, v16
v_add_f32 v7, v7, v17
v_add_f32 v7, v7, v18
v_cvt_pk_bf16_f32 v16, v16, v16
v_cvt_pk_bf16_f32 v17, v17, v17
v_cvt_pk_bf16_f32 v18, v18, v18
v_and_b32 v20, v12, v16
v_and_b32 v21, v13, v16
v_and_b32 v22, v14, v16
v_and_b32 v23, v15, v16
s_nop 1
v_mfma_f32_16x16x32_bf16 v[8:11], v[20:23], v[232:235], v[8:11]
v_and_b32 v20, v12, v17
v_and_b32 v21, v13, v17
v_and_b32 v22, v14, v17
v_and_b32 v23, v15, v17
s_nop 1
v_mfma_f32_16x16x32_bf16 v[8:11], v[20:23], v[236:239], v[8:11]
v_and_b32 v20, v12, v18
v_and_b32 v21, v13, v18
v_and_b32 v22, v14, v18
v_and_b32 v23, v15, v18
s_nop 1
v_mfma_f32_16x16x32_bf16 v[8:11], v[20:23], v[240:243], v[8:11]
v_dot2_f32_bf16 v16, v188, v2, 0
v_dot2_f32_bf16 v17, v192, v2, 0
v_dot2_f32_bf16 v18, v196, v2, 0
v_dot2_f32_bf16 v16, v189, v3, v16
v_dot2_f32_bf16 v17, v193, v3, v17
v_dot2_f32_bf16 v18, v197, v3, v18
v_dot2_f32_bf16 v16, v190, v4, v16
v_dot2_f32_bf16 v17, v194, v4, v17
v_dot2_f32_bf16 v18, v198, v4, v18
v_dot2_f32_bf16 v16, v191, v5, v16
v_dot2_f32_bf16 v17, v195, v5, v17
v_dot2_f32_bf16 v18, v199, v5, v18
s_cmp_lg_u32 s54, 0
s_cbranch_scc1 .L87
s_add_u32 s3, s52, 0
s_mul_i32 s3, s3, 57344
s_lshl_b32 s4, s2, 8
s_add_u32 s3, s3, s4
s_add_u32 s3, s3, 4194304
v_subrev_u32 v20, s48, v1
v_and_b32 v20, 0xf0, v20
v_add_u32 v20, s3, v20
s_branch .L88
.L87:
s_nop 4
s_min_u32 s53, s53, 7
s_add_u32 s3, s53, 8
s_mul_i32 s3, s3, 57344
s_lshl_b32 s4, s2, 8
s_add_u32 s3, s3, s4
s_add_u32 s3, s3, 4194304
v_subrev_u32 v20, s48, v1
v_and_b32 v20, 0xf0, v20
v_add_u32 v20, s3, v20
.L88:
s_nop 4
global_load_dwordx4 v[2:5], v20, s[28:29] sc1
v_add_f32_dpp v16, v16, v16 row_ror:8 row_mask:0xf bank_mask:0xf
v_add_f32_dpp v17, v17, v17 row_ror:8 row_mask:0xf bank_mask:0xf
v_add_f32_dpp v18, v18, v18 row_ror:8 row_mask:0xf bank_mask:0xf
v_add_f32_dpp v16, v16, v16 row_ror:4 row_mask:0xf bank_mask:0xf
v_add_f32_dpp v17, v17, v17 row_ror:4 row_mask:0xf bank_mask:0xf
v_add_f32_dpp v18, v18, v18 row_ror:4 row_mask:0xf bank_mask:0xf
v_add_f32_dpp v16, v16, v16 row_ror:2 row_mask:0xf bank_mask:0xf
v_add_f32_dpp v17, v17, v17 row_ror:2 row_mask:0xf bank_mask:0xf
v_add_f32_dpp v18, v18, v18 row_ror:2 row_mask:0xf bank_mask:0xf
v_add_f32_dpp v16, v16, v16 row_ror:1 row_mask:0xf bank_mask:0xf
v_add_f32_dpp v17, v17, v17 row_ror:1 row_mask:0xf bank_mask:0xf
v_add_f32_dpp v18, v18, v18 row_ror:1 row_mask:0xf bank_mask:0xf
v_add_f32 v16, s45, v16
v_add_f32 v17, s45, v17
v_add_f32 v18, s45, v18
v_max3_f32 v20, v16, v17, v18
v_max_f32 v20, v20, v6
v_mov_b32 v21, v20
s_nop 1
v_permlane16_swap_b32 v20, v21
v_max_f32 v20, v20, v21
v_mov_b32 v21, v20
s_nop 1
v_permlane32_swap_b32 v20, v21
v_max_f32 v20, v20, v21
v_sub_f32 v21, v6, v20
v_mul_f32 v21, s44, v21
v_exp_f32 v21, v21
v_mul_f32 v22, s44, v20
v_mov_b32 v6, v20
v_fma_f32 v16, v16, s44, -v22
v_fma_f32 v17, v17, s44, -v22
v_fma_f32 v18, v18, s44, -v22
v_exp_f32 v16, v16
v_exp_f32 v17, v17
v_exp_f32 v18, v18
v_mul_f32 v7, v7, v21
v_mul_f32 v8, v8, v21
v_mul_f32 v9, v9, v21
v_mul_f32 v10, v10, v21
v_mul_f32 v11, v11, v21
v_add_f32 v7, v7, v16
v_add_f32 v7, v7, v17
v_add_f32 v7, v7, v18
v_cvt_pk_bf16_f32 v16, v16, v16
v_cvt_pk_bf16_f32 v17, v17, v17
v_cvt_pk_bf16_f32 v18, v18, v18
v_and_b32 v20, v12, v16
v_and_b32 v21, v13, v16
v_and_b32 v22, v14, v16
v_and_b32 v23, v15, v16
s_nop 1
v_mfma_f32_16x16x32_bf16 v[8:11], v[20:23], v[244:247], v[8:11]
v_and_b32 v20, v12, v17
v_and_b32 v21, v13, v17
v_and_b32 v22, v14, v17
v_and_b32 v23, v15, v17
s_nop 1
v_mfma_f32_16x16x32_bf16 v[8:11], v[20:23], v[248:251], v[8:11]
v_and_b32 v20, v12, v18
v_and_b32 v21, v13, v18
v_and_b32 v22, v14, v18
v_and_b32 v23, v15, v18
s_nop 1
v_mfma_f32_16x16x32_bf16 v[8:11], v[20:23], v[252:255], v[8:11]
s_cmp_lg_u32 s54, 0
s_cbranch_scc1 .L89
s_nop 7
s_waitcnt vmcnt(4)
s_mov_b32 s46, 4096
buffer_load_dwordx4 v[160:163], v0, s[36:39], s46 offen nt
s_waitcnt vmcnt(4)
s_mov_b32 s46, 5120
buffer_load_dwordx4 v[164:167], v0, s[36:39], s46 offen nt
s_waitcnt vmcnt(4)
s_mov_b32 s46, 6144
buffer_load_dwordx4 v[168:171], v0, s[36:39], s46 offen nt
s_waitcnt vmcnt(4)
s_mov_b32 s46, 7168
buffer_load_dwordx4 v[172:175], v0, s[36:39], s46 offen nt
s_waitcnt vmcnt(4)
s_mov_b32 s46, 4096
buffer_load_dwordx4 v[216:219], v0, s[40:43], s46 offen nt
s_waitcnt vmcnt(4)
s_mov_b32 s46, 5120
buffer_load_dwordx4 v[220:223], v0, s[40:43], s46 offen nt
s_waitcnt vmcnt(4)
s_mov_b32 s46, 6144
buffer_load_dwordx4 v[224:227], v0, s[40:43], s46 offen nt
s_waitcnt vmcnt(4)
s_mov_b32 s46, 7168
buffer_load_dwordx4 v[228:231], v0, s[40:43], s46 offen nt
.L89:
s_nop 4
v_mul_f32 v6, s44, v6
v_mov_b32 v16, v7
s_nop 1
v_permlane16_swap_b32 v7, v16
v_add_f32 v7, v7, v16
v_mov_b32 v16, v7
s_nop 1
v_permlane32_swap_b32 v7, v16
v_add_f32 v7, v7, v16
v_subrev_u32 v16, s48, v1
v_and_b32 v17, 0xf0, v16
v_lshlrev_b32 v17, 1, v17
v_lshrrev_b32 v18, 8, v16
v_lshl_add_u32 v17, v18, 4, v17
s_mul_i32 s3, s30, 528
s_add_u32 s3, s3, 156032
v_add_u32 v17, s3, v17
s_mov_b32 exec_hi, 0
ds_write_b128 v17, v[8:11]
s_mov_b64 exec, 1
ds_write_b64 v17, v[6:7] offset:512
s_waitcnt lgkmcnt(0)
v_mov_b32 v18, 160268
v_mov_b32 v19, 1
ds_add_rtn_u32 v20, v18, v19
s_waitcnt lgkmcnt(0)
s_mov_b64 exec, -1
v_readfirstlane_b32 s3, v20
s_nop 0
s_and_b32 s3, s3, 7
s_cmp_lg_u32 s3, 7
s_cbranch_scc1 .L90
v_mov_b32 v10, 156544
ds_read_b64 v[16:17], v10 offset:0
ds_read_b64 v[18:19], v10 offset:528
ds_read_b64 v[20:21], v10 offset:1056
ds_read_b64 v[22:23], v10 offset:1584
ds_read_b64 v[24:25], v10 offset:2112
ds_read_b64 v[26:27], v10 offset:2640
ds_read_b64 v[28:29], v10 offset:3168
ds_read_b64 v[30:31], v10 offset:3696
v_subrev_u32 v11, s48, v1
v_lshrrev_b32 v11, 1, v11
v_add_u32 v10, 156032, v11
s_waitcnt lgkmcnt(0)
v_max3_f32 v6, v16, v18, v20
v_max3_f32 v6, v6, v22, v24
v_max3_f32 v6, v6, v26, v28
v_max_f32 v6, v6, v30
v_mov_b32 v7, 0
v_mov_b32 v8, 0
v_mov_b32 v9, 0
v_sub_f32 v16, v16, v6
v_exp_f32 v16, v16
v_sub_f32 v18, v18, v6
v_exp_f32 v18, v18
v_sub_f32 v20, v20, v6
v_exp_f32 v20, v20
v_sub_f32 v22, v22, v6
v_exp_f32 v22, v22
v_sub_f32 v24, v24, v6
v_exp_f32 v24, v24
v_sub_f32 v26, v26, v6
v_exp_f32 v26, v26
v_sub_f32 v28, v28, v6
v_exp_f32 v28, v28
v_sub_f32 v30, v30, v6
v_exp_f32 v30, v30
v_fmac_f32 v7, v16, v17
v_fmac_f32 v7, v18, v19
v_fmac_f32 v7, v20, v21
v_fmac_f32 v7, v22, v23
v_fmac_f32 v7, v24, v25
v_fmac_f32 v7, v26, v27
v_fmac_f32 v7, v28, v29
v_fmac_f32 v7, v30, v31
v_mov_b32 v17, v18
v_mov_b32 v18, v20
v_mov_b32 v19, v22
v_mov_b32 v20, v24
v_mov_b32 v21, v26
v_mov_b32 v22, v28
v_mov_b32 v23, v30
ds_read_b64 v[24:25], v10 offset:0
ds_read_b64 v[26:27], v10 offset:528
ds_read_b64 v[28:29], v10 offset:1056
ds_read_b64 v[30:31], v10 offset:1584
s_waitcnt lgkmcnt(0)
v_fmac_f32 v8, v16, v24
v_fmac_f32 v9, v16, v25
v_fmac_f32 v8, v17, v26
v_fmac_f32 v9, v17, v27
v_fmac_f32 v8, v18, v28
v_fmac_f32 v9, v18, v29
v_fmac_f32 v8, v19, v30
v_fmac_f32 v9, v19, v31
ds_read_b64 v[24:25], v10 offset:2112
ds_read_b64 v[26:27], v10 offset:2640
ds_read_b64 v[28:29], v10 offset:3168
ds_read_b64 v[30:31], v10 offset:3696
s_waitcnt lgkmcnt(0)
v_fmac_f32 v8, v20, v24
v_fmac_f32 v9, v20, v25
v_fmac_f32 v8, v21, v26
v_fmac_f32 v9, v21, v27
v_fmac_f32 v8, v22, v28
v_fmac_f32 v9, v22, v29
v_fmac_f32 v8, v23, v30
v_fmac_f32 v9, v23, v31
v_min_u32 v6, 0xfffffffe, v6
v_min_u32 v7, 0xfffffffe, v7
v_min_u32 v8, 0xfffffffe, v8
v_min_u32 v9, 0xfffffffe, v9
s_add_u32 s3, s51, 8
s_mul_i32 s3, s3, 224
s_add_u32 s3, s3, s2
s_mul_i32 s3, s3, 528
v_add_u32 v11, s3, v11
global_store_dwordx2 v11, v[8:9], s[28:29] offset:0 sc1
s_mov_b64 exec, 1
global_store_dwordx2 v11, v[6:7], s[28:29] offset:512 sc1
s_mov_b64 exec, -1
.L90:
s_nop 4
s_cmp_lg_u32 s54, 0
s_cbranch_scc1 .L91
s_branch .L94
.L92:
s_nop 4
s_add_u32 s3, s52, 0
s_mul_i32 s3, s3, 57344
s_lshl_b32 s4, s2, 8
s_add_u32 s3, s3, s4
s_add_u32 s3, s3, 4194304
v_subrev_u32 v20, s48, v1
v_and_b32 v20, 0xf0, v20
v_add_u32 v20, s3, v20
global_load_dwordx4 v[2:5], v20, s[28:29] sc1
s_waitcnt vmcnt(0)
.L94:
s_nop 4
v_max3_u32 v17, v2, v3, v4
v_max_u32 v17, v17, v5
v_cmp_eq_u32 vcc, -1, v17
s_nop 0
s_cmp_eq_u64 vcc, 0
s_cbranch_scc1 .L93
s_sleep 2
s_add_u32 s47, s47, 1
s_cmp_lt_u32 s47, 262144
s_cbranch_scc1 .L92
s_endpgm
.L93:
s_nop 4
v_mov_b32 v6, 0xff800000
v_mov_b32 v7, 0
v_mov_b32 v8, 0
v_mov_b32 v9, 0
v_mov_b32 v10, 0
v_mov_b32 v11, 0
v_dot2_f32_bf16 v16, v144, v2, 0
v_dot2_f32_bf16 v17, v148, v2, 0
v_dot2_f32_bf16 v18, v152, v2, 0
v_dot2_f32_bf16 v19, v156, v2, 0
v_dot2_f32_bf16 v16, v145, v3, v16
v_dot2_f32_bf16 v17, v149, v3, v17
v_dot2_f32_bf16 v18, v153, v3, v18
v_dot2_f32_bf16 v19, v157, v3, v19
v_dot2_f32_bf16 v16, v146, v4, v16
v_dot2_f32_bf16 v17, v150, v4, v17
v_dot2_f32_bf16 v18, v154, v4, v18
v_dot2_f32_bf16 v19, v158, v4, v19
v_dot2_f32_bf16 v16, v147, v5, v16
v_dot2_f32_bf16 v17, v151, v5, v17
v_dot2_f32_bf16 v18, v155, v5, v18
v_dot2_f32_bf16 v19, v159, v5, v19
v_add_f32_dpp v16, v16, v16 row_ror:8 row_mask:0xf bank_mask:0xf
v_add_f32_dpp v17, v17, v17 row_ror:8 row_mask:0xf bank_mask:0xf
v_add_f32_dpp v18, v18, v18 row_ror:8 row_mask:0xf bank_mask:0xf
v_add_f32_dpp v19, v19, v19 row_ror:8 row_mask:0xf bank_mask:0xf
v_add_f32_dpp v16, v16, v16 row_ror:4 row_mask:0xf bank_mask:0xf
v_add_f32_dpp v17, v17, v17 row_ror:4 row_mask:0xf bank_mask:0xf
v_add_f32_dpp v18, v18, v18 row_ror:4 row_mask:0xf bank_mask:0xf
v_add_f32_dpp v19, v19, v19 row_ror:4 row_mask:0xf bank_mask:0xf
v_add_f32_dpp v16, v16, v16 row_ror:2 row_mask:0xf bank_mask:0xf
v_add_f32_dpp v17, v17, v17 row_ror:2 row_mask:0xf bank_mask:0xf
v_add_f32_dpp v18, v18, v18 row_ror:2 row_mask:0xf bank_mask:0xf
v_add_f32_dpp v19, v19, v19 row_ror:2 row_mask:0xf bank_mask:0xf
v_add_f32_dpp v16, v16, v16 row_ror:1 row_mask:0xf bank_mask:0xf
v_add_f32_dpp v17, v17, v17 row_ror:1 row_mask:0xf bank_mask:0xf
v_add_f32_dpp v18, v18, v18 row_ror:1 row_mask:0xf bank_mask:0xf
v_add_f32_dpp v19, v19, v19 row_ror:1 row_mask:0xf bank_mask:0xf
v_max3_f32 v20, v16, v17, v18
v_max3_f32 v20, v20, v19, v6
v_mov_b32 v21, v20
s_nop 1
v_permlane16_swap_b32 v20, v21
v_max_f32 v20, v20, v21
v_mov_b32 v21, v20
s_nop 1
v_permlane32_swap_b32 v20, v21
v_max_f32 v20, v20, v21
v_sub_f32 v21, v6, v20
v_mul_f32 v21, s44, v21
v_exp_f32 v21, v21
v_mul_f32 v22, s44, v20
v_mov_b32 v6, v20
v_fma_f32 v16, v16, s44, -v22
v_fma_f32 v17, v17, s44, -v22
v_fma_f32 v18, v18, s44, -v22
v_fma_f32 v19, v19, s44, -v22
v_exp_f32 v16, v16
v_exp_f32 v17, v17
v_exp_f32 v18, v18
v_exp_f32 v19, v19
v_mul_f32 v7, v7, v21
v_mul_f32 v8, v8, v21
v_mul_f32 v9, v9, v21
v_mul_f32 v10, v10, v21
v_mul_f32 v11, v11, v21
v_add_f32 v7, v7, v16
v_add_f32 v7, v7, v17
v_add_f32 v7, v7, v18
v_add_f32 v7, v7, v19
v_cvt_pk_bf16_f32 v16, v16, v16
v_cvt_pk_bf16_f32 v17, v17, v17
v_cvt_pk_bf16_f32 v18, v18, v18
v_cvt_pk_bf16_f32 v19, v19, v19
v_and_b32 v20, v12, v16
v_and_b32 v21, v13, v16
v_and_b32 v22, v14, v16
v_and_b32 v23, v15, v16
s_nop 1
v_mfma_f32_16x16x32_bf16 v[8:11], v[20:23], v[200:203], v[8:11]
v_and_b32 v20, v12, v17
v_and_b32 v21, v13, v17
v_and_b32 v22, v14, v17
v_and_b32 v23, v15, v17
s_nop 1
v_mfma_f32_16x16x32_bf16 v[8:11], v[20:23], v[204:207], v[8:11]
v_and_b32 v20, v12, v18
v_and_b32 v21, v13, v18
v_and_b32 v22, v14, v18
v_and_b32 v23, v15, v18
s_nop 1
v_mfma_f32_16x16x32_bf16 v[8:11], v[20:23], v[208:211], v[8:11]
v_and_b32 v20, v12, v19
v_and_b32 v21, v13, v19
v_and_b32 v22, v14, v19
v_and_b32 v23, v15, v19
s_nop 1
v_mfma_f32_16x16x32_bf16 v[8:11], v[20:23], v[212:215], v[8:11]
s_nop 7
s_waitcnt vmcnt(4)
s_mov_b32 s46, 8192
buffer_load_dwordx4 v[176:179], v0, s[36:39], s46 offen nt
s_waitcnt vmcnt(4)
s_mov_b32 s46, 9216
buffer_load_dwordx4 v[180:183], v0, s[36:39], s46 offen nt
s_waitcnt vmcnt(4)
s_mov_b32 s46, 10240
buffer_load_dwordx4 v[184:187], v0, s[36:39], s46 offen nt
s_waitcnt vmcnt(4)
s_mov_b32 s46, 8192
buffer_load_dwordx4 v[232:235], v0, s[40:43], s46 offen nt
s_waitcnt vmcnt(4)
s_mov_b32 s46, 9216
buffer_load_dwordx4 v[236:239], v0, s[40:43], s46 offen nt
s_waitcnt vmcnt(4)
s_mov_b32 s46, 10240
buffer_load_dwordx4 v[240:243], v0, s[40:43], s46 offen nt
v_dot2_f32_bf16 v16, v160, v2, 0
v_dot2_f32_bf16 v17, v164, v2, 0
v_dot2_f32_bf16 v18, v168, v2, 0
v_dot2_f32_bf16 v19, v172, v2, 0
v_dot2_f32_bf16 v16, v161, v3, v16
v_dot2_f32_bf16 v17, v165, v3, v17
v_dot2_f32_bf16 v18, v169, v3, v18
v_dot2_f32_bf16 v19, v173, v3, v19
v_dot2_f32_bf16 v16, v162, v4, v16
v_dot2_f32_bf16 v17, v166, v4, v17
v_dot2_f32_bf16 v18, v170, v4, v18
v_dot2_f32_bf16 v19, v174, v4, v19
v_dot2_f32_bf16 v16, v163, v5, v16
v_dot2_f32_bf16 v17, v167, v5, v17
v_dot2_f32_bf16 v18, v171, v5, v18
v_dot2_f32_bf16 v19, v175, v5, v19
v_add_f32_dpp v16, v16, v16 row_ror:8 row_mask:0xf bank_mask:0xf
v_add_f32_dpp v17, v17, v17 row_ror:8 row_mask:0xf bank_mask:0xf
v_add_f32_dpp v18, v18, v18 row_ror:8 row_mask:0xf bank_mask:0xf
v_add_f32_dpp v19, v19, v19 row_ror:8 row_mask:0xf bank_mask:0xf
v_add_f32_dpp v16, v16, v16 row_ror:4 row_mask:0xf bank_mask:0xf
v_add_f32_dpp v17, v17, v17 row_ror:4 row_mask:0xf bank_mask:0xf
v_add_f32_dpp v18, v18, v18 row_ror:4 row_mask:0xf bank_mask:0xf
v_add_f32_dpp v19, v19, v19 row_ror:4 row_mask:0xf bank_mask:0xf
v_add_f32_dpp v16, v16, v16 row_ror:2 row_mask:0xf bank_mask:0xf
v_add_f32_dpp v17, v17, v17 row_ror:2 row_mask:0xf bank_mask:0xf
v_add_f32_dpp v18, v18, v18 row_ror:2 row_mask:0xf bank_mask:0xf
v_add_f32_dpp v19, v19, v19 row_ror:2 row_mask:0xf bank_mask:0xf
v_add_f32_dpp v16, v16, v16 row_ror:1 row_mask:0xf bank_mask:0xf
v_add_f32_dpp v17, v17, v17 row_ror:1 row_mask:0xf bank_mask:0xf
v_add_f32_dpp v18, v18, v18 row_ror:1 row_mask:0xf bank_mask:0xf
v_add_f32_dpp v19, v19, v19 row_ror:1 row_mask:0xf bank_mask:0xf
v_max3_f32 v20, v16, v17, v18
v_max3_f32 v20, v20, v19, v6
v_mov_b32 v21, v20
s_nop 1
v_permlane16_swap_b32 v20, v21
v_max_f32 v20, v20, v21
v_mov_b32 v21, v20
s_nop 1
v_permlane32_swap_b32 v20, v21
v_max_f32 v20, v20, v21
v_sub_f32 v21, v6, v20
v_mul_f32 v21, s44, v21
v_exp_f32 v21, v21
v_mul_f32 v22, s44, v20
v_mov_b32 v6, v20
v_fma_f32 v16, v16, s44, -v22
v_fma_f32 v17, v17, s44, -v22
v_fma_f32 v18, v18, s44, -v22
v_fma_f32 v19, v19, s44, -v22
v_exp_f32 v16, v16
v_exp_f32 v17, v17
v_exp_f32 v18, v18
v_exp_f32 v19, v19
v_mul_f32 v7, v7, v21
v_mul_f32 v8, v8, v21
v_mul_f32 v9, v9, v21
v_mul_f32 v10, v10, v21
v_mul_f32 v11, v11, v21
v_add_f32 v7, v7, v16
v_add_f32 v7, v7, v17
v_add_f32 v7, v7, v18
v_add_f32 v7, v7, v19
v_cvt_pk_bf16_f32 v16, v16, v16
v_cvt_pk_bf16_f32 v17, v17, v17
v_cvt_pk_bf16_f32 v18, v18, v18
v_cvt_pk_bf16_f32 v19, v19, v19
v_and_b32 v20, v12, v16
v_and_b32 v21, v13, v16
v_and_b32 v22, v14, v16
v_and_b32 v23, v15, v16
s_nop 1
v_mfma_f32_16x16x32_bf16 v[8:11], v[20:23], v[216:219], v[8:11]
v_and_b32 v20, v12, v17
v_and_b32 v21, v13, v17
v_and_b32 v22, v14, v17
v_and_b32 v23, v15, v17
s_nop 1
v_mfma_f32_16x16x32_bf16 v[8:11], v[20:23], v[220:223], v[8:11]
v_and_b32 v20, v12, v18
v_and_b32 v21, v13, v18
v_and_b32 v22, v14, v18
v_and_b32 v23, v15, v18
s_nop 1
v_mfma_f32_16x16x32_bf16 v[8:11], v[20:23], v[224:227], v[8:11]
v_and_b32 v20, v12, v19
v_and_b32 v21, v13, v19
v_and_b32 v22, v14, v19
v_and_b32 v23, v15, v19
s_nop 1
v_mfma_f32_16x16x32_bf16 v[8:11], v[20:23], v[228:231], v[8:11]
s_nop 7
s_waitcnt vmcnt(4)
s_mov_b32 s46, 11264
buffer_load_dwordx4 v[188:191], v0, s[36:39], s46 offen nt
s_waitcnt vmcnt(4)
s_mov_b32 s46, 12288
buffer_load_dwordx4 v[192:195], v0, s[36:39], s46 offen nt
s_waitcnt vmcnt(4)
s_mov_b32 s46, 13312
buffer_load_dwordx4 v[196:199], v0, s[36:39], s46 offen nt
s_waitcnt vmcnt(4)
s_mov_b32 s46, 11264
buffer_load_dwordx4 v[244:247], v0, s[40:43], s46 offen nt
s_waitcnt vmcnt(4)
s_mov_b32 s46, 12288
buffer_load_dwordx4 v[248:251], v0, s[40:43], s46 offen nt
s_waitcnt vmcnt(4)
s_mov_b32 s46, 13312
buffer_load_dwordx4 v[252:255], v0, s[40:43], s46 offen nt
v_dot2_f32_bf16 v16, v176, v2, 0
v_dot2_f32_bf16 v17, v180, v2, 0
v_dot2_f32_bf16 v18, v184, v2, 0
v_dot2_f32_bf16 v16, v177, v3, v16
v_dot2_f32_bf16 v17, v181, v3, v17
v_dot2_f32_bf16 v18, v185, v3, v18
v_dot2_f32_bf16 v16, v178, v4, v16
v_dot2_f32_bf16 v17, v182, v4, v17
v_dot2_f32_bf16 v18, v186, v4, v18
v_dot2_f32_bf16 v16, v179, v5, v16
v_dot2_f32_bf16 v17, v183, v5, v17
v_dot2_f32_bf16 v18, v187, v5, v18
s_nop 0
v_add_f32_dpp v16, v16, v16 row_ror:8 row_mask:0xf bank_mask:0xf
v_add_f32_dpp v17, v17, v17 row_ror:8 row_mask:0xf bank_mask:0xf
v_add_f32_dpp v18, v18, v18 row_ror:8 row_mask:0xf bank_mask:0xf
v_add_f32_dpp v16, v16, v16 row_ror:4 row_mask:0xf bank_mask:0xf
v_add_f32_dpp v17, v17, v17 row_ror:4 row_mask:0xf bank_mask:0xf
v_add_f32_dpp v18, v18, v18 row_ror:4 row_mask:0xf bank_mask:0xf
v_add_f32_dpp v16, v16, v16 row_ror:2 row_mask:0xf bank_mask:0xf
v_add_f32_dpp v17, v17, v17 row_ror:2 row_mask:0xf bank_mask:0xf
v_add_f32_dpp v18, v18, v18 row_ror:2 row_mask:0xf bank_mask:0xf
v_add_f32_dpp v16, v16, v16 row_ror:1 row_mask:0xf bank_mask:0xf
v_add_f32_dpp v17, v17, v17 row_ror:1 row_mask:0xf bank_mask:0xf
v_add_f32_dpp v18, v18, v18 row_ror:1 row_mask:0xf bank_mask:0xf
v_add_f32 v17, s45, v17
v_add_f32 v18, s45, v18
v_max3_f32 v20, v16, v17, v18
v_max_f32 v20, v20, v6
v_mov_b32 v21, v20
s_nop 1
v_permlane16_swap_b32 v20, v21
v_max_f32 v20, v20, v21
v_mov_b32 v21, v20
s_nop 1
v_permlane32_swap_b32 v20, v21
v_max_f32 v20, v20, v21
v_sub_f32 v21, v6, v20
v_mul_f32 v21, s44, v21
v_exp_f32 v21, v21
v_mul_f32 v22, s44, v20
v_mov_b32 v6, v20
v_fma_f32 v16, v16, s44, -v22
v_fma_f32 v17, v17, s44, -v22
v_fma_f32 v18, v18, s44, -v22
v_exp_f32 v16, v16
v_exp_f32 v17, v17
v_exp_f32 v18, v18
v_mul_f32 v7, v7, v21
v_mul_f32 v8, v8, v21
v_mul_f32 v9, v9, v21
v_mul_f32 v10, v10, v21
v_mul_f32 v11, v11, v21
v_add_f32 v7, v7, v16
v_add_f32 v7, v7, v17
v_add_f32 v7, v7, v18
v_cvt_pk_bf16_f32 v16, v16, v16
v_cvt_pk_bf16_f32 v17, v17, v17
v_cvt_pk_bf16_f32 v18, v18, v18
v_and_b32 v20, v12, v16
v_and_b32 v21, v13, v16
v_and_b32 v22, v14, v16
v_and_b32 v23, v15, v16
s_nop 1
v_mfma_f32_16x16x32_bf16 v[8:11], v[20:23], v[232:235], v[8:11]
v_and_b32 v20, v12, v17
v_and_b32 v21, v13, v17
v_and_b32 v22, v14, v17
v_and_b32 v23, v15, v17
s_nop 1
v_mfma_f32_16x16x32_bf16 v[8:11], v[20:23], v[236:239], v[8:11]
v_and_b32 v20, v12, v18
v_and_b32 v21, v13, v18
v_and_b32 v22, v14, v18
v_and_b32 v23, v15, v18
s_nop 1
v_mfma_f32_16x16x32_bf16 v[8:11], v[20:23], v[240:243], v[8:11]
s_waitcnt vmcnt(3)
v_dot2_f32_bf16 v16, v188, v2, 0
v_dot2_f32_bf16 v17, v192, v2, 0
v_dot2_f32_bf16 v18, v196, v2, 0
v_dot2_f32_bf16 v16, v189, v3, v16
v_dot2_f32_bf16 v17, v193, v3, v17
v_dot2_f32_bf16 v18, v197, v3, v18
v_dot2_f32_bf16 v16, v190, v4, v16
v_dot2_f32_bf16 v17, v194, v4, v17
v_dot2_f32_bf16 v18, v198, v4, v18
v_dot2_f32_bf16 v16, v191, v5, v16
v_dot2_f32_bf16 v17, v195, v5, v17
v_dot2_f32_bf16 v18, v199, v5, v18
s_add_u32 s3, s53, 8
s_mul_i32 s3, s3, 57344
s_lshl_b32 s4, s2, 8
s_add_u32 s3, s3, s4
s_add_u32 s3, s3, 4194304
v_subrev_u32 v20, s48, v1
v_and_b32 v20, 0xf0, v20
v_add_u32 v20, s3, v20
global_load_dwordx4 v[2:5], v20, s[28:29] sc1
s_waitcnt vmcnt(1)
v_add_f32_dpp v16, v16, v16 row_ror:8 row_mask:0xf bank_mask:0xf
v_add_f32_dpp v17, v17, v17 row_ror:8 row_mask:0xf bank_mask:0xf
v_add_f32_dpp v18, v18, v18 row_ror:8 row_mask:0xf bank_mask:0xf
v_add_f32_dpp v16, v16, v16 row_ror:4 row_mask:0xf bank_mask:0xf
v_add_f32_dpp v17, v17, v17 row_ror:4 row_mask:0xf bank_mask:0xf
v_add_f32_dpp v18, v18, v18 row_ror:4 row_mask:0xf bank_mask:0xf
v_add_f32_dpp v16, v16, v16 row_ror:2 row_mask:0xf bank_mask:0xf
v_add_f32_dpp v17, v17, v17 row_ror:2 row_mask:0xf bank_mask:0xf
v_add_f32_dpp v18, v18, v18 row_ror:2 row_mask:0xf bank_mask:0xf
v_add_f32_dpp v16, v16, v16 row_ror:1 row_mask:0xf bank_mask:0xf
v_add_f32_dpp v17, v17, v17 row_ror:1 row_mask:0xf bank_mask:0xf
v_add_f32_dpp v18, v18, v18 row_ror:1 row_mask:0xf bank_mask:0xf
v_add_f32 v16, s45, v16
v_add_f32 v17, s45, v17
v_add_f32 v18, s45, v18
v_max3_f32 v20, v16, v17, v18
v_max_f32 v20, v20, v6
v_mov_b32 v21, v20
s_nop 1
v_permlane16_swap_b32 v20, v21
v_max_f32 v20, v20, v21
v_mov_b32 v21, v20
s_nop 1
v_permlane32_swap_b32 v20, v21
v_max_f32 v20, v20, v21
v_sub_f32 v21, v6, v20
v_mul_f32 v21, s44, v21
v_exp_f32 v21, v21
v_mul_f32 v22, s44, v20
v_mov_b32 v6, v20
v_fma_f32 v16, v16, s44, -v22
v_fma_f32 v17, v17, s44, -v22
v_fma_f32 v18, v18, s44, -v22
v_exp_f32 v16, v16
v_exp_f32 v17, v17
v_exp_f32 v18, v18
v_mul_f32 v7, v7, v21
v_mul_f32 v8, v8, v21
v_mul_f32 v9, v9, v21
v_mul_f32 v10, v10, v21
v_mul_f32 v11, v11, v21
v_add_f32 v7, v7, v16
v_add_f32 v7, v7, v17
v_add_f32 v7, v7, v18
v_cvt_pk_bf16_f32 v16, v16, v16
v_cvt_pk_bf16_f32 v17, v17, v17
v_cvt_pk_bf16_f32 v18, v18, v18
v_and_b32 v20, v12, v16
v_and_b32 v21, v13, v16
v_and_b32 v22, v14, v16
v_and_b32 v23, v15, v16
s_nop 1
v_mfma_f32_16x16x32_bf16 v[8:11], v[20:23], v[244:247], v[8:11]
v_and_b32 v20, v12, v17
v_and_b32 v21, v13, v17
v_and_b32 v22, v14, v17
v_and_b32 v23, v15, v17
s_nop 1
v_mfma_f32_16x16x32_bf16 v[8:11], v[20:23], v[248:251], v[8:11]
v_and_b32 v20, v12, v18
v_and_b32 v21, v13, v18
v_and_b32 v22, v14, v18
v_and_b32 v23, v15, v18
s_nop 1
v_mfma_f32_16x16x32_bf16 v[8:11], v[20:23], v[252:255], v[8:11]
v_mul_f32 v6, s44, v6
v_mov_b32 v16, v7
s_nop 1
v_permlane16_swap_b32 v7, v16
v_add_f32 v7, v7, v16
v_mov_b32 v16, v7
s_nop 1
v_permlane32_swap_b32 v7, v16
v_add_f32 v7, v7, v16
v_subrev_u32 v16, s48, v1
v_and_b32 v17, 0xf0, v16
v_lshlrev_b32 v17, 1, v17
v_lshrrev_b32 v18, 8, v16
v_lshl_add_u32 v17, v18, 4, v17
s_mul_i32 s3, s30, 528
s_add_u32 s3, s3, 147584
v_add_u32 v17, s3, v17
s_mov_b32 exec_hi, 0
ds_write_b128 v17, v[8:11]
s_mov_b64 exec, 1
ds_write_b64 v17, v[6:7] offset:512
s_waitcnt lgkmcnt(0)
v_mov_b32 v18, 160260
v_mov_b32 v19, 1
ds_add_rtn_u32 v20, v18, v19
s_waitcnt lgkmcnt(0)
s_mov_b64 exec, -1
v_readfirstlane_b32 s3, v20
s_nop 0
s_and_b32 s3, s3, 7
s_cmp_lg_u32 s3, 7
s_cbranch_scc1 .L97
v_mov_b32 v10, 148096
ds_read_b64 v[16:17], v10 offset:0
ds_read_b64 v[18:19], v10 offset:528
ds_read_b64 v[20:21], v10 offset:1056
ds_read_b64 v[22:23], v10 offset:1584
ds_read_b64 v[24:25], v10 offset:2112
ds_read_b64 v[26:27], v10 offset:2640
ds_read_b64 v[28:29], v10 offset:3168
ds_read_b64 v[30:31], v10 offset:3696
v_subrev_u32 v11, s48, v1
v_lshrrev_b32 v11, 1, v11
v_add_u32 v10, 147584, v11
s_waitcnt lgkmcnt(0)
v_max3_f32 v6, v16, v18, v20
v_max3_f32 v6, v6, v22, v24
v_max3_f32 v6, v6, v26, v28
v_max_f32 v6, v6, v30
v_mov_b32 v7, 0
v_mov_b32 v8, 0
v_mov_b32 v9, 0
v_sub_f32 v16, v16, v6
v_exp_f32 v16, v16
v_sub_f32 v18, v18, v6
v_exp_f32 v18, v18
v_sub_f32 v20, v20, v6
v_exp_f32 v20, v20
v_sub_f32 v22, v22, v6
v_exp_f32 v22, v22
v_sub_f32 v24, v24, v6
v_exp_f32 v24, v24
v_sub_f32 v26, v26, v6
v_exp_f32 v26, v26
v_sub_f32 v28, v28, v6
v_exp_f32 v28, v28
v_sub_f32 v30, v30, v6
v_exp_f32 v30, v30
v_fmac_f32 v7, v16, v17
v_fmac_f32 v7, v18, v19
v_fmac_f32 v7, v20, v21
v_fmac_f32 v7, v22, v23
v_fmac_f32 v7, v24, v25
v_fmac_f32 v7, v26, v27
v_fmac_f32 v7, v28, v29
v_fmac_f32 v7, v30, v31
v_mov_b32 v17, v18
v_mov_b32 v18, v20
v_mov_b32 v19, v22
v_mov_b32 v20, v24
v_mov_b32 v21, v26
v_mov_b32 v22, v28
v_mov_b32 v23, v30
ds_read_b64 v[24:25], v10 offset:0
ds_read_b64 v[26:27], v10 offset:528
ds_read_b64 v[28:29], v10 offset:1056
ds_read_b64 v[30:31], v10 offset:1584
s_waitcnt lgkmcnt(0)
v_fmac_f32 v8, v16, v24
v_fmac_f32 v9, v16, v25
v_fmac_f32 v8, v17, v26
v_fmac_f32 v9, v17, v27
v_fmac_f32 v8, v18, v28
v_fmac_f32 v9, v18, v29
v_fmac_f32 v8, v19, v30
v_fmac_f32 v9, v19, v31
ds_read_b64 v[24:25], v10 offset:2112
ds_read_b64 v[26:27], v10 offset:2640
ds_read_b64 v[28:29], v10 offset:3168
ds_read_b64 v[30:31], v10 offset:3696
s_waitcnt lgkmcnt(0)
v_fmac_f32 v8, v20, v24
v_fmac_f32 v9, v20, v25
v_fmac_f32 v8, v21, v26
v_fmac_f32 v9, v21, v27
v_fmac_f32 v8, v22, v28
v_fmac_f32 v9, v22, v29
v_fmac_f32 v8, v23, v30
v_fmac_f32 v9, v23, v31
v_min_u32 v6, 0xfffffffe, v6
v_min_u32 v7, 0xfffffffe, v7
v_min_u32 v8, 0xfffffffe, v8
v_min_u32 v9, 0xfffffffe, v9
s_add_u32 s3, s52, 0
s_mul_i32 s3, s3, 224
s_add_u32 s3, s3, s2
s_mul_i32 s3, s3, 528
v_add_u32 v11, s3, v11
global_store_dwordx2 v11, v[8:9], s[28:29] offset:0 sc1
s_mov_b64 exec, 1
global_store_dwordx2 v11, v[6:7], s[28:29] offset:512 sc1
s_mov_b64 exec, -1
.L97:
s_nop 4
s_add_u32 s36, s36, 0x2000000
s_addc_u32 s37, s37, 0
s_add_u32 s40, s40, 0x2000000
s_addc_u32 s41, s41, 0
.L91:
s_nop 4
s_add_u32 s51, s51, 1
s_cmp_lt_u32 s51, 8
s_cbranch_scc1 L_loop_b
s_endpgm
L_chain:
s_nop 4
v_and_b32 v1, 63, v0
s_sub_u32 s31, s2, 224
v_mov_b32 v20, -1
v_mov_b32 v21, -1
v_mov_b32 v22, -1
v_mov_b32 v23, -1
v_lshrrev_b32 v2, 5, v0
v_and_b32 v3, 31, v0
v_lshlrev_b32 v4, 16, v2
s_lshl_b32 s3, s31, 11
v_add_u32 v4, s3, v4
v_lshl_add_u32 v4, v3, 4, v4
v_add_u32 v8, 1900544, v4
global_store_dwordx4 v8, v[20:23], s[28:29] offset:0 sc1
global_store_dwordx4 v8, v[20:23], s[28:29] offset:512 sc1
global_store_dwordx4 v8, v[20:23], s[28:29] offset:1024 sc1
global_store_dwordx4 v8, v[20:23], s[28:29] offset:1536 sc1
s_nop 1
v_add_u32 v8, 2949120, v4
global_store_dwordx4 v8, v[20:23], s[28:29] offset:0 sc1
global_store_dwordx4 v8, v[20:23], s[28:29] offset:512 sc1
global_store_dwordx4 v8, v[20:23], s[28:29] offset:1024 sc1
global_store_dwordx4 v8, v[20:23], s[28:29] offset:1536 sc1
v_lshlrev_b32 v4, 1, v0
v_add_u32 v4, 4096, v4
global_load_ushort v8, v4, s[8:9] offset:-4096
global_load_ushort v9, v4, s[8:9] offset:-3072
global_load_ushort v10, v4, s[8:9] offset:-2048
global_load_ushort v11, v4, s[8:9] offset:-1024
global_load_ushort v12, v4, s[8:9] offset:0
global_load_ushort v13, v4, s[8:9] offset:1024
global_load_ushort v14, v4, s[8:9] offset:2048
global_load_ushort v15, v4, s[8:9] offset:3072
s_mov_b32 s64, s14
s_and_b32 s65, s15, 0xffff
s_mov_b32 s66, 4194304
s_mov_b32 s67, 0x00020000
v_lshrrev_b32 v2, 4, v1
v_and_b32 v3, 15, v1
s_lshl_b32 s3, s30, 6
v_add_u32 v2, s3, v2
v_lshlrev_b32 v2, 13, v2
v_lshl_add_u32 v2, v3, 4, v2
s_lshl_b32 s3, s31, 8
v_add_u32 v2, s3, v2
s_mul_i32 s4, s30, 16384
s_add_u32 s4, s4, 24576
s_add_u32 s5, s4, 0
s_mov_b32 m0, s5
s_mov_b32 s6, 0
buffer_load_dwordx4 v2, s[64:67], s6 offen nt lds
s_add_u32 s5, s4, 1024
s_mov_b32 m0, s5
s_mov_b32 s6, 32768
buffer_load_dwordx4 v2, s[64:67], s6 offen nt lds
s_add_u32 s5, s4, 2048
s_mov_b32 m0, s5
s_mov_b32 s6, 65536
buffer_load_dwordx4 v2, s[64:67], s6 offen nt lds
s_add_u32 s5, s4, 3072
s_mov_b32 m0, s5
s_mov_b32 s6, 98304
buffer_load_dwordx4 v2, s[64:67], s6 offen nt lds
s_add_u32 s5, s4, 4096
s_mov_b32 m0, s5
s_mov_b32 s6, 131072
buffer_load_dwordx4 v2, s[64:67], s6 offen nt lds
s_add_u32 s5, s4, 5120
s_mov_b32 m0, s5
s_mov_b32 s6, 163840
buffer_load_dwordx4 v2, s[64:67], s6 offen nt lds
s_add_u32 s5, s4, 6144
s_mov_b32 m0, s5
s_mov_b32 s6, 196608
buffer_load_dwordx4 v2, s[64:67], s6 offen nt lds
s_add_u32 s5, s4, 7168
s_mov_b32 m0, s5
s_mov_b32 s6, 229376
buffer_load_dwordx4 v2, s[64:67], s6 offen nt lds
s_add_u32 s5, s4, 8192
s_mov_b32 m0, s5
s_mov_b32 s6, 262144
buffer_load_dwordx4 v2, s[64:67], s6 offen nt lds
s_add_u32 s5, s4, 9216
s_mov_b32 m0, s5
s_mov_b32 s6, 294912
buffer_load_dwordx4 v2, s[64:67], s6 offen nt lds
s_add_u32 s5, s4, 10240
s_mov_b32 m0, s5
s_mov_b32 s6, 327680
buffer_load_dwordx4 v2, s[64:67], s6 offen nt lds
s_add_u32 s5, s4, 11264
s_mov_b32 m0, s5
s_mov_b32 s6, 360448
buffer_load_dwordx4 v2, s[64:67], s6 offen nt lds
s_add_u32 s5, s4, 12288
s_mov_b32 m0, s5
s_mov_b32 s6, 393216
buffer_load_dwordx4 v2, s[64:67], s6 offen nt lds
s_add_u32 s5, s4, 13312
s_mov_b32 m0, s5
s_mov_b32 s6, 425984
buffer_load_dwordx4 v2, s[64:67], s6 offen nt lds
s_add_u32 s5, s4, 14336
s_mov_b32 m0, s5
s_mov_b32 s6, 458752
buffer_load_dwordx4 v2, s[64:67], s6 offen nt lds
s_add_u32 s5, s4, 15360
s_mov_b32 m0, s5
s_mov_b32 s6, 491520
buffer_load_dwordx4 v2, s[64:67], s6 offen nt lds
v_and_b32 v3, 15, v1
v_lshrrev_b32 v4, 4, v1
v_lshlrev_b32 v4, 4, v4
v_mov_b32 v5, 18688
v_cmp_eq_u32 vcc, 0, v3
v_mov_b32 v16, 16640
s_nop 0
v_cndmask_b32 v5, v5, v16, vcc
v_cmp_eq_u32 vcc, 1, v3
v_mov_b32 v16, 17664
s_nop 0
v_cndmask_b32 v5, v5, v16, vcc
v_add_u32 v5, v5, v4
v_mov_b32 v6, 18688
v_cmp_eq_u32 vcc, 0, v3
v_mov_b32 v16, 19712
s_nop 0
v_cndmask_b32 v6, v6, v16, vcc
v_cmp_eq_u32 vcc, 1, v3
v_mov_b32 v16, 19968
s_nop 0
v_cndmask_b32 v6, v6, v16, vcc
v_add_u32 v6, v6, v4
v_mov_b32 v7, 18688
v_cmp_eq_u32 vcc, 0, v3
v_mov_b32 v16, 23296
s_nop 0
v_cndmask_b32 v7, v7, v16, vcc
v_cmp_eq_u32 vcc, 1, v3
v_mov_b32 v16, 23424
s_nop 0
v_cndmask_b32 v7, v7, v16, vcc
v_add_u32 v7, v7, v4
v_mov_b32 v16, 0
v_lshlrev_b32 v17, 1, v0
ds_write_b16 v17, v16 offset:18688
s_mul_i32 s4, s31, 6
s_mul_i32 s5, s31, 5
s_add_u32 s5, s5, 12
s_cmp_lt_u32 s31, 12
s_cselect_b32 s34, s4, s5
s_cselect_b32 s35, 6, 5
v_lshrrev_b32 v18, 4, v1
v_bfe_u32 v19, v1, 2, 2
v_lshl_add_u32 v18, v18, 3, v19
v_and_b32 v19, 3, v1
v_lshlrev_b32 v19, 3, v19
s_waitcnt vmcnt(0)
v_lshlrev_b32 v4, 2, v0
v_lshlrev_b32 v8, 16, v8
ds_write_b32 v4, v8 offset:0
v_lshlrev_b32 v9, 16, v9
ds_write_b32 v4, v9 offset:2048
v_lshlrev_b32 v10, 16, v10
ds_write_b32 v4, v10 offset:4096
v_lshlrev_b32 v11, 16, v11
ds_write_b32 v4, v11 offset:6144
v_lshlrev_b32 v12, 16, v12
ds_write_b32 v4, v12 offset:8192
v_lshlrev_b32 v13, 16, v13
ds_write_b32 v4, v13 offset:10240
v_lshlrev_b32 v14, 16, v14
ds_write_b32 v4, v14 offset:12288
v_lshlrev_b32 v15, 16, v15
ds_write_b32 v4, v15 offset:14336
s_waitcnt lgkmcnt(0)
s_barrier
s_cmp_lg_u32 s30, 0
s_cbranch_scc1 .L98
v_mov_b32 v20, s31
v_mov_b32 v21, 1
s_mov_b64 exec, 1
global_store_byte v20, v21, s[26:27] offset:224 sc1
s_mov_b64 exec, -1
.L98:
s_nop 4
s_lshl_b32 s3, s30, 5
v_mul_u32_u24 v20, 256, v18
v_add_u32 v20, v20, v19
v_add_u32 v20, s3, v20
v_add_u32 v20, 24576, v20
ds_read_b64_tr_b16 v[72:73], v20 offset:0
ds_read_b64_tr_b16 v[74:75], v20 offset:1024
ds_read_b64_tr_b16 v[76:77], v20 offset:8192
ds_read_b64_tr_b16 v[78:79], v20 offset:9216
ds_read_b64_tr_b16 v[80:81], v20 offset:16384
ds_read_b64_tr_b16 v[82:83], v20 offset:17408
ds_read_b64_tr_b16 v[84:85], v20 offset:24576
ds_read_b64_tr_b16 v[86:87], v20 offset:25600
ds_read_b64_tr_b16 v[88:89], v20 offset:32768
ds_read_b64_tr_b16 v[90:91], v20 offset:33792
ds_read_b64_tr_b16 v[92:93], v20 offset:40960
ds_read_b64_tr_b16 v[94:95], v20 offset:41984
ds_read_b64_tr_b16 v[96:97], v20 offset:49152
ds_read_b64_tr_b16 v[98:99], v20 offset:50176
ds_read_b64_tr_b16 v[100:101], v20 offset:57344
ds_read_b64_tr_b16 v[102:103], v20 offset:58368
v_add_u32 v20, 65536, v20
ds_read_b64_tr_b16 v[104:105], v20 offset:0
ds_read_b64_tr_b16 v[106:107], v20 offset:1024
ds_read_b64_tr_b16 v[108:109], v20 offset:8192
ds_read_b64_tr_b16 v[110:111], v20 offset:9216
ds_read_b64_tr_b16 v[112:113], v20 offset:16384
ds_read_b64_tr_b16 v[114:115], v20 offset:17408
ds_read_b64_tr_b16 v[116:117], v20 offset:24576
ds_read_b64_tr_b16 v[118:119], v20 offset:25600
ds_read_b64_tr_b16 v[120:121], v20 offset:32768
ds_read_b64_tr_b16 v[122:123], v20 offset:33792
ds_read_b64_tr_b16 v[124:125], v20 offset:40960
ds_read_b64_tr_b16 v[126:127], v20 offset:41984
ds_read_b64_tr_b16 v[128:129], v20 offset:49152
ds_read_b64_tr_b16 v[130:131], v20 offset:50176
ds_read_b64_tr_b16 v[132:133], v20 offset:57344
ds_read_b64_tr_b16 v[134:135], v20 offset:58368
s_waitcnt lgkmcnt(0)
s_barrier
s_mov_b32 s64, s16
s_and_b32 s65, s17, 0xffff
s_mov_b32 s66, 4194304
s_mov_b32 s67, 0x00020000
s_lshl_b32 s3, s31, 7
s_lshl_b32 s4, s30, 4
s_add_u32 s3, s3, s4
s_lshl_b32 s3, s3, 10
v_lshlrev_b32 v2, 4, v1
v_add_u32 v2, s3, v2
s_mul_i32 s4, s30, 16384
s_add_u32 s4, s4, 24576
s_add_u32 s5, s4, 0
s_mov_b32 m0, s5
s_mov_b32 s6, 0
buffer_load_dwordx4 v2, s[64:67], s6 offen nt lds
s_add_u32 s5, s4, 1024
s_mov_b32 m0, s5
s_mov_b32 s6, 1024
buffer_load_dwordx4 v2, s[64:67], s6 offen nt lds
s_add_u32 s5, s4, 2048
s_mov_b32 m0, s5
s_mov_b32 s6, 2048
buffer_load_dwordx4 v2, s[64:67], s6 offen nt lds
s_add_u32 s5, s4, 3072
s_mov_b32 m0, s5
s_mov_b32 s6, 3072
buffer_load_dwordx4 v2, s[64:67], s6 offen nt lds
s_add_u32 s5, s4, 4096
s_mov_b32 m0, s5
s_mov_b32 s6, 4096
buffer_load_dwordx4 v2, s[64:67], s6 offen nt lds
s_add_u32 s5, s4, 5120
s_mov_b32 m0, s5
s_mov_b32 s6, 5120
buffer_load_dwordx4 v2, s[64:67], s6 offen nt lds
s_add_u32 s5, s4, 6144
s_mov_b32 m0, s5
s_mov_b32 s6, 6144
buffer_load_dwordx4 v2, s[64:67], s6 offen nt lds
s_add_u32 s5, s4, 7168
s_mov_b32 m0, s5
s_mov_b32 s6, 7168
buffer_load_dwordx4 v2, s[64:67], s6 offen nt lds
s_add_u32 s5, s4, 8192
s_mov_b32 m0, s5
s_mov_b32 s6, 8192
buffer_load_dwordx4 v2, s[64:67], s6 offen nt lds
s_add_u32 s5, s4, 9216
s_mov_b32 m0, s5
s_mov_b32 s6, 9216
buffer_load_dwordx4 v2, s[64:67], s6 offen nt lds
s_add_u32 s5, s4, 10240
s_mov_b32 m0, s5
s_mov_b32 s6, 10240
buffer_load_dwordx4 v2, s[64:67], s6 offen nt lds
s_add_u32 s5, s4, 11264
s_mov_b32 m0, s5
s_mov_b32 s6, 11264
buffer_load_dwordx4 v2, s[64:67], s6 offen nt lds
s_add_u32 s5, s4, 12288
s_mov_b32 m0, s5
s_mov_b32 s6, 12288
buffer_load_dwordx4 v2, s[64:67], s6 offen nt lds
s_add_u32 s5, s4, 13312
s_mov_b32 m0, s5
s_mov_b32 s6, 13312
buffer_load_dwordx4 v2, s[64:67], s6 offen nt lds
s_add_u32 s5, s4, 14336
s_mov_b32 m0, s5
s_mov_b32 s6, 14336
buffer_load_dwordx4 v2, s[64:67], s6 offen nt lds
s_add_u32 s5, s4, 15360
s_mov_b32 m0, s5
s_mov_b32 s6, 15360
buffer_load_dwordx4 v2, s[64:67], s6 offen nt lds
s_cmp_lg_u32 s30, 0
s_cbranch_scc1 .L101
v_min_u32 v10, 6, v1
s_mul_i32 s3, s31, 7
v_add_u32 v10, s3, v10
.L99:
s_nop 4
global_load_ubyte v11, v10, s[26:27] sc1
s_waitcnt vmcnt(0)
v_cmp_ne_u32 vcc, 1, v11
s_nop 0
s_cmp_eq_u64 vcc, 0
s_cbranch_scc1 .L100
s_sleep 4
s_add_u32 s47, s47, 1
s_cmp_lt_u32 s47, 262144
s_cbranch_scc1 .L99
s_endpgm
.L100:
s_nop 4
.L101:
s_nop 4
ds_read_b32 v2, v4 offset:0
ds_read_b32 v3, v4 offset:2048
s_waitcnt lgkmcnt(0)
v_mov_b32 v12, v2
v_mul_f32 v13, v2, v2
v_mov_b32 v14, v3
v_mul_f32 v15, v3, v3
v_add_f32_dpp v12, v12, v12 row_ror:8 row_mask:0xf bank_mask:0xf
v_add_f32_dpp v13, v13, v13 row_ror:8 row_mask:0xf bank_mask:0xf
v_add_f32_dpp v14, v14, v14 row_ror:8 row_mask:0xf bank_mask:0xf
v_add_f32_dpp v15, v15, v15 row_ror:8 row_mask:0xf bank_mask:0xf
v_add_f32_dpp v12, v12, v12 row_ror:4 row_mask:0xf bank_mask:0xf
v_add_f32_dpp v13, v13, v13 row_ror:4 row_mask:0xf bank_mask:0xf
v_add_f32_dpp v14, v14, v14 row_ror:4 row_mask:0xf bank_mask:0xf
v_add_f32_dpp v15, v15, v15 row_ror:4 row_mask:0xf bank_mask:0xf
v_add_f32_dpp v12, v12, v12 row_ror:2 row_mask:0xf bank_mask:0xf
v_add_f32_dpp v13, v13, v13 row_ror:2 row_mask:0xf bank_mask:0xf
v_add_f32_dpp v14, v14, v14 row_ror:2 row_mask:0xf bank_mask:0xf
v_add_f32_dpp v15, v15, v15 row_ror:2 row_mask:0xf bank_mask:0xf
v_add_f32_dpp v12, v12, v12 row_ror:1 row_mask:0xf bank_mask:0xf
v_add_f32_dpp v13, v13, v13 row_ror:1 row_mask:0xf bank_mask:0xf
v_add_f32_dpp v14, v14, v14 row_ror:1 row_mask:0xf bank_mask:0xf
v_add_f32_dpp v15, v15, v15 row_ror:1 row_mask:0xf bank_mask:0xf
v_mov_b32 v16, v12
v_mov_b32 v17, v13
v_mov_b32 v18, v14
v_mov_b32 v19, v15
v_permlane16_swap_b32 v12, v16
v_permlane16_swap_b32 v13, v17
v_permlane16_swap_b32 v14, v18
v_permlane16_swap_b32 v15, v19
v_add_f32 v12, v12, v16
v_add_f32 v13, v13, v17
v_add_f32 v14, v14, v18
v_add_f32 v15, v15, v19
v_mov_b32 v16, v12
v_mov_b32 v17, v13
v_mov_b32 v18, v14
v_mov_b32 v19, v15
v_permlane32_swap_b32 v12, v16
v_permlane32_swap_b32 v13, v17
v_permlane32_swap_b32 v14, v18
v_permlane32_swap_b32 v15, v19
v_add_f32 v12, v12, v16
v_add_f32 v13, v13, v17
v_add_f32 v14, v14, v18
v_add_f32 v15, v15, v19
s_lshl_b32 s3, s30, 4
v_mov_b32 v16, s3
s_mov_b64 exec, 1
ds_write_b128 v16, v[12:15] offset:16384
s_mov_b64 exec, -1
s_waitcnt lgkmcnt(0)
s_barrier
v_mov_b32 v12, 0
ds_read_b128 v[8:11], v12 offset:16384
ds_read_b128 v[16:19], v12 offset:16416
ds_read_b128 v[20:23], v12 offset:16432
ds_read_b128 v[24:27], v12 offset:16448
ds_read_b128 v[28:31], v12 offset:16464
ds_read_b128 v[32:35], v12 offset:16480
ds_read_b128 v[36:39], v12 offset:16496
ds_read_b128 v[40:43], v12 offset:16400
s_waitcnt lgkmcnt(0)
v_add_f32 v8, v8, v40
v_add_f32 v16, v16, v20
v_add_f32 v24, v24, v28
v_add_f32 v32, v32, v36
v_add_f32 v9, v9, v41
v_add_f32 v17, v17, v21
v_add_f32 v25, v25, v29
v_add_f32 v33, v33, v37
v_add_f32 v10, v10, v42
v_add_f32 v18, v18, v22
v_add_f32 v26, v26, v30
v_add_f32 v34, v34, v38
v_add_f32 v11, v11, v43
v_add_f32 v19, v19, v23
v_add_f32 v27, v27, v31
v_add_f32 v35, v35, v39
v_add_f32 v8, v8, v16
v_add_f32 v24, v24, v32
v_add_f32 v9, v9, v17
v_add_f32 v25, v25, v33
v_add_f32 v10, v10, v18
v_add_f32 v26, v26, v34
v_add_f32 v11, v11, v19
v_add_f32 v27, v27, v35
v_add_f32 v8, v8, v24
v_add_f32 v9, v9, v25
v_add_f32 v10, v10, v26
v_add_f32 v11, v11, v27
v_mul_f32 v8, 0x3b000000, v8
v_mul_f32 v9, 0x3b000000, v9
v_mul_f32 v10, 0x3b000000, v10
v_mul_f32 v11, 0x3b000000, v11
v_fma_f32 v9, -v8, v8, v9
v_fma_f32 v11, -v10, v10, v11
v_max_f32 v9, 0, v9
v_max_f32 v11, 0, v11
v_add_f32 v9, 0x3727c5ac, v9
v_add_f32 v11, 0x3727c5ac, v11
v_rsq_f32 v9, v9
v_rsq_f32 v11, v11
v_sub_f32 v8, v2, v8
v_sub_f32 v10, v3, v10
v_mul_f32 v8, v8, v9
v_mul_f32 v10, v10, v11
v_cvt_pk_bf16_f32 v8, v8, v8
v_cvt_pk_bf16_f32 v10, v10, v10
v_lshlrev_b32 v12, 1, v0
ds_write_b16 v12, v8 offset:16640
ds_write_b16 v12, v10 offset:17664
s_waitcnt lgkmcnt(0)
s_barrier
s_mov_b32 s74, 1
s_mov_b32 s52, 0
s_mov_b32 s33, 1
ds_read_b128 v[8:11], v5 offset:0
ds_read_b128 v[12:15], v5 offset:64
ds_read_b128 v[16:19], v5 offset:128
ds_read_b128 v[20:23], v5 offset:192
ds_read_b128 v[24:27], v5 offset:256
ds_read_b128 v[28:31], v5 offset:320
ds_read_b128 v[32:35], v5 offset:384
ds_read_b128 v[36:39], v5 offset:448
ds_read_b128 v[44:47], v5 offset:512
ds_read_b128 v[48:51], v5 offset:576
ds_read_b128 v[52:55], v5 offset:640
ds_read_b128 v[56:59], v5 offset:704
ds_read_b128 v[60:63], v5 offset:768
ds_read_b128 v[64:67], v5 offset:832
ds_read_b128 v[68:71], v5 offset:896
s_waitcnt lgkmcnt(14)
v_mfma_f32_16x16x32_bf16 v[40:43], v[8:11], v[72:75], 0
s_waitcnt lgkmcnt(13)
v_mfma_f32_16x16x32_bf16 v[40:43], v[12:15], v[76:79], v[40:43]
s_waitcnt lgkmcnt(12)
v_mfma_f32_16x16x32_bf16 v[40:43], v[16:19], v[80:83], v[40:43]
s_waitcnt lgkmcnt(11)
v_mfma_f32_16x16x32_bf16 v[40:43], v[20:23], v[84:87], v[40:43]
s_waitcnt lgkmcnt(10)
v_mfma_f32_16x16x32_bf16 v[40:43], v[24:27], v[88:91], v[40:43]
s_waitcnt lgkmcnt(9)
v_mfma_f32_16x16x32_bf16 v[40:43], v[28:31], v[92:95], v[40:43]
s_waitcnt lgkmcnt(8)
v_mfma_f32_16x16x32_bf16 v[40:43], v[32:35], v[96:99], v[40:43]
s_waitcnt lgkmcnt(7)
v_mfma_f32_16x16x32_bf16 v[40:43], v[36:39], v[100:103], v[40:43]
s_waitcnt lgkmcnt(6)
v_mfma_f32_16x16x32_bf16 v[40:43], v[44:47], v[104:107], v[40:43]
s_waitcnt lgkmcnt(5)
v_mfma_f32_16x16x32_bf16 v[40:43], v[48:51], v[108:111], v[40:43]
s_waitcnt lgkmcnt(4)
v_mfma_f32_16x16x32_bf16 v[40:43], v[52:55], v[112:115], v[40:43]
s_waitcnt lgkmcnt(3)
v_mfma_f32_16x16x32_bf16 v[40:43], v[56:59], v[116:119], v[40:43]
s_waitcnt lgkmcnt(2)
v_mfma_f32_16x16x32_bf16 v[40:43], v[60:63], v[120:123], v[40:43]
s_waitcnt lgkmcnt(1)
v_mfma_f32_16x16x32_bf16 v[40:43], v[64:67], v[124:127], v[40:43]
s_waitcnt lgkmcnt(0)
v_mfma_f32_16x16x32_bf16 v[40:43], v[68:71], v[128:131], v[40:43]
ds_read_b128 v[8:11], v5 offset:960
s_waitcnt lgkmcnt(0)
v_mfma_f32_16x16x32_bf16 v[40:43], v[8:11], v[132:135], v[40:43]
s_nop 7
v_mov_b32_dpp v44, v40 quad_perm:[1,0,3,2] row_mask:0xf bank_mask:0xf
v_mov_b32_dpp v45, v41 quad_perm:[1,0,3,2] row_mask:0xf bank_mask:0xf
v_cvt_pk_bf16_f32 v40, v40, v44
v_cvt_pk_bf16_f32 v41, v41, v45
v_min_u32 v40, 0xfffffffe, v40
v_min_u32 v41, 0xfffffffe, v41
v_lshlrev_b32 v44, 1, v1
s_lshl_b32 s4, s30, 5
v_add_u32 v44, s4, v44
s_cmp_eq_u32 s74, 0
s_cbranch_scc1 .L102
s_add_u32 s3, s52, 0
s_lshl_b32 s3, s3, 5
s_add_u32 s3, s3, s31
s_mul_i32 s3, s3, 1792
s_add_u32 s3, s3, 4194304
v_add_u32 v45, s3, v44
s_mov_b64 exec, 0x5555
global_store_dword v45, v40, s[28:29] offset:0 sc1
global_store_dword v45, v40, s[28:29] offset:256 sc1
global_store_dword v45, v40, s[28:29] offset:512 sc1
global_store_dword v45, v40, s[28:29] offset:768 sc1
global_store_dword v45, v40, s[28:29] offset:1024 sc1
global_store_dword v45, v40, s[28:29] offset:1280 sc1
global_store_dword v45, v40, s[28:29] offset:1536 sc1
s_mov_b64 exec, -1
.L102:
s_nop 4
s_cmp_eq_u32 s74, 0
s_cbranch_scc1 .L103
s_add_u32 s3, s33, 0
s_lshl_b32 s3, s3, 5
s_add_u32 s3, s3, s31
s_mul_i32 s3, s3, 1792
s_add_u32 s3, s3, 4194304
v_add_u32 v45, s3, v44
s_mov_b64 exec, 0x5555
global_store_dword v45, v41, s[28:29] offset:0 sc1
global_store_dword v45, v41, s[28:29] offset:256 sc1
global_store_dword v45, v41, s[28:29] offset:512 sc1
global_store_dword v45, v41, s[28:29] offset:768 sc1
global_store_dword v45, v41, s[28:29] offset:1024 sc1
global_store_dword v45, v41, s[28:29] offset:1280 sc1
global_store_dword v45, v41, s[28:29] offset:1536 sc1
s_mov_b64 exec, -1
.L103:
s_nop 4
v_lshrrev_b32 v18, 4, v1
v_bfe_u32 v19, v1, 2, 2
v_lshl_add_u32 v18, v18, 3, v19
v_and_b32 v19, 3, v1
v_lshlrev_b32 v19, 3, v19
s_waitcnt vmcnt(0)
s_barrier
s_lshl_b32 s3, s30, 7
s_add_u32 s3, s3, 0
v_mul_u32_u24 v20, 1024, v18
v_add_u32 v20, v20, v19
v_add_u32 v20, s3, v20
v_add_u32 v20, 24576, v20
ds_read_b64_tr_b16 v[136:137], v20 offset:0
ds_read_b64_tr_b16 v[138:139], v20 offset:4096
ds_read_b64_tr_b16 v[140:141], v20 offset:32768
ds_read_b64_tr_b16 v[142:143], v20 offset:36864
v_add_u32 v20, 65536, v20
ds_read_b64_tr_b16 v[144:145], v20 offset:0
ds_read_b64_tr_b16 v[146:147], v20 offset:4096
ds_read_b64_tr_b16 v[148:149], v20 offset:32768
ds_read_b64_tr_b16 v[150:151], v20 offset:36864
s_lshl_b32 s3, s30, 7
s_add_u32 s3, s3, 32
v_mul_u32_u24 v20, 1024, v18
v_add_u32 v20, v20, v19
v_add_u32 v20, s3, v20
v_add_u32 v20, 24576, v20
ds_read_b64_tr_b16 v[152:153], v20 offset:0
ds_read_b64_tr_b16 v[154:155], v20 offset:4096
ds_read_b64_tr_b16 v[156:157], v20 offset:32768
ds_read_b64_tr_b16 v[158:159], v20 offset:36864
v_add_u32 v20, 65536, v20
ds_read_b64_tr_b16 v[160:161], v20 offset:0
ds_read_b64_tr_b16 v[162:163], v20 offset:4096
ds_read_b64_tr_b16 v[164:165], v20 offset:32768
ds_read_b64_tr_b16 v[166:167], v20 offset:36864
s_lshl_b32 s3, s30, 7
s_add_u32 s3, s3, 64
v_mul_u32_u24 v20, 1024, v18
v_add_u32 v20, v20, v19
v_add_u32 v20, s3, v20
v_add_u32 v20, 24576, v20
ds_read_b64_tr_b16 v[168:169], v20 offset:0
ds_read_b64_tr_b16 v[170:171], v20 offset:4096
ds_read_b64_tr_b16 v[172:173], v20 offset:32768
ds_read_b64_tr_b16 v[174:175], v20 offset:36864
v_add_u32 v20, 65536, v20
ds_read_b64_tr_b16 v[176:177], v20 offset:0
ds_read_b64_tr_b16 v[178:179], v20 offset:4096
ds_read_b64_tr_b16 v[180:181], v20 offset:32768
ds_read_b64_tr_b16 v[182:183], v20 offset:36864
s_lshl_b32 s3, s30, 7
s_add_u32 s3, s3, 96
v_mul_u32_u24 v20, 1024, v18
v_add_u32 v20, v20, v19
v_add_u32 v20, s3, v20
v_add_u32 v20, 24576, v20
ds_read_b64_tr_b16 v[184:185], v20 offset:0
ds_read_b64_tr_b16 v[186:187], v20 offset:4096
ds_read_b64_tr_b16 v[188:189], v20 offset:32768
ds_read_b64_tr_b16 v[190:191], v20 offset:36864
v_add_u32 v20, 65536, v20
ds_read_b64_tr_b16 v[192:193], v20 offset:0
ds_read_b64_tr_b16 v[194:195], v20 offset:4096
ds_read_b64_tr_b16 v[196:197], v20 offset:32768
ds_read_b64_tr_b16 v[198:199], v20 offset:36864
s_waitcnt lgkmcnt(0)
s_barrier
s_mov_b32 s64, s20
s_and_b32 s65, s21, 0xffff
s_mov_b32 s66, 1409024
s_mov_b32 s67, 0x00020000
s_mul_i32 s3, s30, 384
v_add_u32 v2, s3, v1
s_lshl_b32 s7, s34, 4
s_mov_b32 s4, 24576
s_mul_i32 s5, s30, 6144
s_add_u32 s4, s4, s5
s_mov_b32 s6, 0xaaaaaaab
v_add_u32 v3, 0, v2
v_mul_hi_u32 v8, v3, s6
v_lshrrev_b32 v8, 2, v8
v_mul_u32_u24 v9, 6, v8
v_sub_u32 v9, v3, v9
v_mul_u32_u24 v8, 2752, v8
v_lshl_add_u32 v8, v9, 4, v8
s_add_u32 s5, s4, 0
s_mov_b32 m0, s5
s_nop 0
buffer_load_dwordx4 v8, s[64:67], s7 offen nt lds
v_add_u32 v3, 64, v2
v_mul_hi_u32 v8, v3, s6
v_lshrrev_b32 v8, 2, v8
v_mul_u32_u24 v9, 6, v8
v_sub_u32 v9, v3, v9
v_mul_u32_u24 v8, 2752, v8
v_lshl_add_u32 v8, v9, 4, v8
s_add_u32 s5, s4, 1024
s_mov_b32 m0, s5
s_nop 0
buffer_load_dwordx4 v8, s[64:67], s7 offen nt lds
v_add_u32 v3, 128, v2
v_mul_hi_u32 v8, v3, s6
v_lshrrev_b32 v8, 2, v8
v_mul_u32_u24 v9, 6, v8
v_sub_u32 v9, v3, v9
v_mul_u32_u24 v8, 2752, v8
v_lshl_add_u32 v8, v9, 4, v8
s_add_u32 s5, s4, 2048
s_mov_b32 m0, s5
s_nop 0
buffer_load_dwordx4 v8, s[64:67], s7 offen nt lds
v_add_u32 v3, 192, v2
v_mul_hi_u32 v8, v3, s6
v_lshrrev_b32 v8, 2, v8
v_mul_u32_u24 v9, 6, v8
v_sub_u32 v9, v3, v9
v_mul_u32_u24 v8, 2752, v8
v_lshl_add_u32 v8, v9, 4, v8
s_add_u32 s5, s4, 3072
s_mov_b32 m0, s5
s_nop 0
buffer_load_dwordx4 v8, s[64:67], s7 offen nt lds
v_add_u32 v3, 256, v2
v_mul_hi_u32 v8, v3, s6
v_lshrrev_b32 v8, 2, v8
v_mul_u32_u24 v9, 6, v8
v_sub_u32 v9, v3, v9
v_mul_u32_u24 v8, 2752, v8
v_lshl_add_u32 v8, v9, 4, v8
s_add_u32 s5, s4, 4096
s_mov_b32 m0, s5
s_nop 0
buffer_load_dwordx4 v8, s[64:67], s7 offen nt lds
v_add_u32 v3, 320, v2
v_mul_hi_u32 v8, v3, s6
v_lshrrev_b32 v8, 2, v8
v_mul_u32_u24 v9, 6, v8
v_sub_u32 v9, v3, v9
v_mul_u32_u24 v8, 2752, v8
v_lshl_add_u32 v8, v9, 4, v8
s_add_u32 s5, s4, 5120
s_mov_b32 m0, s5
s_nop 0
buffer_load_dwordx4 v8, s[64:67], s7 offen nt lds
s_mov_b32 s64, s22
s_and_b32 s65, s23, 0xffff
s_mov_b32 s66, 1409024
s_mov_b32 s67, 0x00020000
s_lshl_b32 s4, s34, 3
s_mul_i32 s5, s30, 6
s_add_u32 s4, s4, s5
v_lshlrev_b32 v2, 4, v1
s_add_u32 s6, s4, 0
s_min_u32 s6, s6, 1375
s_lshl_b32 s6, s6, 10
s_mul_i32 s7, s30, 6144
s_add_u32 s7, s7, 73728
s_mov_b32 m0, s7
s_nop 0
buffer_load_dwordx4 v2, s[64:67], s6 offen nt lds
s_add_u32 s6, s4, 1
s_min_u32 s6, s6, 1375
s_lshl_b32 s6, s6, 10
s_mul_i32 s7, s30, 6144
s_add_u32 s7, s7, 74752
s_mov_b32 m0, s7
s_nop 0
buffer_load_dwordx4 v2, s[64:67], s6 offen nt lds
s_add_u32 s6, s4, 2
s_min_u32 s6, s6, 1375
s_lshl_b32 s6, s6, 10
s_mul_i32 s7, s30, 6144
s_add_u32 s7, s7, 75776
s_mov_b32 m0, s7
s_nop 0
buffer_load_dwordx4 v2, s[64:67], s6 offen nt lds
s_add_u32 s6, s4, 3
s_min_u32 s6, s6, 1375
s_lshl_b32 s6, s6, 10
s_mul_i32 s7, s30, 6144
s_add_u32 s7, s7, 76800
s_mov_b32 m0, s7
s_nop 0
buffer_load_dwordx4 v2, s[64:67], s6 offen nt lds
s_add_u32 s6, s4, 4
s_min_u32 s6, s6, 1375
s_lshl_b32 s6, s6, 10
s_mul_i32 s7, s30, 6144
s_add_u32 s7, s7, 77824
s_mov_b32 m0, s7
s_nop 0
buffer_load_dwordx4 v2, s[64:67], s6 offen nt lds
s_add_u32 s6, s4, 5
s_min_u32 s6, s6, 1375
s_lshl_b32 s6, s6, 10
s_mul_i32 s7, s30, 6144
s_add_u32 s7, s7, 78848
s_mov_b32 m0, s7
s_nop 0
buffer_load_dwordx4 v2, s[64:67], s6 offen nt lds
s_waitcnt vmcnt(0)
s_barrier
s_mul_i32 s3, s30, 6144
s_add_u32 s3, s3, 0
v_mul_u32_u24 v20, 96, v18
v_add_u32 v20, v20, v19
v_add_u32 v20, s3, v20
v_add_u32 v20, 24576, v20
ds_read_b64_tr_b16 v[200:201], v20 offset:0
ds_read_b64_tr_b16 v[202:203], v20 offset:384
ds_read_b64_tr_b16 v[204:205], v20 offset:3072
ds_read_b64_tr_b16 v[206:207], v20 offset:3456
s_mul_i32 s3, s30, 6144
s_add_u32 s3, s3, 32
v_mul_u32_u24 v20, 96, v18
v_add_u32 v20, v20, v19
v_add_u32 v20, s3, v20
v_add_u32 v20, 24576, v20
ds_read_b64_tr_b16 v[208:209], v20 offset:0
ds_read_b64_tr_b16 v[210:211], v20 offset:384
ds_read_b64_tr_b16 v[212:213], v20 offset:3072
ds_read_b64_tr_b16 v[214:215], v20 offset:3456
s_mul_i32 s3, s30, 6144
s_add_u32 s3, s3, 64
v_mul_u32_u24 v20, 96, v18
v_add_u32 v20, v20, v19
v_add_u32 v20, s3, v20
v_add_u32 v20, 24576, v20
ds_read_b64_tr_b16 v[216:217], v20 offset:0
ds_read_b64_tr_b16 v[218:219], v20 offset:384
ds_read_b64_tr_b16 v[220:221], v20 offset:3072
ds_read_b64_tr_b16 v[222:223], v20 offset:3456
s_lshl_b32 s3, s30, 7
s_add_u32 s3, s3, 0
v_mul_u32_u24 v20, 1024, v18
v_add_u32 v20, v20, v19
v_add_u32 v20, s3, v20
v_add_u32 v20, 73728, v20
ds_read_b64_tr_b16 v[224:225], v20 offset:0
ds_read_b64_tr_b16 v[226:227], v20 offset:4096
ds_read_b64_tr_b16 v[228:229], v20 offset:32768
ds_read_b64_tr_b16 v[230:231], v20 offset:36864
s_lshl_b32 s3, s30, 7
s_add_u32 s3, s3, 32
v_mul_u32_u24 v20, 1024, v18
v_add_u32 v20, v20, v19
v_add_u32 v20, s3, v20
v_add_u32 v20, 73728, v20
ds_read_b64_tr_b16 v[232:233], v20 offset:0
ds_read_b64_tr_b16 v[234:235], v20 offset:4096
ds_read_b64_tr_b16 v[236:237], v20 offset:32768
ds_read_b64_tr_b16 v[238:239], v20 offset:36864
s_lshl_b32 s3, s30, 7
s_add_u32 s3, s3, 64
v_mul_u32_u24 v20, 1024, v18
v_add_u32 v20, v20, v19
v_add_u32 v20, s3, v20
v_add_u32 v20, 73728, v20
ds_read_b64_tr_b16 v[240:241], v20 offset:0
ds_read_b64_tr_b16 v[242:243], v20 offset:4096
ds_read_b64_tr_b16 v[244:245], v20 offset:32768
ds_read_b64_tr_b16 v[246:247], v20 offset:36864
s_lshl_b32 s3, s30, 7
s_add_u32 s3, s3, 96
v_mul_u32_u24 v20, 1024, v18
v_add_u32 v20, v20, v19
v_add_u32 v20, s3, v20
v_add_u32 v20, 73728, v20
ds_read_b64_tr_b16 v[248:249], v20 offset:0
ds_read_b64_tr_b16 v[250:251], v20 offset:4096
ds_read_b64_tr_b16 v[252:253], v20 offset:32768
ds_read_b64_tr_b16 v[254:255], v20 offset:36864
s_waitcnt lgkmcnt(0)
v_cmp_gt_u32 vcc, 32, v1
s_nop 1
v_cndmask_b32 v228, 0, v228, vcc
v_cndmask_b32 v229, 0, v229, vcc
v_cndmask_b32 v230, 0, v230, vcc
v_cndmask_b32 v231, 0, v231, vcc
v_cndmask_b32 v236, 0, v236, vcc
v_cndmask_b32 v237, 0, v237, vcc
v_cndmask_b32 v238, 0, v238, vcc
v_cndmask_b32 v239, 0, v239, vcc
v_cndmask_b32 v244, 0, v244, vcc
v_cndmask_b32 v245, 0, v245, vcc
v_cndmask_b32 v246, 0, v246, vcc
v_cndmask_b32 v247, 0, v247, vcc
v_cndmask_b32 v252, 0, v252, vcc
v_cndmask_b32 v253, 0, v253, vcc
v_cndmask_b32 v254, 0, v254, vcc
v_cndmask_b32 v255, 0, v255, vcc
s_lshl_b32 s3, s35, 3
s_sub_u32 s3, s3, 32
v_and_b32 v8, 15, v1
v_cmp_gt_u32 vcc, s3, v8
s_nop 1
v_cndmask_b32 v216, 0, v216, vcc
v_cndmask_b32 v217, 0, v217, vcc
v_cndmask_b32 v218, 0, v218, vcc
v_cndmask_b32 v219, 0, v219, vcc
v_cndmask_b32 v220, 0, v220, vcc
v_cndmask_b32 v221, 0, v221, vcc
v_cndmask_b32 v222, 0, v222, vcc
v_cndmask_b32 v223, 0, v223, vcc
s_cmp_lg_u32 s30, 0
s_cbranch_scc1 .L106
v_and_b32 v10, 7, v1
v_lshlrev_b32 v10, 2, v10
.L104:
s_nop 4
global_load_dword v11, v10, s[26:27] offset:224 sc1
s_waitcnt vmcnt(0)
v_cmp_ne_u32 vcc, 0x01010101, v11
s_nop 0
s_cmp_eq_u64 vcc, 0
s_cbranch_scc1 .L105
s_sleep 4
s_add_u32 s47, s47, 1
s_cmp_lt_u32 s47, 262144
s_cbranch_scc1 .L104
s_endpgm
.L105:
s_nop 4
.L106:
s_nop 4
s_barrier
s_mov_b32 s52, 0
L_ch_loop:
s_nop 4
s_sub_u32 s55, s52, 2
s_sub_u32 s68, s52, 3
s_sub_u32 s69, s52, 4
s_cmp_lt_u32 s52, 8
s_cselect_b32 s74, 1, 0
s_cmp_lt_u32 s55, 8
s_cselect_b32 s75, 1, 0
s_cmp_lt_u32 s68, 8
s_cselect_b32 s78, 1, 0
s_cmp_lt_u32 s69, 8
s_cselect_b32 s79, 1, 0
s_mov_b32 s91, s52
s_mov_b32 s92, s52
s_mov_b32 s94, s74
s_mov_b32 s95, 0
s_cmp_lt_u32 s52, 8
s_cbranch_scc1 .L107
s_mov_b32 s91, 15
s_mov_b32 s92, 7
s_mov_b32 s55, 6
s_cmp_eq_u32 s52, 9
s_cselect_b32 s75, 1, 0
s_cselect_b32 s94, 1, 0
s_cmp_lt_u32 s52, 10
s_cselect_b32 s78, 1, 0
s_cmp_eq_u32 s52, 10
s_cselect_b32 s95, 1, 0
.L107:
s_nop 4
s_or_b32 s89, s94, s75
s_cmp_eq_u32 s89, 0
s_cbranch_scc1 .L108
v_and_b32 v2, 7, v1
v_min_u32 v18, 6, v2
v_mul_u32_u24 v18, 528, v18
v_lshrrev_b32 v3, 3, v1
s_lshl_b32 s3, s30, 6
v_lshl_add_u32 v19, v3, 3, v18
v_add_u32 v19, s3, v19
v_mov_b32 v8, 1.0
v_mov_b32 v9, 1.0
v_mov_b32 v10, 1.0
v_mov_b32 v11, 1.0
v_mov_b32 v12, 1.0
v_mov_b32 v13, 1.0
v_mov_b32 v14, 1.0
v_mov_b32 v15, 1.0
.L109:
s_nop 4
s_cmp_eq_u32 s94, 0
s_cbranch_scc1 .L111
s_mov_b32 s3, s91
s_lshl_b32 s3, s3, 5
s_add_u32 s3, s3, s31
s_mul_i32 s3, s3, 3696
v_add_u32 v20, s3, v18
v_add_u32 v21, s3, v19
global_load_dwordx2 v[8:9], v20, s[28:29] offset:512 sc1
global_load_dwordx2 v[10:11], v21, s[28:29] offset:0 sc1
.L111:
s_nop 4
s_cmp_eq_u32 s75, 0
s_cbranch_scc1 .L112
s_add_u32 s3, s55, 8
s_lshl_b32 s3, s3, 5
s_add_u32 s3, s3, s31
s_mul_i32 s3, s3, 3696
v_add_u32 v20, s3, v18
v_add_u32 v21, s3, v19
global_load_dwordx2 v[12:13], v20, s[28:29] offset:512 sc1
global_load_dwordx2 v[14:15], v21, s[28:29] offset:0 sc1
.L112:
s_nop 4
s_waitcnt vmcnt(0)
v_max3_u32 v16, v8, v9, v10
v_max3_u32 v17, v11, v12, v13
v_max3_u32 v16, v16, v14, v15
v_max_u32 v16, v16, v17
v_cmp_eq_u32 vcc, -1, v16
s_nop 0
s_cmp_eq_u64 vcc, 0
s_cbranch_scc1 .L110
s_sleep 1
s_add_u32 s47, s47, 1
s_cmp_lt_u32 s47, 262144
s_cbranch_scc1 .L109
s_endpgm
.L110:
s_nop 4
v_cmp_eq_u32 vcc, 7, v2
v_mov_b32 v16, 0xff800000
s_nop 0
v_cndmask_b32 v8, v8, v16, vcc
v_cndmask_b32 v12, v12, v16, vcc
v_mov_b32 v16, v8
v_mov_b32 v17, v12
s_nop 0
v_max_f32_dpp v16, v16, v16 quad_perm:[1,0,3,2] row_mask:0xf bank_mask:0xf
v_max_f32_dpp v17, v17, v17 quad_perm:[1,0,3,2] row_mask:0xf bank_mask:0xf
s_nop 0
v_max_f32_dpp v16, v16, v16 quad_perm:[2,3,0,1] row_mask:0xf bank_mask:0xf
v_max_f32_dpp v17, v17, v17 quad_perm:[2,3,0,1] row_mask:0xf bank_mask:0xf
s_nop 0
v_max_f32_dpp v16, v16, v16 row_half_mirror row_mask:0xf bank_mask:0xf
v_max_f32_dpp v17, v17, v17 row_half_mirror row_mask:0xf bank_mask:0xf
v_sub_f32 v8, v8, v16
v_sub_f32 v12, v12, v17
v_exp_f32 v8, v8
v_exp_f32 v12, v12
v_mul_f32 v9, v9, v8
v_mul_f32 v13, v13, v12
v_mul_f32 v10, v10, v8
v_mul_f32 v14, v14, v12
v_mul_f32 v11, v11, v8
v_mul_f32 v15, v15, v12
v_add_f32_dpp v9, v9, v9 quad_perm:[1,0,3,2] row_mask:0xf bank_mask:0xf
v_add_f32_dpp v10, v10, v10 quad_perm:[1,0,3,2] row_mask:0xf bank_mask:0xf
v_add_f32_dpp v11, v11, v11 quad_perm:[1,0,3,2] row_mask:0xf bank_mask:0xf
v_add_f32_dpp v13, v13, v13 quad_perm:[1,0,3,2] row_mask:0xf bank_mask:0xf
v_add_f32_dpp v14, v14, v14 quad_perm:[1,0,3,2] row_mask:0xf bank_mask:0xf
v_add_f32_dpp v15, v15, v15 quad_perm:[1,0,3,2] row_mask:0xf bank_mask:0xf
v_add_f32_dpp v9, v9, v9 quad_perm:[2,3,0,1] row_mask:0xf bank_mask:0xf
v_add_f32_dpp v10, v10, v10 quad_perm:[2,3,0,1] row_mask:0xf bank_mask:0xf
v_add_f32_dpp v11, v11, v11 quad_perm:[2,3,0,1] row_mask:0xf bank_mask:0xf
v_add_f32_dpp v13, v13, v13 quad_perm:[2,3,0,1] row_mask:0xf bank_mask:0xf
v_add_f32_dpp v14, v14, v14 quad_perm:[2,3,0,1] row_mask:0xf bank_mask:0xf
v_add_f32_dpp v15, v15, v15 quad_perm:[2,3,0,1] row_mask:0xf bank_mask:0xf
v_add_f32_dpp v9, v9, v9 row_half_mirror row_mask:0xf bank_mask:0xf
v_add_f32_dpp v10, v10, v10 row_half_mirror row_mask:0xf bank_mask:0xf
v_add_f32_dpp v11, v11, v11 row_half_mirror row_mask:0xf bank_mask:0xf
v_add_f32_dpp v13, v13, v13 row_half_mirror row_mask:0xf bank_mask:0xf
v_add_f32_dpp v14, v14, v14 row_half_mirror row_mask:0xf bank_mask:0xf
v_add_f32_dpp v15, v15, v15 row_half_mirror row_mask:0xf bank_mask:0xf
v_rcp_f32 v9, v9
v_rcp_f32 v13, v13
v_mul_f32 v10, v10, v9
v_mul_f32 v11, v11, v9
v_mul_f32 v14, v14, v13
v_mul_f32 v15, v15, v13
v_cvt_pk_bf16_f32 v10, v10, v11
v_cvt_pk_bf16_f32 v14, v14, v15
s_lshl_b32 s3, s30, 5
v_lshlrev_b32 v3, 2, v3
v_add_u32 v3, s3, v3
ds_write_b32 v3, v10 offset:19712
ds_write_b32 v3, v14 offset:19968
s_waitcnt lgkmcnt(0)
s_barrier
ds_read_b128 v[8:11], v6 offset:0
ds_read_b128 v[12:15], v6 offset:64
ds_read_b128 v[16:19], v6 offset:128
ds_read_b128 v[20:23], v6 offset:192
s_waitcnt lgkmcnt(3)
v_mfma_f32_16x16x32_bf16 v[32:35], v[8:11], v[136:139], 0
v_mfma_f32_16x16x32_bf16 v[36:39], v[8:11], v[152:155], 0
v_mfma_f32_16x16x32_bf16 v[40:43], v[8:11], v[168:171], 0
v_mfma_f32_16x16x32_bf16 v[44:47], v[8:11], v[184:187], 0
s_waitcnt lgkmcnt(2)
v_mfma_f32_16x16x32_bf16 v[32:35], v[12:15], v[140:143], v[32:35]
v_mfma_f32_16x16x32_bf16 v[36:39], v[12:15], v[156:159], v[36:39]
v_mfma_f32_16x16x32_bf16 v[40:43], v[12:15], v[172:175], v[40:43]
v_mfma_f32_16x16x32_bf16 v[44:47], v[12:15], v[188:191], v[44:47]
s_waitcnt lgkmcnt(1)
v_mfma_f32_16x16x32_bf16 v[32:35], v[16:19], v[144:147], v[32:35]
v_mfma_f32_16x16x32_bf16 v[36:39], v[16:19], v[160:163], v[36:39]
v_mfma_f32_16x16x32_bf16 v[40:43], v[16:19], v[176:179], v[40:43]
v_mfma_f32_16x16x32_bf16 v[44:47], v[16:19], v[192:195], v[44:47]
s_waitcnt lgkmcnt(0)
v_mfma_f32_16x16x32_bf16 v[32:35], v[20:23], v[148:151], v[32:35]
v_mfma_f32_16x16x32_bf16 v[36:39], v[20:23], v[164:167], v[36:39]
v_mfma_f32_16x16x32_bf16 v[40:43], v[20:23], v[180:183], v[40:43]
v_mfma_f32_16x16x32_bf16 v[44:47], v[20:23], v[196:199], v[44:47]
s_nop 4
v_min_u32 v32, 0xfffffffe, v32
v_min_u32 v33, 0xfffffffe, v33
v_min_u32 v36, 0xfffffffe, v36
v_min_u32 v37, 0xfffffffe, v37
v_min_u32 v40, 0xfffffffe, v40
v_min_u32 v41, 0xfffffffe, v41
v_min_u32 v44, 0xfffffffe, v44
v_min_u32 v45, 0xfffffffe, v45
v_lshlrev_b32 v48, 2, v1
s_lshl_b32 s4, s30, 8
s_lshl_b32 s5, s31, 11
s_add_u32 s4, s4, s5
s_add_u32 s4, s4, 1900544
v_add_u32 v48, s4, v48
s_cmp_eq_u32 s94, 0
s_cbranch_scc1 .L113
s_mov_b32 s3, s91
s_lshl_b32 s3, s3, 16
v_add_u32 v49, s3, v48
s_mov_b64 exec, 0xffff
global_store_dword v49, v32, s[28:29] offset:0 sc1
global_store_dword v49, v36, s[28:29] offset:64 sc1
global_store_dword v49, v40, s[28:29] offset:128 sc1
global_store_dword v49, v44, s[28:29] offset:192 sc1
s_mov_b64 exec, -1
.L113:
s_nop 4
s_cmp_eq_u32 s75, 0
s_cbranch_scc1 .L114
s_add_u32 s3, s55, 8
s_lshl_b32 s3, s3, 16
v_add_u32 v49, s3, v48
s_mov_b64 exec, 0xffff
global_store_dword v49, v33, s[28:29] offset:0 sc1
global_store_dword v49, v37, s[28:29] offset:64 sc1
global_store_dword v49, v41, s[28:29] offset:128 sc1
global_store_dword v49, v45, s[28:29] offset:192 sc1
s_mov_b64 exec, -1
.L114:
s_nop 4
.L108:
s_nop 4
s_or_b32 s89, s94, s78
s_cmp_eq_u32 s89, 0
s_cbranch_scc1 .L115
s_cmp_lg_u32 s94, 0
s_cbranch_scc1 .L118
v_mov_b32 v8, 0
v_mov_b32 v9, 0
v_mov_b32 v10, 0
v_mov_b32 v11, 0
v_mov_b32 v12, 0
v_mov_b32 v13, 0
v_mov_b32 v14, 0
v_mov_b32 v15, 0
v_mov_b32 v16, 0
v_mov_b32 v17, 0
v_mov_b32 v18, 0
v_mov_b32 v19, 0
v_mov_b32 v20, 0
v_mov_b32 v21, 0
v_mov_b32 v22, 0
v_mov_b32 v23, 0
v_mov_b32 v24, 0
v_mov_b32 v25, 0
v_mov_b32 v26, 0
v_mov_b32 v27, 0
v_mov_b32 v28, 0
v_mov_b32 v29, 0
v_mov_b32 v30, 0
v_mov_b32 v31, 0
v_mov_b32 v32, 0
v_mov_b32 v33, 0
v_mov_b32 v34, 0
v_mov_b32 v35, 0
v_mov_b32 v36, 0
v_mov_b32 v37, 0
v_mov_b32 v38, 0
v_mov_b32 v39, 0
.L118:
s_nop 4
s_cmp_lg_u32 s78, 0
s_cbranch_scc1 .L119
v_mov_b32 v40, 0
v_mov_b32 v41, 0
v_mov_b32 v42, 0
v_mov_b32 v43, 0
v_mov_b32 v44, 0
v_mov_b32 v45, 0
v_mov_b32 v46, 0
v_mov_b32 v47, 0
v_mov_b32 v48, 0
v_mov_b32 v49, 0
v_mov_b32 v50, 0
v_mov_b32 v51, 0
v_mov_b32 v52, 0
v_mov_b32 v53, 0
v_mov_b32 v54, 0
v_mov_b32 v55, 0
v_mov_b32 v56, 0
v_mov_b32 v57, 0
v_mov_b32 v58, 0
v_mov_b32 v59, 0
v_mov_b32 v60, 0
v_mov_b32 v61, 0
v_mov_b32 v62, 0
v_mov_b32 v63, 0
v_mov_b32 v64, 0
v_mov_b32 v65, 0
v_mov_b32 v66, 0
v_mov_b32 v67, 0
v_mov_b32 v68, 0
v_mov_b32 v69, 0
v_mov_b32 v70, 0
v_mov_b32 v71, 0
.L119:
s_nop 4
.L116:
s_nop 4
s_cmp_eq_u32 s94, 0
s_cbranch_scc1 .L120
s_mov_b32 s3, s91
s_lshl_b32 s3, s3, 16
s_add_u32 s3, s3, 1904640
s_add_u32 s76, s28, s3
s_addc_u32 s77, s29, 0
global_load_dword v8, v4, s[76:77] offset:-4096 sc1
global_load_dword v9, v4, s[76:77] offset:-2048 sc1
global_load_dword v10, v4, s[76:77] offset:0 sc1
global_load_dword v11, v4, s[76:77] offset:2048 sc1
s_add_u32 s76, s76, 8192
s_addc_u32 s77, s77, 0
global_load_dword v12, v4, s[76:77] offset:-4096 sc1
global_load_dword v13, v4, s[76:77] offset:-2048 sc1
global_load_dword v14, v4, s[76:77] offset:0 sc1
global_load_dword v15, v4, s[76:77] offset:2048 sc1
s_add_u32 s76, s76, 8192
s_addc_u32 s77, s77, 0
global_load_dword v16, v4, s[76:77] offset:-4096 sc1
global_load_dword v17, v4, s[76:77] offset:-2048 sc1
global_load_dword v18, v4, s[76:77] offset:0 sc1
global_load_dword v19, v4, s[76:77] offset:2048 sc1
s_add_u32 s76, s76, 8192
s_addc_u32 s77, s77, 0
global_load_dword v20, v4, s[76:77] offset:-4096 sc1
global_load_dword v21, v4, s[76:77] offset:-2048 sc1
global_load_dword v22, v4, s[76:77] offset:0 sc1
global_load_dword v23, v4, s[76:77] offset:2048 sc1
s_add_u32 s76, s76, 8192
s_addc_u32 s77, s77, 0
global_load_dword v24, v4, s[76:77] offset:-4096 sc1
global_load_dword v25, v4, s[76:77] offset:-2048 sc1
global_load_dword v26, v4, s[76:77] offset:0 sc1
global_load_dword v27, v4, s[76:77] offset:2048 sc1
s_add_u32 s76, s76, 8192
s_addc_u32 s77, s77, 0
global_load_dword v28, v4, s[76:77] offset:-4096 sc1
global_load_dword v29, v4, s[76:77] offset:-2048 sc1
global_load_dword v30, v4, s[76:77] offset:0 sc1
global_load_dword v31, v4, s[76:77] offset:2048 sc1
s_add_u32 s76, s76, 8192
s_addc_u32 s77, s77, 0
global_load_dword v32, v4, s[76:77] offset:-4096 sc1
global_load_dword v33, v4, s[76:77] offset:-2048 sc1
global_load_dword v34, v4, s[76:77] offset:0 sc1
global_load_dword v35, v4, s[76:77] offset:2048 sc1
s_add_u32 s76, s76, 8192
s_addc_u32 s77, s77, 0
global_load_dword v36, v4, s[76:77] offset:-4096 sc1
global_load_dword v37, v4, s[76:77] offset:-2048 sc1
global_load_dword v38, v4, s[76:77] offset:0 sc1
global_load_dword v39, v4, s[76:77] offset:2048 sc1
.L120:
s_nop 4
s_cmp_eq_u32 s78, 0
s_cbranch_scc1 .L121
s_add_u32 s3, s68, 8
s_lshl_b32 s3, s3, 16
s_add_u32 s3, s3, 1904640
s_add_u32 s76, s28, s3
s_addc_u32 s77, s29, 0
global_load_dword v40, v4, s[76:77] offset:-4096 sc1
global_load_dword v41, v4, s[76:77] offset:-2048 sc1
global_load_dword v42, v4, s[76:77] offset:0 sc1
global_load_dword v43, v4, s[76:77] offset:2048 sc1
s_add_u32 s76, s76, 8192
s_addc_u32 s77, s77, 0
global_load_dword v44, v4, s[76:77] offset:-4096 sc1
global_load_dword v45, v4, s[76:77] offset:-2048 sc1
global_load_dword v46, v4, s[76:77] offset:0 sc1
global_load_dword v47, v4, s[76:77] offset:2048 sc1
s_add_u32 s76, s76, 8192
s_addc_u32 s77, s77, 0
global_load_dword v48, v4, s[76:77] offset:-4096 sc1
global_load_dword v49, v4, s[76:77] offset:-2048 sc1
global_load_dword v50, v4, s[76:77] offset:0 sc1
global_load_dword v51, v4, s[76:77] offset:2048 sc1
s_add_u32 s76, s76, 8192
s_addc_u32 s77, s77, 0
global_load_dword v52, v4, s[76:77] offset:-4096 sc1
global_load_dword v53, v4, s[76:77] offset:-2048 sc1
global_load_dword v54, v4, s[76:77] offset:0 sc1
global_load_dword v55, v4, s[76:77] offset:2048 sc1
s_add_u32 s76, s76, 8192
s_addc_u32 s77, s77, 0
global_load_dword v56, v4, s[76:77] offset:-4096 sc1
global_load_dword v57, v4, s[76:77] offset:-2048 sc1
global_load_dword v58, v4, s[76:77] offset:0 sc1
global_load_dword v59, v4, s[76:77] offset:2048 sc1
s_add_u32 s76, s76, 8192
s_addc_u32 s77, s77, 0
global_load_dword v60, v4, s[76:77] offset:-4096 sc1
global_load_dword v61, v4, s[76:77] offset:-2048 sc1
global_load_dword v62, v4, s[76:77] offset:0 sc1
global_load_dword v63, v4, s[76:77] offset:2048 sc1
s_add_u32 s76, s76, 8192
s_addc_u32 s77, s77, 0
global_load_dword v64, v4, s[76:77] offset:-4096 sc1
global_load_dword v65, v4, s[76:77] offset:-2048 sc1
global_load_dword v66, v4, s[76:77] offset:0 sc1
global_load_dword v67, v4, s[76:77] offset:2048 sc1
s_add_u32 s76, s76, 8192
s_addc_u32 s77, s77, 0
global_load_dword v68, v4, s[76:77] offset:-4096 sc1
global_load_dword v69, v4, s[76:77] offset:-2048 sc1
global_load_dword v70, v4, s[76:77] offset:0 sc1
global_load_dword v71, v4, s[76:77] offset:2048 sc1
.L121:
s_nop 4
s_waitcnt vmcnt(0)
v_max3_u32 v2, v8, v9, v10
v_max3_u32 v3, v11, v12, v13
v_max3_u32 v2, v2, v14, v15
v_max3_u32 v3, v3, v16, v17
v_max3_u32 v2, v2, v18, v19
v_max3_u32 v3, v3, v20, v21
v_max3_u32 v2, v2, v22, v23
v_max3_u32 v3, v3, v24, v25
v_max3_u32 v2, v2, v26, v27
v_max3_u32 v3, v3, v28, v29
v_max3_u32 v2, v2, v30, v31
v_max3_u32 v3, v3, v32, v33
v_max3_u32 v2, v2, v34, v35
v_max3_u32 v3, v3, v36, v37
v_max3_u32 v2, v2, v38, v39
v_max3_u32 v3, v3, v40, v41
v_max3_u32 v2, v2, v42, v43
v_max3_u32 v3, v3, v44, v45
v_max3_u32 v2, v2, v46, v47
v_max3_u32 v3, v3, v48, v49
v_max3_u32 v2, v2, v50, v51
v_max3_u32 v3, v3, v52, v53
v_max3_u32 v2, v2, v54, v55
v_max3_u32 v3, v3, v56, v57
v_max3_u32 v2, v2, v58, v59
v_max3_u32 v3, v3, v60, v61
v_max3_u32 v2, v2, v62, v63
v_max3_u32 v3, v3, v64, v65
v_max3_u32 v2, v2, v66, v67
v_max3_u32 v3, v3, v68, v69
v_max3_u32 v2, v2, v70, v71
v_max_u32 v2, v2, v3
v_cmp_eq_u32 vcc, -1, v2
s_nop 0
s_cmp_eq_u64 vcc, 0
s_cbranch_scc1 .L117
s_sleep 1
s_add_u32 s47, s47, 1
s_cmp_lt_u32 s47, 262144
s_cbranch_scc1 .L116
s_endpgm
.L117:
s_nop 4
v_add_f32 v8, v8, v9
v_add_f32 v40, v40, v41
v_add_f32 v10, v10, v11
v_add_f32 v42, v42, v43
v_add_f32 v12, v12, v13
v_add_f32 v44, v44, v45
v_add_f32 v14, v14, v15
v_add_f32 v46, v46, v47
v_add_f32 v16, v16, v17
v_add_f32 v48, v48, v49
v_add_f32 v18, v18, v19
v_add_f32 v50, v50, v51
v_add_f32 v20, v20, v21
v_add_f32 v52, v52, v53
v_add_f32 v22, v22, v23
v_add_f32 v54, v54, v55
v_add_f32 v24, v24, v25
v_add_f32 v56, v56, v57
v_add_f32 v26, v26, v27
v_add_f32 v58, v58, v59
v_add_f32 v28, v28, v29
v_add_f32 v60, v60, v61
v_add_f32 v30, v30, v31
v_add_f32 v62, v62, v63
v_add_f32 v32, v32, v33
v_add_f32 v64, v64, v65
v_add_f32 v34, v34, v35
v_add_f32 v66, v66, v67
v_add_f32 v36, v36, v37
v_add_f32 v68, v68, v69
v_add_f32 v38, v38, v39
v_add_f32 v70, v70, v71
s_min_u32 s4, s92, 7
s_min_u32 s5, s68, 7
s_lshl_b32 s4, s4, 11
s_lshl_b32 s5, s5, 11
v_add_u32 v9, s4, v4
v_add_u32 v41, s5, v4
ds_read_b32 v2, v9 offset:0
ds_read_b32 v3, v41 offset:0
v_add_f32 v8, v8, v10
v_add_f32 v40, v40, v42
v_add_f32 v12, v12, v14
v_add_f32 v44, v44, v46
v_add_f32 v16, v16, v18
v_add_f32 v48, v48, v50
v_add_f32 v20, v20, v22
v_add_f32 v52, v52, v54
v_add_f32 v24, v24, v26
v_add_f32 v56, v56, v58
v_add_f32 v28, v28, v30
v_add_f32 v60, v60, v62
v_add_f32 v32, v32, v34
v_add_f32 v64, v64, v66
v_add_f32 v36, v36, v38
v_add_f32 v68, v68, v70
v_add_f32 v8, v8, v12
v_add_f32 v40, v40, v44
v_add_f32 v16, v16, v20
v_add_f32 v48, v48, v52
v_add_f32 v24, v24, v28
v_add_f32 v56, v56, v60
v_add_f32 v32, v32, v36
v_add_f32 v64, v64, v68
v_add_f32 v8, v8, v16
v_add_f32 v40, v40, v48
v_add_f32 v24, v24, v32
v_add_f32 v56, v56, v64
v_add_f32 v8, v8, v24
v_add_f32 v40, v40, v56
v_cvt_pk_bf16_f32 v10, v8, v40
v_lshlrev_b32 v11, 16, v10
v_and_b32 v10, 0xffff0000, v10
s_waitcnt lgkmcnt(0)
v_add_f32 v2, v2, v11
v_add_f32 v3, v3, v10
v_cvt_pk_bf16_f32 v10, v2, v3
v_lshlrev_b32 v2, 16, v10
v_and_b32 v3, 0xffff0000, v10
s_cmp_eq_u32 s94, 0
s_cbranch_scc1 .L122
ds_write_b32 v9, v2 offset:0
.L122:
s_nop 4
s_cmp_eq_u32 s78, 0
s_cbranch_scc1 .L123
ds_write_b32 v41, v3 offset:0
.L123:
s_nop 4
v_mov_b32 v12, v2
v_mul_f32 v13, v2, v2
v_mov_b32 v14, v3
v_mul_f32 v15, v3, v3
v_add_f32_dpp v12, v12, v12 row_ror:8 row_mask:0xf bank_mask:0xf
v_add_f32_dpp v13, v13, v13 row_ror:8 row_mask:0xf bank_mask:0xf
v_add_f32_dpp v14, v14, v14 row_ror:8 row_mask:0xf bank_mask:0xf
v_add_f32_dpp v15, v15, v15 row_ror:8 row_mask:0xf bank_mask:0xf
v_add_f32_dpp v12, v12, v12 row_ror:4 row_mask:0xf bank_mask:0xf
v_add_f32_dpp v13, v13, v13 row_ror:4 row_mask:0xf bank_mask:0xf
v_add_f32_dpp v14, v14, v14 row_ror:4 row_mask:0xf bank_mask:0xf
v_add_f32_dpp v15, v15, v15 row_ror:4 row_mask:0xf bank_mask:0xf
v_add_f32_dpp v12, v12, v12 row_ror:2 row_mask:0xf bank_mask:0xf
v_add_f32_dpp v13, v13, v13 row_ror:2 row_mask:0xf bank_mask:0xf
v_add_f32_dpp v14, v14, v14 row_ror:2 row_mask:0xf bank_mask:0xf
v_add_f32_dpp v15, v15, v15 row_ror:2 row_mask:0xf bank_mask:0xf
v_add_f32_dpp v12, v12, v12 row_ror:1 row_mask:0xf bank_mask:0xf
v_add_f32_dpp v13, v13, v13 row_ror:1 row_mask:0xf bank_mask:0xf
v_add_f32_dpp v14, v14, v14 row_ror:1 row_mask:0xf bank_mask:0xf
v_add_f32_dpp v15, v15, v15 row_ror:1 row_mask:0xf bank_mask:0xf
v_mov_b32 v16, v12
v_mov_b32 v17, v13
v_mov_b32 v18, v14
v_mov_b32 v19, v15
v_permlane16_swap_b32 v12, v16
v_permlane16_swap_b32 v13, v17
v_permlane16_swap_b32 v14, v18
v_permlane16_swap_b32 v15, v19
v_add_f32 v12, v12, v16
v_add_f32 v13, v13, v17
v_add_f32 v14, v14, v18
v_add_f32 v15, v15, v19
v_mov_b32 v16, v12
v_mov_b32 v17, v13
v_mov_b32 v18, v14
v_mov_b32 v19, v15
v_permlane32_swap_b32 v12, v16
v_permlane32_swap_b32 v13, v17
v_permlane32_swap_b32 v14, v18
v_permlane32_swap_b32 v15, v19
v_add_f32 v12, v12, v16
v_add_f32 v13, v13, v17
v_add_f32 v14, v14, v18
v_add_f32 v15, v15, v19
s_lshl_b32 s3, s30, 4
v_mov_b32 v16, s3
s_mov_b64 exec, 1
ds_write_b128 v16, v[12:15] offset:16384
s_mov_b64 exec, -1
s_waitcnt lgkmcnt(0)
s_barrier
v_mov_b32 v12, 0
ds_read_b128 v[8:11], v12 offset:16384
ds_read_b128 v[16:19], v12 offset:16416
ds_read_b128 v[20:23], v12 offset:16432
ds_read_b128 v[24:27], v12 offset:16448
ds_read_b128 v[28:31], v12 offset:16464
ds_read_b128 v[32:35], v12 offset:16480
ds_read_b128 v[36:39], v12 offset:16496
ds_read_b128 v[40:43], v12 offset:16400
s_waitcnt lgkmcnt(0)
v_add_f32 v8, v8, v40
v_add_f32 v16, v16, v20
v_add_f32 v24, v24, v28
v_add_f32 v32, v32, v36
v_add_f32 v9, v9, v41
v_add_f32 v17, v17, v21
v_add_f32 v25, v25, v29
v_add_f32 v33, v33, v37
v_add_f32 v10, v10, v42
v_add_f32 v18, v18, v22
v_add_f32 v26, v26, v30
v_add_f32 v34, v34, v38
v_add_f32 v11, v11, v43
v_add_f32 v19, v19, v23
v_add_f32 v27, v27, v31
v_add_f32 v35, v35, v39
v_add_f32 v8, v8, v16
v_add_f32 v24, v24, v32
v_add_f32 v9, v9, v17
v_add_f32 v25, v25, v33
v_add_f32 v10, v10, v18
v_add_f32 v26, v26, v34
v_add_f32 v11, v11, v19
v_add_f32 v27, v27, v35
v_add_f32 v8, v8, v24
v_add_f32 v9, v9, v25
v_add_f32 v10, v10, v26
v_add_f32 v11, v11, v27
v_mul_f32 v8, 0x3b000000, v8
v_mul_f32 v9, 0x3b000000, v9
v_mul_f32 v10, 0x3b000000, v10
v_mul_f32 v11, 0x3b000000, v11
v_fma_f32 v9, -v8, v8, v9
v_fma_f32 v11, -v10, v10, v11
v_max_f32 v9, 0, v9
v_max_f32 v11, 0, v11
v_add_f32 v9, 0x3727c5ac, v9
v_add_f32 v11, 0x3727c5ac, v11
v_rsq_f32 v9, v9
v_rsq_f32 v11, v11
v_sub_f32 v8, v2, v8
v_sub_f32 v10, v3, v10
v_mul_f32 v8, v8, v9
v_mul_f32 v10, v10, v11
v_cvt_pk_bf16_f32 v8, v8, v8
v_cvt_pk_bf16_f32 v10, v10, v10
v_lshlrev_b32 v12, 1, v0
ds_write_b16 v12, v8 offset:16640
ds_write_b16 v12, v10 offset:17664
s_waitcnt lgkmcnt(0)
s_barrier
s_lshl_b32 s3, s30, 7
v_add_u32 v16, s3, v5
ds_read_b128 v[8:11], v16 offset:0
ds_read_b128 v[12:15], v16 offset:64
s_waitcnt lgkmcnt(1)
v_mfma_f32_16x16x32_bf16 v[32:35], v[8:11], v[200:203], 0
v_mfma_f32_16x16x32_bf16 v[36:39], v[8:11], v[208:211], 0
v_mfma_f32_16x16x32_bf16 v[40:43], v[8:11], v[216:219], 0
s_waitcnt lgkmcnt(0)
v_mfma_f32_16x16x32_bf16 v[32:35], v[12:15], v[204:207], v[32:35]
v_mfma_f32_16x16x32_bf16 v[36:39], v[12:15], v[212:215], v[36:39]
v_mfma_f32_16x16x32_bf16 v[40:43], v[12:15], v[220:223], v[40:43]
s_mul_i32 s3, s30, 384
v_lshlrev_b32 v16, 2, v1
v_add_u32 v16, s3, v16
s_mov_b64 exec, 0xffff
s_nop 1
ds_write_b32 v16, v32 offset:20224
ds_write_b32 v16, v33 offset:20416
ds_write_b32 v16, v36 offset:20288
ds_write_b32 v16, v37 offset:20480
ds_write_b32 v16, v40 offset:20352
ds_write_b32 v16, v41 offset:20544
s_mov_b64 exec, -1
s_waitcnt lgkmcnt(0)
s_barrier
v_min_u32 v16, 47, v1
v_lshlrev_b32 v16, 2, v16
ds_read_b32 v8, v16 offset:20224
ds_read_b32 v24, v16 offset:20416
ds_read_b32 v9, v16 offset:20608
ds_read_b32 v25, v16 offset:20800
ds_read_b32 v10, v16 offset:20992
ds_read_b32 v26, v16 offset:21184
ds_read_b32 v11, v16 offset:21376
ds_read_b32 v27, v16 offset:21568
ds_read_b32 v12, v16 offset:21760
ds_read_b32 v28, v16 offset:21952
ds_read_b32 v13, v16 offset:22144
ds_read_b32 v29, v16 offset:22336
ds_read_b32 v14, v16 offset:22528
ds_read_b32 v30, v16 offset:22720
ds_read_b32 v15, v16 offset:22912
ds_read_b32 v31, v16 offset:23104
s_waitcnt lgkmcnt(0)
v_add_f32 v8, v8, v9
v_add_f32 v24, v24, v25
v_add_f32 v10, v10, v11
v_add_f32 v26, v26, v27
v_add_f32 v12, v12, v13
v_add_f32 v28, v28, v29
v_add_f32 v14, v14, v15
v_add_f32 v30, v30, v31
v_add_f32 v8, v8, v10
v_add_f32 v24, v24, v26
v_add_f32 v12, v12, v14
v_add_f32 v28, v28, v30
v_add_f32 v8, v8, v12
v_add_f32 v24, v24, v28
v_cvt_pk_bf16_f32 v10, v8, v24
v_lshlrev_b32 v8, 16, v10
v_and_b32 v9, 0xffff0000, v10
v_mul_f32 v10, 0xbfb8aa3b, v8
v_mul_f32 v11, 0xbfb8aa3b, v9
v_exp_f32 v10, v10
v_exp_f32 v11, v11
v_add_f32 v10, 1.0, v10
v_add_f32 v11, 1.0, v11
v_rcp_f32 v10, v10
v_rcp_f32 v11, v11
v_mul_f32 v8, v8, v10
v_mul_f32 v9, v9, v11
v_cmp_gt_u32 vcc, 48, v1
s_nop 1
v_cndmask_b32 v8, 0, v8, vcc
v_cndmask_b32 v9, 0, v9, vcc
v_cvt_pk_bf16_f32 v8, v8, v8
v_cvt_pk_bf16_f32 v9, v9, v9
v_lshlrev_b32 v16, 1, v1
ds_write_b16 v16, v8 offset:23296
ds_write_b16 v16, v9 offset:23424
s_waitcnt lgkmcnt(0)
ds_read_b128 v[8:11], v7 offset:0
ds_read_b128 v[12:15], v7 offset:64
s_waitcnt lgkmcnt(1)
v_mfma_f32_16x16x32_bf16 v[32:35], v[8:11], v[224:227], 0
v_mfma_f32_16x16x32_bf16 v[36:39], v[8:11], v[232:235], 0
v_mfma_f32_16x16x32_bf16 v[40:43], v[8:11], v[240:243], 0
v_mfma_f32_16x16x32_bf16 v[44:47], v[8:11], v[248:251], 0
s_waitcnt lgkmcnt(0)
v_mfma_f32_16x16x32_bf16 v[32:35], v[12:15], v[228:231], v[32:35]
v_mfma_f32_16x16x32_bf16 v[36:39], v[12:15], v[236:239], v[36:39]
v_mfma_f32_16x16x32_bf16 v[40:43], v[12:15], v[244:247], v[40:43]
v_mfma_f32_16x16x32_bf16 v[44:47], v[12:15], v[252:255], v[44:47]
s_nop 4
v_min_u32 v32, 0xfffffffe, v32
v_min_u32 v33, 0xfffffffe, v33
v_min_u32 v36, 0xfffffffe, v36
v_min_u32 v37, 0xfffffffe, v37
v_min_u32 v40, 0xfffffffe, v40
v_min_u32 v41, 0xfffffffe, v41
v_min_u32 v44, 0xfffffffe, v44
v_min_u32 v45, 0xfffffffe, v45
v_lshlrev_b32 v48, 2, v1
s_lshl_b32 s4, s30, 8
s_lshl_b32 s5, s31, 11
s_add_u32 s4, s4, s5
s_add_u32 s4, s4, 2949120
v_add_u32 v48, s4, v48
s_cmp_eq_u32 s94, 0
s_cbranch_scc1 .L124
s_mov_b32 s3, s91
s_lshl_b32 s3, s3, 16
v_add_u32 v49, s3, v48
s_mov_b64 exec, 0xffff
global_store_dword v49, v32, s[28:29] offset:0 sc1
global_store_dword v49, v36, s[28:29] offset:64 sc1
global_store_dword v49, v40, s[28:29] offset:128 sc1
global_store_dword v49, v44, s[28:29] offset:192 sc1
s_mov_b64 exec, -1
.L124:
s_nop 4
s_cmp_eq_u32 s78, 0
s_cbranch_scc1 .L125
s_add_u32 s3, s68, 8
s_lshl_b32 s3, s3, 16
v_add_u32 v49, s3, v48
s_mov_b64 exec, 0xffff
global_store_dword v49, v33, s[28:29] offset:0 sc1
global_store_dword v49, v37, s[28:29] offset:64 sc1
global_store_dword v49, v41, s[28:29] offset:128 sc1
global_store_dword v49, v45, s[28:29] offset:192 sc1
s_mov_b64 exec, -1
.L125:
s_nop 4
.L115:
s_nop 4
s_lshr_b32 s3, s31, 2
s_cmp_eq_u32 s3, s30
s_cselect_b32 s73, s79, 0
s_cselect_b32 s96, s95, 0
s_or_b32 s97, s74, s96
s_cmp_lg_u32 s97, 0
s_cbranch_scc1 .L128
v_mov_b32 v8, 0
v_mov_b32 v9, 0
v_mov_b32 v10, 0
v_mov_b32 v11, 0
v_mov_b32 v12, 0
v_mov_b32 v13, 0
v_mov_b32 v14, 0
v_mov_b32 v15, 0
v_mov_b32 v16, 0
v_mov_b32 v17, 0
v_mov_b32 v18, 0
v_mov_b32 v19, 0
v_mov_b32 v20, 0
v_mov_b32 v21, 0
v_mov_b32 v22, 0
v_mov_b32 v23, 0
v_mov_b32 v24, 0
v_mov_b32 v25, 0
v_mov_b32 v26, 0
v_mov_b32 v27, 0
v_mov_b32 v28, 0
v_mov_b32 v29, 0
v_mov_b32 v30, 0
v_mov_b32 v31, 0
v_mov_b32 v32, 0
v_mov_b32 v33, 0
v_mov_b32 v34, 0
v_mov_b32 v35, 0
v_mov_b32 v36, 0
v_mov_b32 v37, 0
v_mov_b32 v38, 0
v_mov_b32 v39, 0
.L128:
s_nop 4
s_cmp_lg_u32 s73, 0
s_cbranch_scc1 .L129
v_mov_b32 v40, 0
v_mov_b32 v41, 0
v_mov_b32 v42, 0
v_mov_b32 v43, 0
v_mov_b32 v44, 0
v_mov_b32 v45, 0
v_mov_b32 v46, 0
v_mov_b32 v47, 0
v_mov_b32 v48, 0
v_mov_b32 v49, 0
v_mov_b32 v50, 0
v_mov_b32 v51, 0
v_mov_b32 v52, 0
v_mov_b32 v53, 0
v_mov_b32 v54, 0
v_mov_b32 v55, 0
v_mov_b32 v56, 0
v_mov_b32 v57, 0
v_mov_b32 v58, 0
v_mov_b32 v59, 0
v_mov_b32 v60, 0
v_mov_b32 v61, 0
v_mov_b32 v62, 0
v_mov_b32 v63, 0
v_mov_b32 v64, 0
v_mov_b32 v65, 0
v_mov_b32 v66, 0
v_mov_b32 v67, 0
v_mov_b32 v68, 0
v_mov_b32 v69, 0
v_mov_b32 v70, 0
v_mov_b32 v71, 0
.L129:
s_nop 4
.L126:
s_nop 4
s_cmp_eq_u32 s97, 0
s_cbranch_scc1 .L130
s_mov_b32 s3, s91
s_lshl_b32 s3, s3, 16
s_add_u32 s3, s3, 2953216
s_add_u32 s76, s28, s3
s_addc_u32 s77, s29, 0
global_load_dword v8, v4, s[76:77] offset:-4096 sc1
global_load_dword v9, v4, s[76:77] offset:-2048 sc1
global_load_dword v10, v4, s[76:77] offset:0 sc1
global_load_dword v11, v4, s[76:77] offset:2048 sc1
s_add_u32 s76, s76, 8192
s_addc_u32 s77, s77, 0
global_load_dword v12, v4, s[76:77] offset:-4096 sc1
global_load_dword v13, v4, s[76:77] offset:-2048 sc1
global_load_dword v14, v4, s[76:77] offset:0 sc1
global_load_dword v15, v4, s[76:77] offset:2048 sc1
s_add_u32 s76, s76, 8192
s_addc_u32 s77, s77, 0
global_load_dword v16, v4, s[76:77] offset:-4096 sc1
global_load_dword v17, v4, s[76:77] offset:-2048 sc1
global_load_dword v18, v4, s[76:77] offset:0 sc1
global_load_dword v19, v4, s[76:77] offset:2048 sc1
s_add_u32 s76, s76, 8192
s_addc_u32 s77, s77, 0
global_load_dword v20, v4, s[76:77] offset:-4096 sc1
global_load_dword v21, v4, s[76:77] offset:-2048 sc1
global_load_dword v22, v4, s[76:77] offset:0 sc1
global_load_dword v23, v4, s[76:77] offset:2048 sc1
s_add_u32 s76, s76, 8192
s_addc_u32 s77, s77, 0
global_load_dword v24, v4, s[76:77] offset:-4096 sc1
global_load_dword v25, v4, s[76:77] offset:-2048 sc1
global_load_dword v26, v4, s[76:77] offset:0 sc1
global_load_dword v27, v4, s[76:77] offset:2048 sc1
s_add_u32 s76, s76, 8192
s_addc_u32 s77, s77, 0
global_load_dword v28, v4, s[76:77] offset:-4096 sc1
global_load_dword v29, v4, s[76:77] offset:-2048 sc1
global_load_dword v30, v4, s[76:77] offset:0 sc1
global_load_dword v31, v4, s[76:77] offset:2048 sc1
s_add_u32 s76, s76, 8192
s_addc_u32 s77, s77, 0
global_load_dword v32, v4, s[76:77] offset:-4096 sc1
global_load_dword v33, v4, s[76:77] offset:-2048 sc1
global_load_dword v34, v4, s[76:77] offset:0 sc1
global_load_dword v35, v4, s[76:77] offset:2048 sc1
s_add_u32 s76, s76, 8192
s_addc_u32 s77, s77, 0
global_load_dword v36, v4, s[76:77] offset:-4096 sc1
global_load_dword v37, v4, s[76:77] offset:-2048 sc1
global_load_dword v38, v4, s[76:77] offset:0 sc1
global_load_dword v39, v4, s[76:77] offset:2048 sc1
.L130:
s_nop 4
s_cmp_eq_u32 s73, 0
s_cbranch_scc1 .L131
s_add_u32 s3, s69, 8
s_lshl_b32 s3, s3, 16
s_add_u32 s3, s3, 2953216
s_add_u32 s76, s28, s3
s_addc_u32 s77, s29, 0
global_load_dword v40, v4, s[76:77] offset:-4096 sc1
global_load_dword v41, v4, s[76:77] offset:-2048 sc1
global_load_dword v42, v4, s[76:77] offset:0 sc1
global_load_dword v43, v4, s[76:77] offset:2048 sc1
s_add_u32 s76, s76, 8192
s_addc_u32 s77, s77, 0
global_load_dword v44, v4, s[76:77] offset:-4096 sc1
global_load_dword v45, v4, s[76:77] offset:-2048 sc1
global_load_dword v46, v4, s[76:77] offset:0 sc1
global_load_dword v47, v4, s[76:77] offset:2048 sc1
s_add_u32 s76, s76, 8192
s_addc_u32 s77, s77, 0
global_load_dword v48, v4, s[76:77] offset:-4096 sc1
global_load_dword v49, v4, s[76:77] offset:-2048 sc1
global_load_dword v50, v4, s[76:77] offset:0 sc1
global_load_dword v51, v4, s[76:77] offset:2048 sc1
s_add_u32 s76, s76, 8192
s_addc_u32 s77, s77, 0
global_load_dword v52, v4, s[76:77] offset:-4096 sc1
global_load_dword v53, v4, s[76:77] offset:-2048 sc1
global_load_dword v54, v4, s[76:77] offset:0 sc1
global_load_dword v55, v4, s[76:77] offset:2048 sc1
s_add_u32 s76, s76, 8192
s_addc_u32 s77, s77, 0
global_load_dword v56, v4, s[76:77] offset:-4096 sc1
global_load_dword v57, v4, s[76:77] offset:-2048 sc1
global_load_dword v58, v4, s[76:77] offset:0 sc1
global_load_dword v59, v4, s[76:77] offset:2048 sc1
s_add_u32 s76, s76, 8192
s_addc_u32 s77, s77, 0
global_load_dword v60, v4, s[76:77] offset:-4096 sc1
global_load_dword v61, v4, s[76:77] offset:-2048 sc1
global_load_dword v62, v4, s[76:77] offset:0 sc1
global_load_dword v63, v4, s[76:77] offset:2048 sc1
s_add_u32 s76, s76, 8192
s_addc_u32 s77, s77, 0
global_load_dword v64, v4, s[76:77] offset:-4096 sc1
global_load_dword v65, v4, s[76:77] offset:-2048 sc1
global_load_dword v66, v4, s[76:77] offset:0 sc1
global_load_dword v67, v4, s[76:77] offset:2048 sc1
s_add_u32 s76, s76, 8192
s_addc_u32 s77, s77, 0
global_load_dword v68, v4, s[76:77] offset:-4096 sc1
global_load_dword v69, v4, s[76:77] offset:-2048 sc1
global_load_dword v70, v4, s[76:77] offset:0 sc1
global_load_dword v71, v4, s[76:77] offset:2048 sc1
.L131:
s_nop 4
s_waitcnt vmcnt(0)
v_max3_u32 v2, v8, v9, v10
v_max3_u32 v3, v11, v12, v13
v_max3_u32 v2, v2, v14, v15
v_max3_u32 v3, v3, v16, v17
v_max3_u32 v2, v2, v18, v19
v_max3_u32 v3, v3, v20, v21
v_max3_u32 v2, v2, v22, v23
v_max3_u32 v3, v3, v24, v25
v_max3_u32 v2, v2, v26, v27
v_max3_u32 v3, v3, v28, v29
v_max3_u32 v2, v2, v30, v31
v_max3_u32 v3, v3, v32, v33
v_max3_u32 v2, v2, v34, v35
v_max3_u32 v3, v3, v36, v37
v_max3_u32 v2, v2, v38, v39
v_max3_u32 v3, v3, v40, v41
v_max3_u32 v2, v2, v42, v43
v_max3_u32 v3, v3, v44, v45
v_max3_u32 v2, v2, v46, v47
v_max3_u32 v3, v3, v48, v49
v_max3_u32 v2, v2, v50, v51
v_max3_u32 v3, v3, v52, v53
v_max3_u32 v2, v2, v54, v55
v_max3_u32 v3, v3, v56, v57
v_max3_u32 v2, v2, v58, v59
v_max3_u32 v3, v3, v60, v61
v_max3_u32 v2, v2, v62, v63
v_max3_u32 v3, v3, v64, v65
v_max3_u32 v2, v2, v66, v67
v_max3_u32 v3, v3, v68, v69
v_max3_u32 v2, v2, v70, v71
v_max_u32 v2, v2, v3
v_cmp_eq_u32 vcc, -1, v2
s_nop 0
s_cmp_eq_u64 vcc, 0
s_cbranch_scc1 .L127
s_sleep 1
s_add_u32 s47, s47, 1
s_cmp_lt_u32 s47, 262144
s_cbranch_scc1 .L126
s_endpgm
.L127:
s_nop 4
v_add_f32 v8, v8, v9
v_add_f32 v40, v40, v41
v_add_f32 v10, v10, v11
v_add_f32 v42, v42, v43
v_add_f32 v12, v12, v13
v_add_f32 v44, v44, v45
v_add_f32 v14, v14, v15
v_add_f32 v46, v46, v47
v_add_f32 v16, v16, v17
v_add_f32 v48, v48, v49
v_add_f32 v18, v18, v19
v_add_f32 v50, v50, v51
v_add_f32 v20, v20, v21
v_add_f32 v52, v52, v53
v_add_f32 v22, v22, v23
v_add_f32 v54, v54, v55
v_add_f32 v24, v24, v25
v_add_f32 v56, v56, v57
v_add_f32 v26, v26, v27
v_add_f32 v58, v58, v59
v_add_f32 v28, v28, v29
v_add_f32 v60, v60, v61
v_add_f32 v30, v30, v31
v_add_f32 v62, v62, v63
v_add_f32 v32, v32, v33
v_add_f32 v64, v64, v65
v_add_f32 v34, v34, v35
v_add_f32 v66, v66, v67
v_add_f32 v36, v36, v37
v_add_f32 v68, v68, v69
v_add_f32 v38, v38, v39
v_add_f32 v70, v70, v71
s_min_u32 s4, s92, 7
s_min_u32 s5, s69, 7
s_lshl_b32 s4, s4, 11
s_lshl_b32 s5, s5, 11
v_add_u32 v9, s4, v4
v_add_u32 v41, s5, v4
ds_read_b32 v2, v9 offset:0
ds_read_b32 v3, v41 offset:0
v_add_f32 v8, v8, v10
v_add_f32 v40, v40, v42
v_add_f32 v12, v12, v14
v_add_f32 v44, v44, v46
v_add_f32 v16, v16, v18
v_add_f32 v48, v48, v50
v_add_f32 v20, v20, v22
v_add_f32 v52, v52, v54
v_add_f32 v24, v24, v26
v_add_f32 v56, v56, v58
v_add_f32 v28, v28, v30
v_add_f32 v60, v60, v62
v_add_f32 v32, v32, v34
v_add_f32 v64, v64, v66
v_add_f32 v36, v36, v38
v_add_f32 v68, v68, v70
v_add_f32 v8, v8, v12
v_add_f32 v40, v40, v44
v_add_f32 v16, v16, v20
v_add_f32 v48, v48, v52
v_add_f32 v24, v24, v28
v_add_f32 v56, v56, v60
v_add_f32 v32, v32, v36
v_add_f32 v64, v64, v68
v_add_f32 v8, v8, v16
v_add_f32 v40, v40, v48
v_add_f32 v24, v24, v32
v_add_f32 v56, v56, v64
v_add_f32 v8, v8, v24
v_add_f32 v40, v40, v56
v_cvt_pk_bf16_f32 v10, v8, v40
v_lshlrev_b32 v11, 16, v10
v_and_b32 v10, 0xffff0000, v10
s_waitcnt lgkmcnt(0)
v_add_f32 v2, v2, v11
v_add_f32 v3, v3, v10
v_cvt_pk_bf16_f32 v10, v2, v3
v_lshlrev_b32 v2, 16, v10
v_and_b32 v3, 0xffff0000, v10
s_cmp_eq_u32 s74, 0
s_cbranch_scc1 .L132
ds_write_b32 v9, v2 offset:0
.L132:
s_nop 4
s_cmp_eq_u32 s73, 0
s_cbranch_scc1 .L133
v_cvt_pk_bf16_f32 v8, v3, v3
v_lshrrev_b32 v9, 4, v0
v_cmp_eq_u32 vcc, s31, v9
s_lshl_b32 s3, s69, 10
v_lshlrev_b32 v10, 1, v0
v_add_u32 v10, s3, v10
s_and_saveexec_b64 s[4:5], vcc
global_store_short v10, v8, s[24:25]
s_mov_b64 exec, s[4:5]
.L133:
s_nop 4
s_cmp_eq_u32 s96, 0
s_cbranch_scc1 .L134
v_cvt_pk_bf16_f32 v8, v2, v2
v_lshrrev_b32 v9, 4, v0
v_cmp_eq_u32 vcc, s31, v9
s_lshl_b32 s3, s92, 10
v_lshlrev_b32 v10, 1, v0
v_add_u32 v10, s3, v10
s_and_saveexec_b64 s[4:5], vcc
global_store_short v10, v8, s[24:25]
s_mov_b64 exec, s[4:5]
.L134:
s_nop 4
s_cmp_eq_u32 s74, 0
s_cbranch_scc1 .L135
s_add_u32 s33, s52, 2
s_cmp_lt_u32 s33, 8
s_cselect_b32 s88, 1, 0
s_min_u32 s4, s33, 7
s_lshl_b32 s4, s4, 11
v_add_u32 v9, s4, v4
ds_read_b32 v3, v9 offset:0
s_waitcnt lgkmcnt(0)
v_mov_b32 v12, v2
v_mul_f32 v13, v2, v2
v_mov_b32 v14, v3
v_mul_f32 v15, v3, v3
v_add_f32_dpp v12, v12, v12 row_ror:8 row_mask:0xf bank_mask:0xf
v_add_f32_dpp v13, v13, v13 row_ror:8 row_mask:0xf bank_mask:0xf
v_add_f32_dpp v14, v14, v14 row_ror:8 row_mask:0xf bank_mask:0xf
v_add_f32_dpp v15, v15, v15 row_ror:8 row_mask:0xf bank_mask:0xf
v_add_f32_dpp v12, v12, v12 row_ror:4 row_mask:0xf bank_mask:0xf
v_add_f32_dpp v13, v13, v13 row_ror:4 row_mask:0xf bank_mask:0xf
v_add_f32_dpp v14, v14, v14 row_ror:4 row_mask:0xf bank_mask:0xf
v_add_f32_dpp v15, v15, v15 row_ror:4 row_mask:0xf bank_mask:0xf
v_add_f32_dpp v12, v12, v12 row_ror:2 row_mask:0xf bank_mask:0xf
v_add_f32_dpp v13, v13, v13 row_ror:2 row_mask:0xf bank_mask:0xf
v_add_f32_dpp v14, v14, v14 row_ror:2 row_mask:0xf bank_mask:0xf
v_add_f32_dpp v15, v15, v15 row_ror:2 row_mask:0xf bank_mask:0xf
v_add_f32_dpp v12, v12, v12 row_ror:1 row_mask:0xf bank_mask:0xf
v_add_f32_dpp v13, v13, v13 row_ror:1 row_mask:0xf bank_mask:0xf
v_add_f32_dpp v14, v14, v14 row_ror:1 row_mask:0xf bank_mask:0xf
v_add_f32_dpp v15, v15, v15 row_ror:1 row_mask:0xf bank_mask:0xf
v_mov_b32 v16, v12
v_mov_b32 v17, v13
v_mov_b32 v18, v14
v_mov_b32 v19, v15
v_permlane16_swap_b32 v12, v16
v_permlane16_swap_b32 v13, v17
v_permlane16_swap_b32 v14, v18
v_permlane16_swap_b32 v15, v19
v_add_f32 v12, v12, v16
v_add_f32 v13, v13, v17
v_add_f32 v14, v14, v18
v_add_f32 v15, v15, v19
v_mov_b32 v16, v12
v_mov_b32 v17, v13
v_mov_b32 v18, v14
v_mov_b32 v19, v15
v_permlane32_swap_b32 v12, v16
v_permlane32_swap_b32 v13, v17
v_permlane32_swap_b32 v14, v18
v_permlane32_swap_b32 v15, v19
v_add_f32 v12, v12, v16
v_add_f32 v13, v13, v17
v_add_f32 v14, v14, v18
v_add_f32 v15, v15, v19
s_lshl_b32 s3, s30, 4
v_mov_b32 v16, s3
s_mov_b64 exec, 1
ds_write_b128 v16, v[12:15] offset:16384
s_mov_b64 exec, -1
s_waitcnt lgkmcnt(0)
s_barrier
v_mov_b32 v12, 0
ds_read_b128 v[8:11], v12 offset:16384
ds_read_b128 v[16:19], v12 offset:16416
ds_read_b128 v[20:23], v12 offset:16432
ds_read_b128 v[24:27], v12 offset:16448
ds_read_b128 v[28:31], v12 offset:16464
ds_read_b128 v[32:35], v12 offset:16480
ds_read_b128 v[36:39], v12 offset:16496
ds_read_b128 v[40:43], v12 offset:16400
s_waitcnt lgkmcnt(0)
v_add_f32 v8, v8, v40
v_add_f32 v16, v16, v20
v_add_f32 v24, v24, v28
v_add_f32 v32, v32, v36
v_add_f32 v9, v9, v41
v_add_f32 v17, v17, v21
v_add_f32 v25, v25, v29
v_add_f32 v33, v33, v37
v_add_f32 v10, v10, v42
v_add_f32 v18, v18, v22
v_add_f32 v26, v26, v30
v_add_f32 v34, v34, v38
v_add_f32 v11, v11, v43
v_add_f32 v19, v19, v23
v_add_f32 v27, v27, v31
v_add_f32 v35, v35, v39
v_add_f32 v8, v8, v16
v_add_f32 v24, v24, v32
v_add_f32 v9, v9, v17
v_add_f32 v25, v25, v33
v_add_f32 v10, v10, v18
v_add_f32 v26, v26, v34
v_add_f32 v11, v11, v19
v_add_f32 v27, v27, v35
v_add_f32 v8, v8, v24
v_add_f32 v9, v9, v25
v_add_f32 v10, v10, v26
v_add_f32 v11, v11, v27
v_mul_f32 v8, 0x3b000000, v8
v_mul_f32 v9, 0x3b000000, v9
v_mul_f32 v10, 0x3b000000, v10
v_mul_f32 v11, 0x3b000000, v11
v_fma_f32 v9, -v8, v8, v9
v_fma_f32 v11, -v10, v10, v11
v_max_f32 v9, 0, v9
v_max_f32 v11, 0, v11
v_add_f32 v9, 0x3727c5ac, v9
v_add_f32 v11, 0x3727c5ac, v11
v_rsq_f32 v9, v9
v_rsq_f32 v11, v11
v_sub_f32 v8, v2, v8
v_sub_f32 v10, v3, v10
v_mul_f32 v8, v8, v9
v_mul_f32 v10, v10, v11
v_cvt_pk_bf16_f32 v8, v8, v8
v_cvt_pk_bf16_f32 v10, v10, v10
v_lshlrev_b32 v12, 1, v0
ds_write_b16 v12, v8 offset:16640
ds_write_b16 v12, v10 offset:17664
s_waitcnt lgkmcnt(0)
s_barrier
ds_read_b128 v[8:11], v5 offset:0
ds_read_b128 v[12:15], v5 offset:64
ds_read_b128 v[16:19], v5 offset:128
ds_read_b128 v[20:23], v5 offset:192
ds_read_b128 v[24:27], v5 offset:256
ds_read_b128 v[28:31], v5 offset:320
ds_read_b128 v[32:35], v5 offset:384
ds_read_b128 v[36:39], v5 offset:448
ds_read_b128 v[44:47], v5 offset:512
ds_read_b128 v[48:51], v5 offset:576
ds_read_b128 v[52:55], v5 offset:640
ds_read_b128 v[56:59], v5 offset:704
ds_read_b128 v[60:63], v5 offset:768
ds_read_b128 v[64:67], v5 offset:832
ds_read_b128 v[68:71], v5 offset:896
s_waitcnt lgkmcnt(14)
v_mfma_f32_16x16x32_bf16 v[40:43], v[8:11], v[72:75], 0
s_waitcnt lgkmcnt(13)
v_mfma_f32_16x16x32_bf16 v[40:43], v[12:15], v[76:79], v[40:43]
s_waitcnt lgkmcnt(12)
v_mfma_f32_16x16x32_bf16 v[40:43], v[16:19], v[80:83], v[40:43]
s_waitcnt lgkmcnt(11)
v_mfma_f32_16x16x32_bf16 v[40:43], v[20:23], v[84:87], v[40:43]
s_waitcnt lgkmcnt(10)
v_mfma_f32_16x16x32_bf16 v[40:43], v[24:27], v[88:91], v[40:43]
s_waitcnt lgkmcnt(9)
v_mfma_f32_16x16x32_bf16 v[40:43], v[28:31], v[92:95], v[40:43]
s_waitcnt lgkmcnt(8)
v_mfma_f32_16x16x32_bf16 v[40:43], v[32:35], v[96:99], v[40:43]
s_waitcnt lgkmcnt(7)
v_mfma_f32_16x16x32_bf16 v[40:43], v[36:39], v[100:103], v[40:43]
s_waitcnt lgkmcnt(6)
v_mfma_f32_16x16x32_bf16 v[40:43], v[44:47], v[104:107], v[40:43]
s_waitcnt lgkmcnt(5)
v_mfma_f32_16x16x32_bf16 v[40:43], v[48:51], v[108:111], v[40:43]
s_waitcnt lgkmcnt(4)
v_mfma_f32_16x16x32_bf16 v[40:43], v[52:55], v[112:115], v[40:43]
s_waitcnt lgkmcnt(3)
v_mfma_f32_16x16x32_bf16 v[40:43], v[56:59], v[116:119], v[40:43]
s_waitcnt lgkmcnt(2)
v_mfma_f32_16x16x32_bf16 v[40:43], v[60:63], v[120:123], v[40:43]
s_waitcnt lgkmcnt(1)
v_mfma_f32_16x16x32_bf16 v[40:43], v[64:67], v[124:127], v[40:43]
s_waitcnt lgkmcnt(0)
v_mfma_f32_16x16x32_bf16 v[40:43], v[68:71], v[128:131], v[40:43]
ds_read_b128 v[8:11], v5 offset:960
s_waitcnt lgkmcnt(0)
v_mfma_f32_16x16x32_bf16 v[40:43], v[8:11], v[132:135], v[40:43]
s_nop 7
v_mov_b32_dpp v44, v40 quad_perm:[1,0,3,2] row_mask:0xf bank_mask:0xf
v_mov_b32_dpp v45, v41 quad_perm:[1,0,3,2] row_mask:0xf bank_mask:0xf
v_cvt_pk_bf16_f32 v40, v40, v44
v_cvt_pk_bf16_f32 v41, v41, v45
v_min_u32 v40, 0xfffffffe, v40
v_min_u32 v41, 0xfffffffe, v41
v_lshlrev_b32 v44, 1, v1
s_lshl_b32 s4, s30, 5
v_add_u32 v44, s4, v44
s_cmp_eq_u32 s74, 0
s_cbranch_scc1 .L136
s_add_u32 s3, s52, 8
s_lshl_b32 s3, s3, 5
s_add_u32 s3, s3, s31
s_mul_i32 s3, s3, 1792
s_add_u32 s3, s3, 4194304
v_add_u32 v45, s3, v44
s_mov_b64 exec, 0x5555
global_store_dword v45, v40, s[28:29] offset:0 sc1
global_store_dword v45, v40, s[28:29] offset:256 sc1
global_store_dword v45, v40, s[28:29] offset:512 sc1
global_store_dword v45, v40, s[28:29] offset:768 sc1
global_store_dword v45, v40, s[28:29] offset:1024 sc1
global_store_dword v45, v40, s[28:29] offset:1280 sc1
global_store_dword v45, v40, s[28:29] offset:1536 sc1
s_mov_b64 exec, -1
.L136:
s_nop 4
s_cmp_eq_u32 s88, 0
s_cbranch_scc1 .L137
s_add_u32 s3, s33, 0
s_lshl_b32 s3, s3, 5
s_add_u32 s3, s3, s31
s_mul_i32 s3, s3, 1792
s_add_u32 s3, s3, 4194304
v_add_u32 v45, s3, v44
s_mov_b64 exec, 0x5555
global_store_dword v45, v41, s[28:29] offset:0 sc1
global_store_dword v45, v41, s[28:29] offset:256 sc1
global_store_dword v45, v41, s[28:29] offset:512 sc1
global_store_dword v45, v41, s[28:29] offset:768 sc1
global_store_dword v45, v41, s[28:29] offset:1024 sc1
global_store_dword v45, v41, s[28:29] offset:1280 sc1
global_store_dword v45, v41, s[28:29] offset:1536 sc1
s_mov_b64 exec, -1
.L137:
s_nop 4
.L135:
s_nop 4
s_add_u32 s52, s52, 1
s_cmp_lt_u32 s52, 11
s_cbranch_scc1 L_ch_loop
L_exit:
s_nop 4
s_endpgm
.section .rodata,"a"
.p2align 6
.amdhsa_kernel interleave_layers__gqa_block_cached__dense_activation_silu__decode_kernel
  .amdhsa_next_free_vgpr 256
  .amdhsa_next_free_sgpr 100
  .amdhsa_accum_offset 256
  .amdhsa_group_segment_fixed_size 0
  .amdhsa_kernarg_size 88
  .amdhsa_user_sgpr_count 2
  .amdhsa_user_sgpr_kernarg_segment_ptr 1
  .amdhsa_system_sgpr_workgroup_id_x 1
.end_amdhsa_kernel
```
